```python
import torch

def _softmax(x, axis=-1):
    return torch.softmax(x, dim=axis)
def _gelu(x):
    return torch.nn.functional.gelu(x, approximate="tanh")
def _silu(x):
    return torch.nn.functional.silu(x)
def _sigmoid(x):
    return torch.sigmoid(x)
def _layernorm(x, axis=-1, eps=1e-5):
    m = x.mean(dim=axis, keepdim=True)
    v = x.var(dim=axis, keepdim=True, unbiased=False)
    return (x - m) / torch.sqrt(v + eps)
def _scatter_add(tgt, idx, src, axis=0):
    return tgt.clone().index_add_(axis, idx, src)
def _segment_sum(src, seg, n):
    out = torch.zeros((n,) + src.shape[1:], dtype=src.dtype)
    return out.index_add_(0, seg, src)
def _pad(x, pw):
    flat = tuple(v for pair in reversed(pw) for v in pair)
    return torch.nn.functional.pad(x, flat)

kernel_name = 'interleave_layers__linear_attn_block__mixer_token_mlp__prompt'

def setup_inputs():

    _w = (lambda a: (lambda t: t.to(torch.bfloat16) if t.is_floating_point() else t)(torch.as_tensor(a)))
    def _A_setup():
        B, S, D = 1, 2048, 448
        return {
            "x": _w((lambda *s: torch.randn(*s, dtype=torch.bfloat16) * 0.05)(B, S, D)),
            "wqkv": _w((lambda *s: torch.randn(*s, dtype=torch.bfloat16) * 0.1)(D, 3 * D)),
            "wo": _w((lambda *s: torch.randn(*s, dtype=torch.bfloat16) * 0.05)(D, D)),
        }
    _A_in = _A_setup()

    def _B_setup():
        B, S, D, F = 1, 2048, 448, 1792
        return {
            "x": _w((lambda *s: torch.randn(*s, dtype=torch.bfloat16) * 0.05)(B, S, D)),
            "w1": _w((lambda *s: torch.randn(*s, dtype=torch.bfloat16) * 0.8)(S, F) * (S ** -0.5)),
            "b1": _w((lambda *s: torch.randn(*s, dtype=torch.bfloat16) * 12.8)(F) * 0.02),
            "w2": _w((lambda *s: torch.randn(*s, dtype=torch.bfloat16) * 0.4)(F, S) * (F ** -0.5)),
            "b2": _w((lambda *s: torch.randn(*s, dtype=torch.bfloat16) * 6.4)(S) * 0.02),
        }
    _B_in = _B_setup()

    return {
        "A_x": _A_in["x"],
        "A_wqkv": _A_in["wqkv"],
        "A_wo": _A_in["wo"],
        "B_x": _B_in["x"],
        "B_w1": _B_in["w1"],
        "B_b1": _B_in["b1"],
        "B_w2": _B_in["w2"],
        "B_b2": _B_in["b2"],
    }

def reference(A_x, A_wqkv, A_wo, B_x, B_w1, B_b1, B_w2, B_b2):
    def _A_ref(x, wqkv, wo):
        B, S, D = x.shape
        H = 16; Dh = D // H
        qkv = (lambda x, *d: x.permute(*d))((x @ wqkv).reshape(B, S, 3, H, Dh), 2, 0, 3, 1, 4)
        q, k, v = qkv[0], qkv[1], qkv[2]
        phi = lambda t: torch.where(t > 0, t + 1, torch.exp(t)) + 1e-6
        pq, pk = phi(q), phi(k)
        kv = torch.einsum("bhsd,bhse->bhde", pk, v)
        z = torch.einsum("bhsd->bhd", pk)
        num = torch.einsum("bhqd,bhde->bhqe", pq, kv)
        den = torch.einsum("bhqd,bhd->bhq", pq, z)[..., None] + 1e-6
        o = num / den
        return (lambda x, *d: x.permute(*d))(o, 0, 2, 1, 3).reshape(B, S, D) @ wo

    def _B_ref(x, w1, b1, w2, b2):
        B, S, D = x.shape
        h = _layernorm(x, axis=-1)
        u = torch.einsum("bsd,sf->bdf", h, w1) + b1
        u = _gelu(u)
        y = torch.einsum("bdf,fs->bds", u, w2) + b2
        return (lambda x, *d: x.permute(*d))(y, 0, 2, 1)

    x = A_x
    x = x + _A_ref(_layernorm(x, axis=-1), A_wqkv, A_wo)
    x = x + _B_ref(_layernorm(x, axis=-1), B_w1, B_b1, B_w2, B_b2)
    x = x + _A_ref(_layernorm(x, axis=-1), A_wqkv, A_wo)
    x = x + _B_ref(_layernorm(x, axis=-1), B_w1, B_b1, B_w2, B_b2)
    return x
```

```asm
; @launch grid=(256,1,1) block=(256,1,1) lds=163840
.amdgcn_target "amdgcn-amd-amdhsa--gfx950"
.text
.globl interleave_layers__linear_attn_block__mixer_token_mlp__prompt_kernel
.p2align 8
.type interleave_layers__linear_attn_block__mixer_token_mlp__prompt_kernel,@function
interleave_layers__linear_attn_block__mixer_token_mlp__prompt_kernel:
    s_cmp_ge_u32 s2, 256
    s_cbranch_scc1 L_end
    s_load_dwordx16 s[80:95], s[0:1], 0
    s_load_dwordx4 s[96:99], s[0:1], 64
    s_load_dwordx2 s[100:101], s[0:1], 80
    v_lshrrev_b32 v60, 6, v0
    v_and_b32 v0, 63, v0
    v_readfirstlane_b32 s48, v60
    v_lshlrev_b32 v1, 4, v0
    s_and_b32 s76, s2, 7
    s_lshr_b32 s77, s2, 3
    s_and_b32 s3, s77, 1
    s_lshl_b32 s49, s76, 1
    s_add_u32 s49, s49, s3
    s_lshr_b32 s50, s77, 1
    s_lshl_b32 s5, s49, 2
    s_add_u32 s5, s5, s48
    s_lshl_b32 s78, s48, 11
    s_lshl_b32 s58, s48, 14
    s_add_u32 s58, s58, 86016
    s_mul_i32 s59, s48, 3072
    s_add_u32 s59, s59, 151552
    s_lshl_b32 s68, s50, 15
    s_lshl_b32 s3, s48, 9
    s_add_u32 s68, s68, s3
    s_lshl_b32 s3, s49, 11
    s_add_u32 s76, s68, s3
    v_lshlrev_b32 v2, 3, v0
    s_lshl_b32 s69, s5, 15
    s_lshl_b32 s3, s50, 11
    s_add_u32 s69, s69, s3
    s_add_u32 s69, s69, 1048576
    s_mul_i32 s65, s50, 56
    s_and_b32 s65, s65, 0xfffffff0
    s_mul_i32 s3, s48, 86016
    s_add_u32 s65, s65, s3
    v_lshrrev_b32 v60, 2, v0
    v_mul_u32_u24 v9, 2688, v60
    v_and_b32 v62, 3, v0
    v_lshl_add_u32 v9, v62, 4, v9
    v_lshrrev_b32 v60, 3, v0
    v_mul_u32_u24 v60, 896, v60
    v_lshrrev_b32 v61, 4, v0
    v_and_b32 v62, 7, v0
    v_xor_b32 v61, v61, v62
    v_lshl_add_u32 v8, v61, 4, v60
    v_xor_b32 v61, 4, v61
    v_lshl_add_u32 v10, v61, 4, v60
    v_mov_b32 v240, -1
    v_mov_b32 v241, -1
    v_mov_b32 v242, -1
    v_mov_b32 v243, -1
    s_waitcnt lgkmcnt(0)
    s_mov_b32 s8, s80
    s_and_b32 s9, s81, 0xffff
    s_mov_b32 s10, 1835008
    s_mov_b32 s11, 0x20000
    s_mov_b32 s12, s82
    s_and_b32 s13, s83, 0xffff
    s_mov_b32 s14, 1204224
    s_mov_b32 s15, 0x20000
    s_lshr_b32 s3, s2, 3
    s_lshl_b32 s3, s3, 2
    s_add_u32 s3, s3, s48
    s_mul_i32 s4, s3, 1792
    s_and_b32 s77, s2, 7
    s_mul_i32 s77, s77, 229376
    s_add_u32 s4, s4, s77
    v_lshlrev_b32 v63, 7, v0
    v_min_u32 v62, 1788, v63
    s_mul_i32 s77, s3, 10752
    v_and_b32 v63, 15, v0
    v_min_u32 v63, 13, v63
    v_lshlrev_b32 v63, 7, v63
    v_lshrrev_b32 v61, 4, v0
    v_mul_u32_u24 v61, 2688, v61
    v_add_u32 v63, v63, v61
    buffer_load_dword a191, v62, s[8:11], s4 offen
    buffer_load_dword a191, v63, s[12:15], s77 offen offset:896
    v_and_b32 v62, 15, v0
    v_min_u32 v62, 6, v62
    v_lshl_add_u32 v62, v62, 7, v61
    buffer_load_dword a191, v62, s[12:15], s77 offen
    s_getpc_b64 s[6:7]
    s_and_b32 s6, s6, 0xffffff00
    s_lshr_b32 s3, s2, 3
    s_lshl_b32 s3, s3, 2
    s_add_u32 s3, s3, s48
    s_lshl_b32 s3, s3, 9
    v_and_b32 v63, 7, v0
    v_lshl_add_u32 v63, v63, 6, s3
    v_min_u32 v63, 0xd664, v63
    global_load_dword a191, v63, s[6:7]
    s_mov_b32 s28, s100
    s_and_b32 s29, s101, 0xffff
    s_mov_b32 s30, 67108864
    s_mov_b32 s31, 0x20000
    s_mov_b32 s16, s84
    s_and_b32 s17, s85, 0xffff
    s_mov_b32 s18, 401408
    s_mov_b32 s19, 0x20000
    s_mov_b32 s20, s88
    s_and_b32 s21, s89, 0xffff
    s_mov_b32 s22, 7340032
    s_mov_b32 s23, 0x20000
    s_mov_b32 s36, s90
    s_and_b32 s37, s91, 0xffff
    s_mov_b32 s38, 3584
    s_mov_b32 s39, 0x20000
    s_mov_b32 s24, s92
    s_and_b32 s25, s93, 0xffff
    s_mov_b32 s26, 7340032
    s_mov_b32 s27, 0x20000
    s_mov_b32 s40, s94
    s_and_b32 s41, s95, 0xffff
    s_mov_b32 s42, 4096
    s_mov_b32 s43, 0x20000
    s_mov_b32 s32, s96
    s_and_b32 s33, s97, 0xffff
    s_mov_b32 s34, 1835008
    s_mov_b32 s35, 0x20000
    s_mov_b32 s44, s98
    s_and_b32 s45, s99, 0xffff
    s_mov_b32 s46, 256
    s_mov_b32 s47, 0x20000
    s_and_b32 s76, s2, 7
    s_lshr_b32 s77, s2, 3
    s_and_b32 s3, s77, 3
    s_lshl_b32 s51, s76, 2
    s_add_u32 s51, s51, s3
    s_lshr_b32 s52, s77, 2
    s_cmp_lt_u32 s52, 7
    s_cselect_b32 s55, 1, 0
    s_mul_i32 s3, s77, 37
    s_lshr_b32 s3, s3, 8
    s_and_b32 s53, s76, 1
    s_lshl_b32 s53, s53, 2
    s_add_u32 s53, s53, s3
    s_mul_i32 s80, s3, 7
    s_sub_u32 s80, s77, s80
    s_lshr_b32 s54, s76, 1
    s_mul_i32 s54, s54, 7
    s_add_u32 s54, s54, s80
    s_mov_b32 s56, 0
    s_and_b32 s80, s48, 1
    s_lshr_b32 s81, s48, 1
    s_lshl_b32 s84, s51, 1
    s_add_u32 s84, s84, s80
    s_lshl_b32 s85, s52, 1
    s_add_u32 s85, s85, s81
    s_and_b32 s3, s53, 1
    s_lshl_b32 s3, s3, 2
    s_add_u32 s3, s3, s48
    s_mul_i32 s62, s3, 917504
    s_lshl_b32 s3, s54, 7
    s_add_u32 s62, s62, s3
    s_and_b32 s3, s52, 1
    s_lshl_b32 s3, s3, 2
    s_add_u32 s3, s3, s48
    s_mul_i32 s63, s3, 917504
    s_lshl_b32 s3, s51, 7
    s_add_u32 s63, s63, s3
    s_mul_i32 s64, s48, 100352
    s_lshl_b32 s3, s52, 7
    s_add_u32 s64, s64, s3
    s_mul_i32 s74, s84, 3584
    s_lshl_b32 s3, s85, 8
    s_add_u32 s74, s74, s3
    s_add_u32 s74, s74, 15007744
    s_lshl_b32 s75, s52, 18
    s_lshl_b32 s3, s84, 11
    s_add_u32 s75, s75, s3
    s_add_u32 s75, s75, 6291456
    s_mul_i32 s0, s84, 28672
    s_lshl_b32 s3, s52, 12
    s_add_u32 s0, s0, s3
    s_lshl_b32 s3, s81, 10
    s_add_u32 s0, s0, s3
    s_add_u32 s0, s0, 13172736
    s_mul_i32 s1, s53, 229376
    s_lshl_b32 s3, s54, 12
    s_add_u32 s1, s1, s3
    s_lshl_b32 s3, s80, 11
    s_add_u32 s1, s1, s3
    s_lshl_b32 s3, s81, 10
    s_add_u32 s1, s1, s3
    s_add_u32 s1, s1, 9961472
    s_cmp_ge_u32 s53, 7
    s_cselect_b32 s1, 1073741824, s1
    s_cmp_eq_u32 s55, 0
    s_cselect_b32 s74, 1073741824, s74
    s_cselect_b32 s75, 1073741824, s75
    s_cselect_b32 s0, 1073741824, s0
    s_cselect_b32 s1, 1073741824, s1
    s_lshl_b32 s3, s81, 17
    s_add_u32 s61, s75, s3
    s_lshl_b32 s3, s48, 11
    s_add_u32 s3, s3, 16777216
    s_lshl_b32 s57, s2, 14
    s_add_u32 s57, s57, s3
    s_xor_b32 s83, s2, 32
    s_lshl_b32 s83, s83, 14
    s_add_u32 s83, s83, s3
    s_bitcmp1_b32 s53, 0
    s_cselect_b32 s3, 0xffe40000, 0
    s_add_u32 s82, s57, s3
    s_add_u32 s82, s82, 917504
    s_mov_b32 s72, 1.0
    s_mov_b32 s73, 1.0
    s_mov_b32 s70, 0xbdd2d3e8
    s_mov_b32 s71, 0xbdd2d3e8
    v_bfe_u32 v58, v0, 2, 3
    v_mul_u32_u24 v58, 3584, v58
    v_lshrrev_b32 v60, 5, v0
    s_and_b32 s3, s48, 1
    v_xor_b32 v60, s3, v60
    v_lshl_add_u32 v58, v60, 6, v58
    v_and_b32 v60, 3, v0
    s_and_b32 s3, s48, 2
    v_xor_b32 v60, s3, v60
    v_lshl_add_u32 v58, v60, 4, v58
    v_bfe_u32 v59, v0, 2, 3
    v_mul_u32_u24 v59, 4096, v59
    v_lshrrev_b32 v60, 5, v0
    s_and_b32 s3, s48, 1
    v_xor_b32 v60, s3, v60
    v_lshl_add_u32 v59, v60, 6, v59
    v_and_b32 v60, 3, v0
    v_lshl_add_u32 v59, v60, 4, v59
    v_lshrrev_b32 v60, 5, v0
    v_bfe_u32 v61, v0, 2, 2
    v_bfe_u32 v62, v0, 4, 1
    v_and_b32 v63, 3, v0
    v_lshlrev_b32 v63, 3, v63
    v_lshl_add_u32 v63, v62, 5, v63
    v_lshl_add_u32 v63, v61, 6, v63
    v_lshl_add_u32 v63, v60, 8, v63
    v_add_u32 v3, s58, v63
    v_and_b32 v61, 31, v0
    v_cmp_gt_u32 vcc, 28, v61
    s_nop 1
    v_cndmask_b32 v4, 0, -1, vcc
    v_cmp_eq_u32 vcc, 28, v61
    v_mov_b32 v62, 0x3f803f80
    s_nop 0
    v_cndmask_b32 v5, 0, v62, vcc
    v_cmp_gt_u32 vcc, 32, v0
    s_nop 1
    v_cndmask_b32 v6, 0, -1, vcc
    v_bfe_u32 v62, v0, 1, 3
    v_xor_b32 v62, v62, v60
    v_lshlrev_b32 v63, 7, v61
    v_add_u32 v63, s58, v63
    v_xor_b32 v16, 0, v62
    v_lshl_add_u32 v16, v16, 4, v63
    v_xor_b32 v17, 2, v62
    v_lshl_add_u32 v17, v17, 4, v63
    v_xor_b32 v18, 4, v62
    v_lshl_add_u32 v18, v18, 4, v63
    v_xor_b32 v19, 6, v62
    v_lshl_add_u32 v19, v19, 4, v63
    s_and_b32 s3, s50, 1
    s_lshl_b32 s3, s3, 3
    s_sub_u32 s3, s3, s58
    v_add_u32 v12, s3, v3
    v_lshrrev_b32 v63, 5, v0
    v_lshl_add_u32 v12, v63, 8, v12
    v_add_u32 v13, 256, v12
    v_add_u32 v14, 57344, v12
    v_add_u32 v15, 57344, v13
    v_mov_b32 v248, 0x3f803f80
    v_mov_b32 v249, 0x3f803f80
    v_mov_b32 v250, 0x3f803f80
    v_mov_b32 v251, 0x3f803f80
    v_mov_b32 v252, 0
    v_mov_b32 v253, 0
    v_mov_b32 v254, 0
    v_mov_b32 v255, 0
    s_getreg_b32 s3, hwreg(HW_REG_XCC_ID, 0, 3)
    s_mul_i32 s79, s3, s3
    s_lshl_b32 s79, s79, 8
    s_add_u32 s79, s79, s3
    s_lshl_b32 s79, s79, 8
    s_add_u32 s79, s79, 1
    s_and_b32 s3, s2, 3
    s_lshl_b32 s6, s3, 2
    s_and_b32 s3, s2, 4
    s_lshl_b32 s3, s3, 5
    s_add_u32 s6, s6, s3
    s_nop 0
    s_mul_i32 s7, s5, 28672
    s_mul_i32 s60, s84, 28672
    s_lshl_b32 s3, s52, 7
    s_add_u32 s60, s60, s3
    s_lshr_b32 s3, s48, 1
    s_lshl_b32 s3, s3, 5
    s_add_u32 s60, s60, s3
    s_cmp_eq_u32 s55, 0
    s_cselect_b32 s60, 1073741824, s60
    v_mul_u32_u24 v246, 896, v61
    v_lshl_add_u32 v246, v60, 3, v246
    s_lshl_b32 s77, s84, 6
    v_lshlrev_b32 v247, 1, v61
    v_lshlrev_b32 v244, 2, v0
    s_lshl_b32 s3, s49, 11
    s_add_u32 s80, s68, s3
    s_add_u32 s4, s80, 0
    buffer_store_dwordx2 v[240:241], v2, s[28:31], s4 offen offset:0 sc0 sc1
    s_add_u32 s4, s69, 0
    buffer_store_dwordx4 v[240:243], v1, s[28:31], s4 offen offset:0 sc0 sc1
    s_add_u32 s4, s69, 0
    buffer_store_dwordx4 v[240:243], v1, s[28:31], s4 offen offset:1024 sc0 sc1
    s_add_u32 m0, s58, 0
    s_add_u32 s4, s7, 0
    buffer_load_dwordx4 v8, s[8:11], s4 offen lds
    s_add_u32 m0, s58, 1024
    s_add_u32 s4, s7, 7168
    buffer_load_dwordx4 v10, s[8:11], s4 offen lds
    s_add_u32 m0, s58, 2048
    s_add_u32 s4, s7, 14336
    buffer_load_dwordx4 v8, s[8:11], s4 offen lds
    s_add_u32 m0, s58, 3072
    s_add_u32 s4, s7, 21504
    buffer_load_dwordx4 v10, s[8:11], s4 offen lds
    s_add_u32 m0, s58, 4096
    s_add_u32 s4, s7, 128
    buffer_load_dwordx4 v8, s[8:11], s4 offen lds
    s_add_u32 m0, s58, 5120
    s_add_u32 s4, s7, 7296
    buffer_load_dwordx4 v10, s[8:11], s4 offen lds
    s_add_u32 m0, s58, 6144
    s_add_u32 s4, s7, 14464
    buffer_load_dwordx4 v8, s[8:11], s4 offen lds
    s_add_u32 m0, s58, 7168
    s_add_u32 s4, s7, 21632
    buffer_load_dwordx4 v10, s[8:11], s4 offen lds
    s_add_u32 m0, s58, 8192
    s_add_u32 s4, s7, 256
    buffer_load_dwordx4 v8, s[8:11], s4 offen lds
    s_add_u32 m0, s58, 9216
    s_add_u32 s4, s7, 7424
    buffer_load_dwordx4 v10, s[8:11], s4 offen lds
    s_add_u32 m0, s58, 10240
    s_add_u32 s4, s7, 14592
    buffer_load_dwordx4 v8, s[8:11], s4 offen lds
    s_add_u32 m0, s58, 11264
    s_add_u32 s4, s7, 21760
    buffer_load_dwordx4 v10, s[8:11], s4 offen lds
    s_add_u32 m0, s58, 12288
    s_add_u32 s4, s7, 384
    buffer_load_dwordx4 v8, s[8:11], s4 offen lds
    s_add_u32 m0, s58, 13312
    s_add_u32 s4, s7, 7552
    buffer_load_dwordx4 v10, s[8:11], s4 offen lds
    s_add_u32 m0, s58, 14336
    s_add_u32 s4, s7, 14720
    buffer_load_dwordx4 v8, s[8:11], s4 offen lds
    s_add_u32 m0, s58, 15360
    s_add_u32 s4, s7, 21888
    buffer_load_dwordx4 v10, s[8:11], s4 offen lds
    s_add_u32 m0, s78, 0
    s_add_u32 s4, s65, 896
    buffer_load_dwordx4 v9, s[12:15], s4 offen lds
    s_add_u32 m0, s78, 28672
    s_add_u32 s4, s65, 1792
    buffer_load_dwordx4 v9, s[12:15], s4 offen lds
    s_add_u32 m0, s78, 1024
    s_add_u32 s4, s65, 43904
    buffer_load_dwordx4 v9, s[12:15], s4 offen lds
    s_add_u32 m0, s78, 29696
    s_add_u32 s4, s65, 44800
    buffer_load_dwordx4 v9, s[12:15], s4 offen lds
    s_waitcnt vmcnt(4)
    ds_read_b128 v[128:131], v16 offset:0
    ds_read_b128 v[132:135], v17 offset:0
    ds_read_b128 v[136:139], v18 offset:0
    ds_read_b128 v[140:143], v19 offset:0
    ds_read_b128 v[144:147], v16 offset:4096
    ds_read_b128 v[148:151], v17 offset:4096
    ds_read_b128 v[152:155], v18 offset:4096
    ds_read_b128 v[156:159], v19 offset:4096
    ds_read_b128 v[160:163], v16 offset:8192
    ds_read_b128 v[164:167], v17 offset:8192
    ds_read_b128 v[168:171], v18 offset:8192
    ds_read_b128 v[172:175], v19 offset:8192
    ds_read_b128 v[176:179], v16 offset:12288
    ds_read_b128 v[180:183], v17 offset:12288
    ds_read_b128 v[184:187], v18 offset:12288
    ds_read_b128 v[188:191], v19 offset:12288
    s_barrier
    s_cmp_lg_u32 s48, 0
    s_cbranch_scc1 IA1
    v_mov_b32 v63, s79
    v_mov_b32 v62, 0
    s_mov_b64 exec, 1
    buffer_atomic_add v63, v62, s[44:47], s6 offen sc1
    s_mov_b64 exec, -1
IA1:
    s_waitcnt lgkmcnt(0)
    s_mov_b32 s66, 0x3fb8aa3b
    s_mov_b32 s67, 0x3fb8aa3b
    v_dot2_f32_bf16 v252, v128, v248, v252
    v_dot2_f32_bf16 v254, v128, v128, v254
    v_dot2_f32_bf16 v253, v129, v248, v253
    v_dot2_f32_bf16 v255, v129, v129, v255
    v_dot2_f32_bf16 v252, v130, v248, v252
    v_dot2_f32_bf16 v254, v130, v130, v254
    v_dot2_f32_bf16 v253, v131, v248, v253
    v_dot2_f32_bf16 v255, v131, v131, v255
    v_dot2_f32_bf16 v252, v132, v248, v252
    v_dot2_f32_bf16 v254, v132, v132, v254
    s_add_u32 m0, s78, 8192
    s_add_u32 s4, s65, 344960
    buffer_load_dwordx4 v9, s[12:15], s4 offen lds
    v_dot2_f32_bf16 v253, v133, v248, v253
    v_dot2_f32_bf16 v255, v133, v133, v255
    v_dot2_f32_bf16 v252, v134, v248, v252
    v_dot2_f32_bf16 v254, v134, v134, v254
    v_dot2_f32_bf16 v253, v135, v248, v253
    v_dot2_f32_bf16 v255, v135, v135, v255
    v_dot2_f32_bf16 v252, v136, v248, v252
    v_dot2_f32_bf16 v254, v136, v136, v254
    v_dot2_f32_bf16 v253, v137, v248, v253
    v_dot2_f32_bf16 v255, v137, v137, v255
    s_add_u32 m0, s78, 36864
    s_add_u32 s4, s65, 345856
    buffer_load_dwordx4 v9, s[12:15], s4 offen lds
    v_dot2_f32_bf16 v252, v138, v248, v252
    v_dot2_f32_bf16 v254, v138, v138, v254
    v_dot2_f32_bf16 v253, v139, v248, v253
    v_dot2_f32_bf16 v255, v139, v139, v255
    v_dot2_f32_bf16 v252, v140, v248, v252
    v_dot2_f32_bf16 v254, v140, v140, v254
    v_dot2_f32_bf16 v253, v141, v248, v253
    v_dot2_f32_bf16 v255, v141, v141, v255
    v_dot2_f32_bf16 v252, v142, v248, v252
    v_dot2_f32_bf16 v254, v142, v142, v254
    s_add_u32 m0, s78, 9216
    s_add_u32 s4, s65, 387968
    buffer_load_dwordx4 v9, s[12:15], s4 offen lds
    v_dot2_f32_bf16 v253, v143, v248, v253
    v_dot2_f32_bf16 v255, v143, v143, v255
    v_dot2_f32_bf16 v252, v144, v248, v252
    v_dot2_f32_bf16 v254, v144, v144, v254
    v_dot2_f32_bf16 v253, v145, v248, v253
    v_dot2_f32_bf16 v255, v145, v145, v255
    v_dot2_f32_bf16 v252, v146, v248, v252
    v_dot2_f32_bf16 v254, v146, v146, v254
    v_dot2_f32_bf16 v253, v147, v248, v253
    v_dot2_f32_bf16 v255, v147, v147, v255
    s_add_u32 m0, s78, 37888
    s_add_u32 s4, s65, 388864
    buffer_load_dwordx4 v9, s[12:15], s4 offen lds
    v_dot2_f32_bf16 v252, v148, v248, v252
    v_dot2_f32_bf16 v254, v148, v148, v254
    v_dot2_f32_bf16 v253, v149, v248, v253
    v_dot2_f32_bf16 v255, v149, v149, v255
    v_dot2_f32_bf16 v252, v150, v248, v252
    v_dot2_f32_bf16 v254, v150, v150, v254
    v_dot2_f32_bf16 v253, v151, v248, v253
    v_dot2_f32_bf16 v255, v151, v151, v255
    v_dot2_f32_bf16 v252, v152, v248, v252
    v_dot2_f32_bf16 v254, v152, v152, v254
    s_add_u32 m0, s58, 0
    s_add_u32 s4, s7, 512
    buffer_load_dwordx4 v8, s[8:11], s4 offen lds
    v_dot2_f32_bf16 v253, v153, v248, v253
    v_dot2_f32_bf16 v255, v153, v153, v255
    v_dot2_f32_bf16 v252, v154, v248, v252
    v_dot2_f32_bf16 v254, v154, v154, v254
    v_dot2_f32_bf16 v253, v155, v248, v253
    v_dot2_f32_bf16 v255, v155, v155, v255
    v_dot2_f32_bf16 v252, v156, v248, v252
    v_dot2_f32_bf16 v254, v156, v156, v254
    v_dot2_f32_bf16 v253, v157, v248, v253
    v_dot2_f32_bf16 v255, v157, v157, v255
    s_add_u32 m0, s58, 1024
    s_add_u32 s4, s7, 7680
    buffer_load_dwordx4 v10, s[8:11], s4 offen lds
    v_dot2_f32_bf16 v252, v158, v248, v252
    v_dot2_f32_bf16 v254, v158, v158, v254
    v_dot2_f32_bf16 v253, v159, v248, v253
    v_dot2_f32_bf16 v255, v159, v159, v255
    v_dot2_f32_bf16 v252, v160, v248, v252
    v_dot2_f32_bf16 v254, v160, v160, v254
    v_dot2_f32_bf16 v253, v161, v248, v253
    v_dot2_f32_bf16 v255, v161, v161, v255
    v_dot2_f32_bf16 v252, v162, v248, v252
    v_dot2_f32_bf16 v254, v162, v162, v254
    s_add_u32 m0, s58, 2048
    s_add_u32 s4, s7, 14848
    buffer_load_dwordx4 v8, s[8:11], s4 offen lds
    v_dot2_f32_bf16 v253, v163, v248, v253
    v_dot2_f32_bf16 v255, v163, v163, v255
    v_dot2_f32_bf16 v252, v164, v248, v252
    v_dot2_f32_bf16 v254, v164, v164, v254
    v_dot2_f32_bf16 v253, v165, v248, v253
    v_dot2_f32_bf16 v255, v165, v165, v255
    v_dot2_f32_bf16 v252, v166, v248, v252
    v_dot2_f32_bf16 v254, v166, v166, v254
    v_dot2_f32_bf16 v253, v167, v248, v253
    v_dot2_f32_bf16 v255, v167, v167, v255
    s_add_u32 m0, s58, 3072
    s_add_u32 s4, s7, 22016
    buffer_load_dwordx4 v10, s[8:11], s4 offen lds
    v_dot2_f32_bf16 v252, v168, v248, v252
    v_dot2_f32_bf16 v254, v168, v168, v254
    v_dot2_f32_bf16 v253, v169, v248, v253
    v_dot2_f32_bf16 v255, v169, v169, v255
    v_dot2_f32_bf16 v252, v170, v248, v252
    v_dot2_f32_bf16 v254, v170, v170, v254
    v_dot2_f32_bf16 v253, v171, v248, v253
    v_dot2_f32_bf16 v255, v171, v171, v255
    v_dot2_f32_bf16 v252, v172, v248, v252
    v_dot2_f32_bf16 v254, v172, v172, v254
    s_add_u32 m0, s58, 4096
    s_add_u32 s4, s7, 640
    buffer_load_dwordx4 v8, s[8:11], s4 offen lds
    v_dot2_f32_bf16 v253, v173, v248, v253
    v_dot2_f32_bf16 v255, v173, v173, v255
    v_dot2_f32_bf16 v252, v174, v248, v252
    v_dot2_f32_bf16 v254, v174, v174, v254
    v_dot2_f32_bf16 v253, v175, v248, v253
    v_dot2_f32_bf16 v255, v175, v175, v255
    v_dot2_f32_bf16 v252, v176, v248, v252
    v_dot2_f32_bf16 v254, v176, v176, v254
    v_dot2_f32_bf16 v253, v177, v248, v253
    v_dot2_f32_bf16 v255, v177, v177, v255
    s_add_u32 m0, s58, 5120
    s_add_u32 s4, s7, 7808
    buffer_load_dwordx4 v10, s[8:11], s4 offen lds
    v_dot2_f32_bf16 v252, v178, v248, v252
    v_dot2_f32_bf16 v254, v178, v178, v254
    v_dot2_f32_bf16 v253, v179, v248, v253
    v_dot2_f32_bf16 v255, v179, v179, v255
    v_dot2_f32_bf16 v252, v180, v248, v252
    v_dot2_f32_bf16 v254, v180, v180, v254
    v_dot2_f32_bf16 v253, v181, v248, v253
    v_dot2_f32_bf16 v255, v181, v181, v255
    v_dot2_f32_bf16 v252, v182, v248, v252
    v_dot2_f32_bf16 v254, v182, v182, v254
    s_add_u32 m0, s58, 6144
    s_add_u32 s4, s7, 14976
    buffer_load_dwordx4 v8, s[8:11], s4 offen lds
    v_dot2_f32_bf16 v253, v183, v248, v253
    v_dot2_f32_bf16 v255, v183, v183, v255
    v_dot2_f32_bf16 v252, v184, v248, v252
    v_dot2_f32_bf16 v254, v184, v184, v254
    v_dot2_f32_bf16 v253, v185, v248, v253
    v_dot2_f32_bf16 v255, v185, v185, v255
    v_dot2_f32_bf16 v252, v186, v248, v252
    v_dot2_f32_bf16 v254, v186, v186, v254
    v_dot2_f32_bf16 v253, v187, v248, v253
    v_dot2_f32_bf16 v255, v187, v187, v255
    s_add_u32 m0, s58, 7168
    s_add_u32 s4, s7, 22144
    buffer_load_dwordx4 v10, s[8:11], s4 offen lds
    v_dot2_f32_bf16 v252, v188, v248, v252
    v_dot2_f32_bf16 v254, v188, v188, v254
    v_dot2_f32_bf16 v253, v189, v248, v253
    v_dot2_f32_bf16 v255, v189, v189, v255
    v_dot2_f32_bf16 v252, v190, v248, v252
    v_dot2_f32_bf16 v254, v190, v190, v254
    v_dot2_f32_bf16 v253, v191, v248, v253
    v_dot2_f32_bf16 v255, v191, v191, v255
    s_waitcnt vmcnt(12)
    s_barrier
    v_add_u32 v20, s78, v12
    s_lshl_b32 s3, s48, 10
    v_add_u32 v21, s3, v12
    ds_read_b64_tr_b16 a[192:193], v12 offset:0
    ds_read_b64_tr_b16 a[194:195], v13 offset:0
    ds_read_b64_tr_b16 a[196:197], v12 offset:28672
    ds_read_b64_tr_b16 a[198:199], v13 offset:28672
    ds_read_b64_tr_b16 a[200:201], v12 offset:1024
    ds_read_b64_tr_b16 a[202:203], v13 offset:1024
    ds_read_b64_tr_b16 a[204:205], v12 offset:29696
    ds_read_b64_tr_b16 a[206:207], v13 offset:29696
    ds_read_b64_tr_b16 a[208:209], v12 offset:2048
    ds_read_b64_tr_b16 a[210:211], v13 offset:2048
    ds_read_b64_tr_b16 a[212:213], v12 offset:30720
    ds_read_b64_tr_b16 a[214:215], v13 offset:30720
    s_waitcnt lgkmcnt(8)
    v_mfma_f32_32x32x16_bf16 v[64:79], v[128:131], a[192:195], 0
    ds_read_b64_tr_b16 a[216:217], v12 offset:3072
    ds_read_b64_tr_b16 a[218:219], v13 offset:3072
    s_add_u32 m0, s58, 8192
    s_add_u32 s4, s7, 768
    buffer_load_dwordx4 v8, s[8:11], s4 offen lds
    v_mfma_f32_32x32x16_bf16 v[80:95], v[128:131], a[196:199], 0
    ds_read_b64_tr_b16 a[220:221], v12 offset:31744
    ds_read_b64_tr_b16 a[222:223], v13 offset:31744
    ds_read_b64_tr_b16 a[0:1], v20 offset:0
    ds_read_b64_tr_b16 a[2:3], v20 offset:256
    s_waitcnt lgkmcnt(10)
    v_mfma_f32_32x32x16_bf16 v[64:79], v[132:135], a[200:203], v[64:79]
    ds_read_b64_tr_b16 a[192:193], v12 offset:4096
    ds_read_b64_tr_b16 a[194:195], v13 offset:4096
    s_add_u32 m0, s58, 9216
    s_add_u32 s4, s7, 7936
    buffer_load_dwordx4 v10, s[8:11], s4 offen lds
    v_mfma_f32_32x32x16_bf16 v[80:95], v[132:135], a[204:207], v[80:95]
    ds_read_b64_tr_b16 a[196:197], v12 offset:32768
    ds_read_b64_tr_b16 a[198:199], v13 offset:32768
    ds_read_b64_tr_b16 a[4:5], v20 offset:28672
    ds_read_b64_tr_b16 a[6:7], v20 offset:28928
    s_waitcnt lgkmcnt(12)
    v_mfma_f32_32x32x16_bf16 v[64:79], v[136:139], a[208:211], v[64:79]
    ds_read_b64_tr_b16 a[200:201], v12 offset:5120
    ds_read_b64_tr_b16 a[202:203], v13 offset:5120
    s_add_u32 m0, s58, 10240
    s_add_u32 s4, s7, 15104
    buffer_load_dwordx4 v8, s[8:11], s4 offen lds
    v_mfma_f32_32x32x16_bf16 v[80:95], v[136:139], a[212:215], v[80:95]
    ds_read_b64_tr_b16 a[204:205], v12 offset:33792
    ds_read_b64_tr_b16 a[206:207], v13 offset:33792
    ds_read_b64_tr_b16 a[8:9], v20 offset:1024
    ds_read_b64_tr_b16 a[10:11], v20 offset:1280
    s_waitcnt lgkmcnt(14)
    v_mfma_f32_32x32x16_bf16 v[64:79], v[140:143], a[216:219], v[64:79]
    ds_read_b64_tr_b16 a[208:209], v12 offset:6144
    ds_read_b64_tr_b16 a[210:211], v13 offset:6144
    s_add_u32 m0, s58, 11264
    s_add_u32 s4, s7, 22272
    buffer_load_dwordx4 v10, s[8:11], s4 offen lds
    v_mfma_f32_32x32x16_bf16 v[80:95], v[140:143], a[220:223], v[80:95]
    ds_read_b64_tr_b16 a[212:213], v12 offset:34816
    ds_read_b64_tr_b16 a[214:215], v13 offset:34816
    ds_read_b64_tr_b16 a[12:13], v20 offset:29696
    ds_read_b64_tr_b16 a[14:15], v20 offset:29952
    s_waitcnt lgkmcnt(14)
    v_mfma_f32_32x32x16_bf16 v[64:79], v[144:147], a[192:195], v[64:79]
    ds_read_b64_tr_b16 a[216:217], v12 offset:7168
    ds_read_b64_tr_b16 a[218:219], v13 offset:7168
    s_add_u32 m0, s78, 16384
    s_add_u32 s4, s65, 689024
    buffer_load_dwordx4 v9, s[12:15], s4 offen lds
    v_mfma_f32_32x32x16_bf16 v[80:95], v[144:147], a[196:199], v[80:95]
    ds_read_b64_tr_b16 a[220:221], v12 offset:35840
    ds_read_b64_tr_b16 a[222:223], v13 offset:35840
    s_waitcnt vmcnt(13)
    s_barrier
    s_waitcnt lgkmcnt(12)
    v_mfma_f32_32x32x16_bf16 v[64:79], v[148:151], a[200:203], v[64:79]
    ds_read_b64_tr_b16 a[192:193], v12 offset:8192
    ds_read_b64_tr_b16 a[194:195], v13 offset:8192
    s_add_u32 m0, s78, 45056
    s_add_u32 s4, s65, 689920
    buffer_load_dwordx4 v9, s[12:15], s4 offen lds
    v_mfma_f32_32x32x16_bf16 v[80:95], v[148:151], a[204:207], v[80:95]
    ds_read_b64_tr_b16 a[196:197], v12 offset:36864
    ds_read_b64_tr_b16 a[198:199], v13 offset:36864
    s_waitcnt lgkmcnt(8)
    v_mfma_f32_32x32x16_bf16 v[96:111], v[248:251], a[0:3], 0
    v_mfma_f32_32x32x16_bf16 v[112:127], v[248:251], a[4:7], 0
    v_mfma_f32_32x32x16_bf16 v[64:79], v[152:155], a[208:211], v[64:79]
    ds_read_b64_tr_b16 a[200:201], v12 offset:9216
    ds_read_b64_tr_b16 a[202:203], v13 offset:9216
    s_add_u32 m0, s78, 17408
    s_add_u32 s4, s65, 732032
    buffer_load_dwordx4 v9, s[12:15], s4 offen lds
    v_mfma_f32_32x32x16_bf16 v[80:95], v[152:155], a[212:215], v[80:95]
    ds_read_b64_tr_b16 a[204:205], v12 offset:37888
    ds_read_b64_tr_b16 a[206:207], v13 offset:37888
    v_mfma_f32_32x32x16_bf16 v[96:111], v[248:251], a[8:11], v[96:111]
    v_mfma_f32_32x32x16_bf16 v[112:127], v[248:251], a[12:15], v[112:127]
    s_waitcnt lgkmcnt(8)
    v_mfma_f32_32x32x16_bf16 v[64:79], v[156:159], a[216:219], v[64:79]
    ds_read_b64_tr_b16 a[208:209], v12 offset:10240
    ds_read_b64_tr_b16 a[210:211], v13 offset:10240
    s_add_u32 m0, s78, 46080
    s_add_u32 s4, s65, 732928
    buffer_load_dwordx4 v9, s[12:15], s4 offen lds
    v_mfma_f32_32x32x16_bf16 v[80:95], v[156:159], a[220:223], v[80:95]
    ds_read_b64_tr_b16 a[212:213], v12 offset:38912
    ds_read_b64_tr_b16 a[214:215], v13 offset:38912
    ds_read_b64_tr_b16 a[0:1], v20 offset:8192
    ds_read_b64_tr_b16 a[2:3], v20 offset:8448
    s_waitcnt lgkmcnt(10)
    v_mfma_f32_32x32x16_bf16 v[64:79], v[160:163], a[192:195], v[64:79]
    ds_read_b64_tr_b16 a[216:217], v12 offset:11264
    ds_read_b64_tr_b16 a[218:219], v13 offset:11264
    s_lshl_b32 s3, s48, 10
    s_add_u32 m0, s3, 24576
    s_mul_i32 s3, s48, 43008
    s_sub_u32 s4, s65, s3
    s_add_u32 s4, s4, 1033088
    buffer_load_dwordx4 v9, s[12:15], s4 offen lds
    v_mfma_f32_32x32x16_bf16 v[80:95], v[160:163], a[196:199], v[80:95]
    ds_read_b64_tr_b16 a[220:221], v12 offset:39936
    ds_read_b64_tr_b16 a[222:223], v13 offset:39936
    ds_read_b64_tr_b16 a[4:5], v20 offset:36864
    ds_read_b64_tr_b16 a[6:7], v20 offset:37120
    s_waitcnt lgkmcnt(12)
    v_mfma_f32_32x32x16_bf16 v[64:79], v[164:167], a[200:203], v[64:79]
    ds_read_b64_tr_b16 a[192:193], v12 offset:12288
    ds_read_b64_tr_b16 a[194:195], v13 offset:12288
    s_lshl_b32 s3, s48, 10
    s_add_u32 m0, s3, 53248
    s_mul_i32 s3, s48, 43008
    s_sub_u32 s4, s65, s3
    s_add_u32 s4, s4, 1033984
    buffer_load_dwordx4 v9, s[12:15], s4 offen lds
    v_mfma_f32_32x32x16_bf16 v[80:95], v[164:167], a[204:207], v[80:95]
    ds_read_b64_tr_b16 a[196:197], v12 offset:40960
    ds_read_b64_tr_b16 a[198:199], v13 offset:40960
    ds_read_b64_tr_b16 a[8:9], v20 offset:9216
    ds_read_b64_tr_b16 a[10:11], v20 offset:9472
    s_waitcnt lgkmcnt(14)
    v_mfma_f32_32x32x16_bf16 v[64:79], v[168:171], a[208:211], v[64:79]
    ds_read_b64_tr_b16 a[200:201], v12 offset:13312
    ds_read_b64_tr_b16 a[202:203], v13 offset:13312
    s_cmp_lg_u32 s55, 0
    s_cbranch_scc1 SP2
    s_add_u32 s4, s57, 4194304
    buffer_store_dwordx4 v[240:243], v1, s[28:31], s4 offen offset:0 sc0 sc1
    s_add_u32 s4, s57, 4202496
    buffer_store_dwordx4 v[240:243], v1, s[28:31], s4 offen offset:0 sc0 sc1
    s_add_u32 s4, s80, 3145728
    buffer_store_dwordx2 v[240:241], v2, s[28:31], s4 offen offset:0 sc0 sc1
    s_add_u32 s4, s69, 3145728
    buffer_store_dwordx4 v[240:243], v1, s[28:31], s4 offen offset:0 sc0 sc1
    s_add_u32 s4, s69, 3145728
    buffer_store_dwordx4 v[240:243], v1, s[28:31], s4 offen offset:1024 sc0 sc1
SP2:
    v_mfma_f32_32x32x16_bf16 v[80:95], v[168:171], a[212:215], v[80:95]
    ds_read_b64_tr_b16 a[204:205], v12 offset:41984
    ds_read_b64_tr_b16 a[206:207], v13 offset:41984
    ds_read_b64_tr_b16 a[12:13], v20 offset:37888
    ds_read_b64_tr_b16 a[14:15], v20 offset:38144
    s_waitcnt lgkmcnt(14)
    v_mfma_f32_32x32x16_bf16 v[64:79], v[172:175], a[216:219], v[64:79]
    ds_read_b64_tr_b16 a[208:209], v12 offset:14336
    ds_read_b64_tr_b16 a[210:211], v13 offset:14336
    s_add_u32 s4, s74, 0
    buffer_store_dword v240, v244, s[28:31], s4 offen offset:0 sc0 sc1
    v_mfma_f32_32x32x16_bf16 v[80:95], v[172:175], a[220:223], v[80:95]
    ds_read_b64_tr_b16 a[212:213], v12 offset:43008
    ds_read_b64_tr_b16 a[214:215], v13 offset:43008
    s_waitcnt lgkmcnt(12)
    v_mfma_f32_32x32x16_bf16 v[64:79], v[176:179], a[192:195], v[64:79]
    ds_read_b64_tr_b16 a[216:217], v12 offset:15360
    ds_read_b64_tr_b16 a[218:219], v13 offset:15360
    s_add_u32 s4, s61, 0
    buffer_store_dwordx4 v[240:243], v1, s[28:31], s4 offen offset:0 sc0 sc1
    v_mfma_f32_32x32x16_bf16 v[80:95], v[176:179], a[196:199], v[80:95]
    ds_read_b64_tr_b16 a[220:221], v12 offset:44032
    ds_read_b64_tr_b16 a[222:223], v13 offset:44032
    s_waitcnt lgkmcnt(8)
    v_mfma_f32_32x32x16_bf16 v[96:111], v[248:251], a[0:3], v[96:111]
    v_mfma_f32_32x32x16_bf16 v[112:127], v[248:251], a[4:7], v[112:127]
    s_waitcnt vmcnt(8)
    s_waitcnt vmcnt(4)
    s_waitcnt vmcnt(2)
    s_barrier
    ds_read_b128 v[192:195], v16 offset:0
    ds_read_b128 v[196:199], v17 offset:0
    ds_read_b128 v[200:203], v18 offset:0
    ds_read_b128 v[204:207], v19 offset:0
    ds_read_b128 v[208:211], v16 offset:4096
    ds_read_b128 v[212:215], v17 offset:4096
    ds_read_b128 v[216:219], v18 offset:4096
    ds_read_b128 v[220:223], v19 offset:4096
    ds_read_b128 v[224:227], v16 offset:8192
    ds_read_b128 v[228:231], v17 offset:8192
    ds_read_b128 v[232:235], v18 offset:8192
    ds_read_b128 v[236:239], v19 offset:8192
    v_mfma_f32_32x32x16_bf16 v[96:111], v[248:251], a[8:11], v[96:111]
    v_mfma_f32_32x32x16_bf16 v[112:127], v[248:251], a[12:15], v[112:127]
    v_mfma_f32_32x32x16_bf16 v[64:79], v[180:183], a[200:203], v[64:79]
    ds_read_b64_tr_b16 a[192:193], v12 offset:16384
    ds_read_b64_tr_b16 a[194:195], v13 offset:16384
    s_add_u32 s4, s61, 0
    buffer_store_dwordx4 v[240:243], v1, s[28:31], s4 offen offset:1024 sc0 sc1
    v_mfma_f32_32x32x16_bf16 v[80:95], v[180:183], a[204:207], v[80:95]
    ds_read_b64_tr_b16 a[196:197], v12 offset:45056
    ds_read_b64_tr_b16 a[198:199], v13 offset:45056
    ds_read_b64_tr_b16 a[0:1], v20 offset:16384
    ds_read_b64_tr_b16 a[2:3], v20 offset:16640
    ds_read_b64_tr_b16 a[4:5], v20 offset:45056
    ds_read_b64_tr_b16 a[6:7], v20 offset:45312
    s_waitcnt lgkmcnt(15)
    v_mfma_f32_32x32x16_bf16 v[64:79], v[184:187], a[208:211], v[64:79]
    ds_read_b64_tr_b16 a[200:201], v12 offset:17408
    ds_read_b64_tr_b16 a[202:203], v13 offset:17408
    s_add_u32 s4, s57, 0
    buffer_store_dwordx4 v[240:243], v1, s[28:31], s4 offen offset:0 sc0 sc1
    v_mfma_f32_32x32x16_bf16 v[80:95], v[184:187], a[212:215], v[80:95]
    ds_read_b64_tr_b16 a[204:205], v12 offset:46080
    ds_read_b64_tr_b16 a[206:207], v13 offset:46080
    ds_read_b64_tr_b16 a[8:9], v20 offset:17408
    ds_read_b64_tr_b16 a[10:11], v20 offset:17664
    ds_read_b64_tr_b16 a[12:13], v20 offset:46080
    ds_read_b64_tr_b16 a[14:15], v20 offset:46336
    v_mfma_f32_32x32x16_bf16 v[64:79], v[188:191], a[216:219], v[64:79]
    ds_read_b64_tr_b16 a[208:209], v12 offset:18432
    ds_read_b64_tr_b16 a[210:211], v13 offset:18432
    s_add_u32 s4, s57, 8192
    buffer_store_dwordx4 v[240:243], v1, s[28:31], s4 offen offset:0 sc0 sc1
    v_mfma_f32_32x32x16_bf16 v[80:95], v[188:191], a[220:223], v[80:95]
    ds_read_b64_tr_b16 a[212:213], v12 offset:47104
    ds_read_b64_tr_b16 a[214:215], v13 offset:47104
    s_waitcnt lgkmcnt(4)
    v_mfma_f32_32x32x16_bf16 v[96:111], v[248:251], a[0:3], v[96:111]
    v_mfma_f32_32x32x16_bf16 v[112:127], v[248:251], a[4:7], v[112:127]
    v_mfma_f32_32x32x16_bf16 v[96:111], v[248:251], a[8:11], v[96:111]
    v_mfma_f32_32x32x16_bf16 v[112:127], v[248:251], a[12:15], v[112:127]
    ds_read_b64_tr_b16 a[0:1], v21 offset:24576
    ds_read_b64_tr_b16 a[2:3], v21 offset:24832
    ds_read_b64_tr_b16 a[4:5], v21 offset:53248
    ds_read_b64_tr_b16 a[6:7], v21 offset:53504
    s_waitcnt lgkmcnt(0)
    v_mfma_f32_32x32x16_bf16 v[96:111], v[248:251], a[0:3], v[96:111]
    v_mfma_f32_32x32x16_bf16 v[112:127], v[248:251], a[4:7], v[112:127]
    s_nop 11
    v_bfi_b32 v62, v6, v96, v112
    v_lshl_add_u32 v61, v0, 2, s58
    ds_write_b32 v61, v62 offset:15872
    s_waitcnt lgkmcnt(0)
    v_dot2_f32_bf16 v252, v192, v248, v252
    v_dot2_f32_bf16 v254, v192, v192, v254
    v_dot2_f32_bf16 v253, v193, v248, v253
    v_dot2_f32_bf16 v255, v193, v193, v255
    v_dot2_f32_bf16 v252, v194, v248, v252
    v_dot2_f32_bf16 v254, v194, v194, v254
    v_dot2_f32_bf16 v253, v195, v248, v253
    v_dot2_f32_bf16 v255, v195, v195, v255
    v_dot2_f32_bf16 v252, v196, v248, v252
    v_dot2_f32_bf16 v254, v196, v196, v254
    v_dot2_f32_bf16 v253, v197, v248, v253
    v_dot2_f32_bf16 v255, v197, v197, v255
    v_dot2_f32_bf16 v252, v198, v248, v252
    v_dot2_f32_bf16 v254, v198, v198, v254
    s_add_u32 m0, s78, 57344
    s_add_u32 s4, s65, 0
    buffer_load_dwordx4 v9, s[12:15], s4 offen lds
    v_dot2_f32_bf16 v253, v199, v248, v253
    v_dot2_f32_bf16 v255, v199, v199, v255
    v_dot2_f32_bf16 v252, v200, v248, v252
    v_dot2_f32_bf16 v254, v200, v200, v254
    v_dot2_f32_bf16 v253, v201, v248, v253
    v_dot2_f32_bf16 v255, v201, v201, v255
    v_dot2_f32_bf16 v252, v202, v248, v252
    v_dot2_f32_bf16 v254, v202, v202, v254
    v_dot2_f32_bf16 v253, v203, v248, v253
    v_dot2_f32_bf16 v255, v203, v203, v255
    v_dot2_f32_bf16 v252, v204, v248, v252
    v_dot2_f32_bf16 v254, v204, v204, v254
    v_dot2_f32_bf16 v253, v205, v248, v253
    v_dot2_f32_bf16 v255, v205, v205, v255
    s_add_u32 m0, s78, 58368
    s_add_u32 s4, s65, 43008
    buffer_load_dwordx4 v9, s[12:15], s4 offen lds
    v_dot2_f32_bf16 v252, v206, v248, v252
    v_dot2_f32_bf16 v254, v206, v206, v254
    v_dot2_f32_bf16 v253, v207, v248, v253
    v_dot2_f32_bf16 v255, v207, v207, v255
    v_dot2_f32_bf16 v252, v208, v248, v252
    v_dot2_f32_bf16 v254, v208, v208, v254
    v_dot2_f32_bf16 v253, v209, v248, v253
    v_dot2_f32_bf16 v255, v209, v209, v255
    v_dot2_f32_bf16 v252, v210, v248, v252
    v_dot2_f32_bf16 v254, v210, v210, v254
    v_dot2_f32_bf16 v253, v211, v248, v253
    v_dot2_f32_bf16 v255, v211, v211, v255
    v_dot2_f32_bf16 v252, v212, v248, v252
    v_dot2_f32_bf16 v254, v212, v212, v254
    s_add_u32 m0, s78, 65536
    s_add_u32 s4, s65, 344064
    buffer_load_dwordx4 v9, s[12:15], s4 offen lds
    v_dot2_f32_bf16 v253, v213, v248, v253
    v_dot2_f32_bf16 v255, v213, v213, v255
    v_dot2_f32_bf16 v252, v214, v248, v252
    v_dot2_f32_bf16 v254, v214, v214, v254
    v_dot2_f32_bf16 v253, v215, v248, v253
    v_dot2_f32_bf16 v255, v215, v215, v255
    v_dot2_f32_bf16 v252, v216, v248, v252
    v_dot2_f32_bf16 v254, v216, v216, v254
    v_dot2_f32_bf16 v253, v217, v248, v253
    v_dot2_f32_bf16 v255, v217, v217, v255
    v_dot2_f32_bf16 v252, v218, v248, v252
    v_dot2_f32_bf16 v254, v218, v218, v254
    v_dot2_f32_bf16 v253, v219, v248, v253
    v_dot2_f32_bf16 v255, v219, v219, v255
    s_add_u32 m0, s78, 66560
    s_add_u32 s4, s65, 387072
    buffer_load_dwordx4 v9, s[12:15], s4 offen lds
    v_dot2_f32_bf16 v252, v220, v248, v252
    v_dot2_f32_bf16 v254, v220, v220, v254
    v_dot2_f32_bf16 v253, v221, v248, v253
    v_dot2_f32_bf16 v255, v221, v221, v255
    v_dot2_f32_bf16 v252, v222, v248, v252
    v_dot2_f32_bf16 v254, v222, v222, v254
    v_dot2_f32_bf16 v253, v223, v248, v253
    v_dot2_f32_bf16 v255, v223, v223, v255
    v_dot2_f32_bf16 v252, v224, v248, v252
    v_dot2_f32_bf16 v254, v224, v224, v254
    v_dot2_f32_bf16 v253, v225, v248, v253
    v_dot2_f32_bf16 v255, v225, v225, v255
    v_dot2_f32_bf16 v252, v226, v248, v252
    v_dot2_f32_bf16 v254, v226, v226, v254
    s_add_u32 m0, s78, 73728
    s_add_u32 s4, s65, 688128
    buffer_load_dwordx4 v9, s[12:15], s4 offen lds
    v_dot2_f32_bf16 v253, v227, v248, v253
    v_dot2_f32_bf16 v255, v227, v227, v255
    v_dot2_f32_bf16 v252, v228, v248, v252
    v_dot2_f32_bf16 v254, v228, v228, v254
    v_dot2_f32_bf16 v253, v229, v248, v253
    v_dot2_f32_bf16 v255, v229, v229, v255
    v_dot2_f32_bf16 v252, v230, v248, v252
    v_dot2_f32_bf16 v254, v230, v230, v254
    v_dot2_f32_bf16 v253, v231, v248, v253
    v_dot2_f32_bf16 v255, v231, v231, v255
    v_dot2_f32_bf16 v252, v232, v248, v252
    v_dot2_f32_bf16 v254, v232, v232, v254
    v_dot2_f32_bf16 v253, v233, v248, v253
    v_dot2_f32_bf16 v255, v233, v233, v255
    s_add_u32 m0, s78, 74752
    s_add_u32 s4, s65, 731136
    buffer_load_dwordx4 v9, s[12:15], s4 offen lds
    v_dot2_f32_bf16 v252, v234, v248, v252
    v_dot2_f32_bf16 v254, v234, v234, v254
    v_dot2_f32_bf16 v253, v235, v248, v253
    v_dot2_f32_bf16 v255, v235, v235, v255
    v_dot2_f32_bf16 v252, v236, v248, v252
    v_dot2_f32_bf16 v254, v236, v236, v254
    v_dot2_f32_bf16 v253, v237, v248, v253
    v_dot2_f32_bf16 v255, v237, v237, v255
    v_dot2_f32_bf16 v252, v238, v248, v252
    v_dot2_f32_bf16 v254, v238, v238, v254
    v_dot2_f32_bf16 v253, v239, v248, v253
    v_dot2_f32_bf16 v255, v239, v239, v255
    s_barrier
    v_lshlrev_b32 v61, 2, v0
    v_add_u32 v61, 101888, v61
    ds_read_b32 v24, v61 offset:0
    ds_read_b32 v25, v61 offset:16384
    ds_read_b32 v26, v61 offset:32768
    ds_read_b32 v27, v61 offset:49152
    v_add_f32 v62, v252, v253
    v_add_f32 v63, v254, v255
    s_nop 1
    v_permlane32_swap_b32 v62, v63
    v_add_f32 v62, v62, v63
    v_mfma_f32_32x32x16_bf16 v[64:79], v[192:195], a[192:195], v[64:79]
    ds_read_b64_tr_b16 a[216:217], v12 offset:19456
    ds_read_b64_tr_b16 a[218:219], v13 offset:19456
    s_lshl_b32 s3, s48, 10
    s_add_u32 m0, s3, 81920
    s_mul_i32 s3, s48, 43008
    s_sub_u32 s4, s65, s3
    s_add_u32 s4, s4, 1032192
    buffer_load_dwordx4 v9, s[12:15], s4 offen lds
    v_mfma_f32_32x32x16_bf16 v[80:95], v[192:195], a[196:199], v[80:95]
    ds_read_b64_tr_b16 a[220:221], v12 offset:48128
    ds_read_b64_tr_b16 a[222:223], v13 offset:48128
    v_mov_b32 v61, v62
    v_mov_b32 v60, v62
    v_mfma_f32_32x32x16_bf16 v[64:79], v[196:199], a[200:203], v[64:79]
    ds_read_b64_tr_b16 a[192:193], v12 offset:20480
    ds_read_b64_tr_b16 a[194:195], v13 offset:20480
    buffer_load_dwordx2 v[40:41], v246, s[8:11], s60 offen offset:0
    v_mfma_f32_32x32x16_bf16 v[80:95], v[196:199], a[204:207], v[80:95]
    ds_read_b64_tr_b16 a[196:197], v12 offset:49152
    ds_read_b64_tr_b16 a[198:199], v13 offset:49152
    v_permlane32_swap_b32 v60, v61
    v_mul_f32 v60, 0x3b124925, v60
    v_mfma_f32_32x32x16_bf16 v[64:79], v[200:203], a[208:211], v[64:79]
    ds_read_b64_tr_b16 a[200:201], v12 offset:21504
    ds_read_b64_tr_b16 a[202:203], v13 offset:21504
    buffer_load_dwordx2 v[42:43], v246, s[8:11], s60 offen offset:16
    v_mfma_f32_32x32x16_bf16 v[80:95], v[200:203], a[212:215], v[80:95]
    ds_read_b64_tr_b16 a[204:205], v12 offset:50176
    ds_read_b64_tr_b16 a[206:207], v13 offset:50176
    v_mul_f32 v61, 0x3b124925, v61
    v_fma_f32 v61, -v60, v60, v61
    s_waitcnt lgkmcnt(8)
    v_mfma_f32_32x32x16_bf16 v[64:79], v[204:207], a[216:219], v[64:79]
    ds_read_b64_tr_b16 a[208:209], v12 offset:22528
    ds_read_b64_tr_b16 a[210:211], v13 offset:22528
    buffer_load_dwordx2 v[44:45], v246, s[8:11], s60 offen offset:64
    v_mfma_f32_32x32x16_bf16 v[80:95], v[204:207], a[220:223], v[80:95]
    ds_read_b64_tr_b16 a[212:213], v12 offset:51200
    ds_read_b64_tr_b16 a[214:215], v13 offset:51200
    v_max_f32 v61, 0, v61
    v_add_f32 v61, 0x3727c5ac, v61
    s_waitcnt lgkmcnt(8)
    v_mfma_f32_32x32x16_bf16 v[64:79], v[208:211], a[192:195], v[64:79]
    ds_read_b64_tr_b16 a[216:217], v12 offset:23552
    ds_read_b64_tr_b16 a[218:219], v13 offset:23552
    buffer_load_dwordx2 v[46:47], v246, s[8:11], s60 offen offset:80
    v_mfma_f32_32x32x16_bf16 v[80:95], v[208:211], a[196:199], v[80:95]
    ds_read_b64_tr_b16 a[220:221], v12 offset:52224
    ds_read_b64_tr_b16 a[222:223], v13 offset:52224
    v_rsq_f32 v254, v61
    v_lshl_add_u32 v61, v0, 2, s58
    s_waitcnt lgkmcnt(8)
    v_mfma_f32_32x32x16_bf16 v[64:79], v[212:215], a[200:203], v[64:79]
    ds_read_b64_tr_b16 a[192:193], v12 offset:24576
    ds_read_b64_tr_b16 a[194:195], v13 offset:24576
    buffer_load_ushort v7, v247, s[40:43], s77 offen
    v_mfma_f32_32x32x16_bf16 v[80:95], v[212:215], a[204:207], v[80:95]
    ds_read_b64_tr_b16 a[196:197], v12 offset:53248
    ds_read_b64_tr_b16 a[198:199], v13 offset:53248
    v_mul_f32 v255, v60, v254
    v_bfi_b32 v60, v6, v254, v255
    s_waitcnt lgkmcnt(8)
    v_mfma_f32_32x32x16_bf16 v[64:79], v[216:219], a[208:211], v[64:79]
    ds_read_b64_tr_b16 a[200:201], v12 offset:25600
    ds_read_b64_tr_b16 a[202:203], v13 offset:25600
    buffer_load_dword a191, v244, s[36:39], 0 offen
    v_mfma_f32_32x32x16_bf16 v[80:95], v[216:219], a[212:215], v[80:95]
    ds_read_b64_tr_b16 a[204:205], v12 offset:54272
    ds_read_b64_tr_b16 a[206:207], v13 offset:54272
    ds_write_b32 v61, v60 offset:15616
    v_lshrrev_b32 v60, 5, v0
    v_lshl_add_u32 v61, v60, 4, s58
    s_waitcnt lgkmcnt(9)
    v_mfma_f32_32x32x16_bf16 v[64:79], v[220:223], a[216:219], v[64:79]
    ds_read_b64_tr_b16 a[208:209], v12 offset:26624
    ds_read_b64_tr_b16 a[210:211], v13 offset:26624
    s_lshr_b32 s81, s2, 3
    s_lshl_b32 s81, s81, 2
    s_add_u32 s81, s81, s48
    s_mul_i32 s4, s81, 3136
    v_lshlrev_b32 v48, 7, v0
    v_min_u32 v48, 3132, v48
    v_and_b32 v49, 7, v0
    v_min_u32 v49, 6, v49
    v_lshlrev_b32 v49, 7, v49
    v_lshrrev_b32 v51, 3, v0
    v_mul_u32_u24 v51, 3584, v51
    v_add_u32 v49, v49, v51
    v_and_b32 v50, 3, v0
    v_lshlrev_b32 v50, 7, v50
    v_lshrrev_b32 v51, 2, v0
    v_lshl_add_u32 v50, v51, 12, v50
    buffer_load_dword a191, v48, s[16:19], s4 offen
    v_mfma_f32_32x32x16_bf16 v[80:95], v[220:223], a[220:223], v[80:95]
    ds_read_b64_tr_b16 a[212:213], v12 offset:55296
    ds_read_b64_tr_b16 a[214:215], v13 offset:55296
    ds_read_b128 v[96:99], v61 offset:15616
    ds_read_b128 v[100:103], v61 offset:15648
    s_waitcnt lgkmcnt(11)
    v_mfma_f32_32x32x16_bf16 v[64:79], v[224:227], a[192:195], v[64:79]
    ds_read_b64_tr_b16 a[216:217], v12 offset:27648
    ds_read_b64_tr_b16 a[218:219], v13 offset:27648
    s_bfe_u32 s3, s2, 0x20001
    s_mul_i32 s3, s3, 896
    s_lshr_b32 s4, s81, 4
    s_lshl_b32 s4, s4, 4
    s_add_u32 s4, s4, s81
    s_mul_i32 s4, s4, 28672
    s_add_u32 s4, s4, s3
    s_add_u32 s4, s4, 0
    s_and_b32 s3, s2, 1
    s_mul_i32 s3, s3, 458752
    s_add_u32 s4, s4, s3
    buffer_load_dword a191, v49, s[20:23], s4 offen
    v_mfma_f32_32x32x16_bf16 v[80:95], v[224:227], a[196:199], v[80:95]
    ds_read_b64_tr_b16 a[220:221], v12 offset:56320
    ds_read_b64_tr_b16 a[222:223], v13 offset:56320
    ds_read_b128 v[104:107], v61 offset:15680
    ds_read_b128 v[108:111], v61 offset:15712
    ds_read_b128 v[112:115], v61 offset:15744
    ds_read_b128 v[116:119], v61 offset:15776
    s_waitcnt lgkmcnt(15)
    v_mfma_f32_32x32x16_bf16 v[64:79], v[228:231], a[200:203], v[64:79]
    v_mfma_f32_32x32x16_bf16 v[80:95], v[228:231], a[204:207], v[80:95]
    ds_read_b128 v[120:123], v61 offset:15808
    ds_read_b128 v[124:127], v61 offset:15840
    v_add_f32 v24, v24, v25
    s_waitcnt lgkmcnt(12)
    v_mfma_f32_32x32x16_bf16 v[64:79], v[232:235], a[208:211], v[64:79]
    v_mfma_f32_32x32x16_bf16 v[80:95], v[232:235], a[212:215], v[80:95]
    v_add_f32 v26, v26, v27
    v_add_f32 v56, v24, v26
    v_add_f32 v57, v24, v26
    s_nop 1
    v_permlane32_swap_b32 v56, v57
    s_waitcnt lgkmcnt(6)
    v_mfma_f32_32x32x16_bf16 v[64:79], v[236:239], a[216:219], v[64:79]
    v_mfma_f32_32x32x16_bf16 v[80:95], v[236:239], a[220:223], v[80:95]
    v_mov_b32 v8, 0xb5c1a2a0
    v_mov_b32 v9, 0xb5c1a2a0
    v_mov_b32 v10, 0xb58637bd
    v_mov_b32 v11, 0xb58637bd
    s_sub_u32 s3, s48, 1
    s_and_b32 s3, s3, 3
    s_lshl_b32 s3, s3, 10
    s_add_u32 s3, s3, 151552
    v_add_u32 v48, s3, v1
    s_sub_u32 s3, s48, 2
    s_and_b32 s3, s3, 3
    s_lshl_b32 s3, s3, 10
    s_add_u32 s3, s3, 154624
    v_add_u32 v49, s3, v1
    s_sub_u32 s3, s48, 3
    s_and_b32 s3, s3, 3
    s_lshl_b32 s3, s3, 10
    s_add_u32 s3, s3, 157696
    v_add_u32 v50, s3, v1
    s_sub_u32 s3, s48, 4
    s_and_b32 s3, s3, 3
    s_lshl_b32 s3, s3, 10
    s_add_u32 s3, s3, 160768
    v_add_u32 v51, s3, v1
    s_waitcnt lgkmcnt(0)
    v_pk_mul_f32 v[240:241], v[112:113], v[56:57] op_sel:[0,1] op_sel_hi:[1,1]
    v_pk_mul_f32 v[242:243], v[114:115], v[56:57] op_sel:[0,1] op_sel_hi:[1,1]
    v_pk_mul_f32 v[244:245], v[116:117], v[56:57] op_sel:[0,1] op_sel_hi:[1,1]
    v_pk_mul_f32 v[246:247], v[118:119], v[56:57] op_sel:[0,1] op_sel_hi:[1,1]
    v_pk_fma_f32 v[80:81], v[80:81], v[96:97], v[240:241] neg_lo:[0,0,1] neg_hi:[0,0,1]
    v_pk_fma_f32 v[82:83], v[82:83], v[98:99], v[242:243] neg_lo:[0,0,1] neg_hi:[0,0,1]
    v_pk_fma_f32 v[84:85], v[84:85], v[100:101], v[244:245] neg_lo:[0,0,1] neg_hi:[0,0,1]
    v_pk_fma_f32 v[86:87], v[86:87], v[102:103], v[246:247] neg_lo:[0,0,1] neg_hi:[0,0,1]
    v_pk_mul_f32 v[240:241], v[120:121], v[56:57] op_sel:[0,1] op_sel_hi:[1,1]
    v_pk_mul_f32 v[242:243], v[122:123], v[56:57] op_sel:[0,1] op_sel_hi:[1,1]
    v_pk_mul_f32 v[244:245], v[124:125], v[56:57] op_sel:[0,1] op_sel_hi:[1,1]
    v_pk_mul_f32 v[246:247], v[126:127], v[56:57] op_sel:[0,1] op_sel_hi:[1,1]
    v_pk_fma_f32 v[88:89], v[88:89], v[104:105], v[240:241] neg_lo:[0,0,1] neg_hi:[0,0,1]
    v_pk_fma_f32 v[90:91], v[90:91], v[106:107], v[242:243] neg_lo:[0,0,1] neg_hi:[0,0,1]
    v_pk_fma_f32 v[92:93], v[92:93], v[108:109], v[244:245] neg_lo:[0,0,1] neg_hi:[0,0,1]
    v_pk_fma_f32 v[94:95], v[94:95], v[110:111], v[246:247] neg_lo:[0,0,1] neg_hi:[0,0,1]
    v_cvt_pk_bf16_f32 v80, v80, v81
    v_cvt_pk_bf16_f32 v81, v82, v83
    v_cvt_pk_bf16_f32 v82, v84, v85
    v_cvt_pk_bf16_f32 v83, v86, v87
    v_cvt_pk_bf16_f32 v84, v88, v89
    v_cvt_pk_bf16_f32 v85, v90, v91
    v_cvt_pk_bf16_f32 v86, v92, v93
    v_cvt_pk_bf16_f32 v87, v94, v95
    v_and_or_b32 v80, v80, v4, v5
    v_and_or_b32 v81, v81, v4, v5
    v_and_or_b32 v82, v82, v4, v5
    v_and_or_b32 v83, v83, v4, v5
    v_and_or_b32 v84, v84, v4, v5
    v_and_or_b32 v85, v85, v4, v5
    v_and_or_b32 v86, v86, v4, v5
    v_and_or_b32 v87, v87, v4, v5
    v_pk_fma_f32 v[112:113], v[112:113], v[56:57], v[10:11] op_sel_hi:[1,0,1]
    v_pk_fma_f32 v[114:115], v[114:115], v[56:57], v[10:11] op_sel_hi:[1,0,1]
    v_pk_fma_f32 v[116:117], v[116:117], v[56:57], v[10:11] op_sel_hi:[1,0,1]
    v_pk_fma_f32 v[118:119], v[118:119], v[56:57], v[10:11] op_sel_hi:[1,0,1]
    v_pk_fma_f32 v[120:121], v[120:121], v[56:57], v[10:11] op_sel_hi:[1,0,1]
    v_pk_fma_f32 v[122:123], v[122:123], v[56:57], v[10:11] op_sel_hi:[1,0,1]
    v_pk_fma_f32 v[124:125], v[124:125], v[56:57], v[10:11] op_sel_hi:[1,0,1]
    v_pk_fma_f32 v[126:127], v[126:127], v[56:57], v[10:11] op_sel_hi:[1,0,1]
    v_pk_fma_f32 v[64:65], v[64:65], v[96:97], v[112:113] neg_lo:[0,0,1] neg_hi:[0,0,1]
    v_pk_fma_f32 v[66:67], v[66:67], v[98:99], v[114:115] neg_lo:[0,0,1] neg_hi:[0,0,1]
    v_pk_fma_f32 v[68:69], v[68:69], v[100:101], v[116:117] neg_lo:[0,0,1] neg_hi:[0,0,1]
    v_pk_fma_f32 v[70:71], v[70:71], v[102:103], v[118:119] neg_lo:[0,0,1] neg_hi:[0,0,1]
    v_pk_fma_f32 v[72:73], v[72:73], v[104:105], v[120:121] neg_lo:[0,0,1] neg_hi:[0,0,1]
    v_pk_fma_f32 v[74:75], v[74:75], v[106:107], v[122:123] neg_lo:[0,0,1] neg_hi:[0,0,1]
    v_pk_fma_f32 v[76:77], v[76:77], v[108:109], v[124:125] neg_lo:[0,0,1] neg_hi:[0,0,1]
    v_pk_fma_f32 v[78:79], v[78:79], v[110:111], v[126:127] neg_lo:[0,0,1] neg_hi:[0,0,1]
    v_pk_fma_f32 v[112:113], v[64:65], s[66:67], v[8:9]
    v_pk_fma_f32 v[114:115], v[66:67], s[66:67], v[8:9]
    v_pk_fma_f32 v[116:117], v[68:69], s[66:67], v[8:9]
    v_pk_fma_f32 v[118:119], v[70:71], s[66:67], v[8:9]
    v_pk_fma_f32 v[120:121], v[72:73], s[66:67], v[8:9]
    v_pk_fma_f32 v[122:123], v[74:75], s[66:67], v[8:9]
    v_pk_fma_f32 v[124:125], v[76:77], s[66:67], v[8:9]
    v_pk_fma_f32 v[126:127], v[78:79], s[66:67], v[8:9]
    v_exp_f32_e64 v112, v112 clamp
    v_max_f32 v64, 0x358637bd, v64
    v_exp_f32_e64 v113, v113 clamp
    v_max_f32 v65, 0x358637bd, v65
    v_exp_f32_e64 v114, v114 clamp
    v_max_f32 v66, 0x358637bd, v66
    v_exp_f32_e64 v115, v115 clamp
    v_max_f32 v67, 0x358637bd, v67
    v_exp_f32_e64 v116, v116 clamp
    v_max_f32 v68, 0x358637bd, v68
    v_exp_f32_e64 v117, v117 clamp
    v_max_f32 v69, 0x358637bd, v69
    v_exp_f32_e64 v118, v118 clamp
    v_max_f32 v70, 0x358637bd, v70
    v_exp_f32_e64 v119, v119 clamp
    v_max_f32 v71, 0x358637bd, v71
    v_exp_f32_e64 v120, v120 clamp
    v_max_f32 v72, 0x358637bd, v72
    v_exp_f32_e64 v121, v121 clamp
    v_max_f32 v73, 0x358637bd, v73
    v_exp_f32_e64 v122, v122 clamp
    v_max_f32 v74, 0x358637bd, v74
    v_exp_f32_e64 v123, v123 clamp
    v_max_f32 v75, 0x358637bd, v75
    v_exp_f32_e64 v124, v124 clamp
    v_max_f32 v76, 0x358637bd, v76
    v_exp_f32_e64 v125, v125 clamp
    v_max_f32 v77, 0x358637bd, v77
    v_exp_f32_e64 v126, v126 clamp
    v_max_f32 v78, 0x358637bd, v78
    v_exp_f32_e64 v127, v127 clamp
    v_max_f32 v79, 0x358637bd, v79
    v_pk_add_f32 v[64:65], v[64:65], v[112:113]
    v_pk_add_f32 v[66:67], v[66:67], v[114:115]
    v_pk_add_f32 v[68:69], v[68:69], v[116:117]
    v_pk_add_f32 v[70:71], v[70:71], v[118:119]
    v_pk_add_f32 v[72:73], v[72:73], v[120:121]
    v_pk_add_f32 v[74:75], v[74:75], v[122:123]
    v_pk_add_f32 v[76:77], v[76:77], v[124:125]
    v_pk_add_f32 v[78:79], v[78:79], v[126:127]
    v_cvt_pk_bf16_f32 v64, v64, v65
    v_cvt_pk_bf16_f32 v65, v66, v67
    v_cvt_pk_bf16_f32 v66, v68, v69
    v_cvt_pk_bf16_f32 v67, v70, v71
    v_cvt_pk_bf16_f32 v68, v72, v73
    v_cvt_pk_bf16_f32 v69, v74, v75
    v_cvt_pk_bf16_f32 v70, v76, v77
    v_cvt_pk_bf16_f32 v71, v78, v79
    v_and_b32 v64, v4, v64
    v_and_b32 v65, v4, v65
    v_and_b32 v66, v4, v66
    v_and_b32 v67, v4, v67
    v_and_b32 v68, v4, v68
    v_and_b32 v69, v4, v69
    v_and_b32 v70, v4, v70
    v_and_b32 v71, v4, v71
    v_mfma_f32_32x32x16_bf16 v[96:111], v[64:67], v[80:83], 0
    v_mfma_f32_32x32x16_bf16 v[96:111], v[68:71], v[84:87], v[96:111]
    v_add_u32 v60, s59, v1
    s_add_u32 s80, s68, 0
    s_lshl_b32 s3, s49, 11
    s_add_u32 s81, s80, s3
    s_cmp_eq_u32 s48, 0
    s_cselect_b64 exec, 0, -1
    s_nop 5
    ds_write_b128 v48, v[96:99]
    s_cmp_eq_u32 s48, 1
    s_cselect_b64 exec, 0, -1
    ds_write_b128 v49, v[100:103]
    s_cmp_eq_u32 s48, 2
    s_cselect_b64 exec, 0, -1
    ds_write_b128 v50, v[104:107]
    s_cmp_eq_u32 s48, 3
    s_cselect_b64 exec, 0, -1
    ds_write_b128 v51, v[108:111]
    s_mov_b64 exec, -1
OQ3:
    s_cmp_lg_u32 s48, 0
    s_cbranch_scc1 OQ4
    v_pk_mul_f32 v[92:93], v[96:97], s[72:73]
    v_pk_mul_f32 v[94:95], v[98:99], s[72:73]
    s_branch OQ7
OQ4:
    s_cmp_lg_u32 s48, 1
    s_cbranch_scc1 OQ5
    v_pk_mul_f32 v[92:93], v[100:101], s[72:73]
    v_pk_mul_f32 v[94:95], v[102:103], s[72:73]
    s_branch OQ7
OQ5:
    s_cmp_lg_u32 s48, 2
    s_cbranch_scc1 OQ6
    v_pk_mul_f32 v[92:93], v[104:105], s[72:73]
    v_pk_mul_f32 v[94:95], v[106:107], s[72:73]
    s_branch OQ7
OQ6:
    v_pk_mul_f32 v[92:93], v[108:109], s[72:73]
    v_pk_mul_f32 v[94:95], v[110:111], s[72:73]
OQ7:
    s_waitcnt vmcnt(15)
    s_waitcnt vmcnt(8)
    s_waitcnt lgkmcnt(0)
    s_barrier
    ds_read_b128 v[80:83], v60 offset:0
    ds_read_b128 v[84:87], v60 offset:1024
    ds_read_b128 v[88:91], v60 offset:2048
    ds_read_b64_tr_b16 a[240:241], v14 offset:0
    ds_read_b64_tr_b16 a[242:243], v15 offset:0
    ds_read_b64_tr_b16 a[244:245], v14 offset:1024
    ds_read_b64_tr_b16 a[246:247], v15 offset:1024
    ds_read_b64_tr_b16 a[248:249], v14 offset:2048
    ds_read_b64_tr_b16 a[250:251], v15 offset:2048
    ds_read_b64_tr_b16 a[252:253], v14 offset:3072
    ds_read_b64_tr_b16 a[254:255], v15 offset:3072
    ds_read_b64_tr_b16 v[72:73], v14 offset:4096
    ds_read_b64_tr_b16 v[74:75], v15 offset:4096
    s_waitcnt lgkmcnt(10)
    v_pk_add_f32 v[80:81], v[80:81], v[84:85]
    v_pk_add_f32 v[88:89], v[88:89], v[92:93]
    v_pk_add_f32 v[82:83], v[82:83], v[86:87]
    v_pk_add_f32 v[90:91], v[90:91], v[94:95]
    v_pk_add_f32 v[80:81], v[80:81], v[88:89]
    v_pk_add_f32 v[82:83], v[82:83], v[90:91]
    v_cvt_pk_bf16_f32 v80, v80, v81
    v_cvt_pk_bf16_f32 v81, v82, v83
    buffer_store_dwordx2 v[80:81], v2, s[28:31], s81 offen sc0 sc1
    v_lshrrev_b32 v60, 5, v0
    v_lshlrev_b32 v60, 9, v60
    v_add_u32 v88, 256, v3
    v_add_u32 v88, v88, v60
    v_min_u32 v89, 15, v0
    v_lshlrev_b32 v89, 11, v89
    v_add_u32 v89, 508, v89
    v_bfe_u32 v91, v0, 2, 3
    v_mul_u32_u24 v91, 896, v91
    v_lshrrev_b32 v60, 5, v0
    v_lshl_add_u32 v91, v60, 6, v91
    v_and_b32 v60, 3, v0
    s_and_b32 s3, s48, 2
    v_xor_b32 v60, s3, v60
    v_lshl_add_u32 v91, v60, 4, v91
    v_mov_b32 v240, -1
    v_mov_b32 v241, -1
    v_mov_b32 v242, -1
    v_mov_b32 v243, -1
    v_lshlrev_b32 v244, 2, v0
    ds_read_b64_tr_b16 v[76:77], v14 offset:5120
    ds_read_b64_tr_b16 v[78:79], v15 offset:5120
    s_waitcnt lgkmcnt(10)
    v_mfma_f32_32x32x16_bf16 v[112:127], a[240:243], v[128:131], 0
    v_mfma_f32_32x32x16_bf16 v[16:31], a[240:243], v[248:251], 0
    s_add_u32 m0, s58, 0
    s_add_u32 s4, s64, 0
    buffer_load_dwordx4 v91, s[16:19], s4 offen lds
    s_add_u32 m0, s58, 1024
    s_add_u32 s4, s64, 7168
    buffer_load_dwordx4 v91, s[16:19], s4 offen lds
    ds_read_b64_tr_b16 a[240:241], v14 offset:6144
    ds_read_b64_tr_b16 a[242:243], v15 offset:6144
    s_waitcnt lgkmcnt(10)
    v_mfma_f32_32x32x16_bf16 v[112:127], a[244:247], v[132:135], v[112:127]
    v_mfma_f32_32x32x16_bf16 v[16:31], a[244:247], v[248:251], v[16:31]
    s_add_u32 m0, s58, 2048
    s_add_u32 s4, s64, 14336
    buffer_load_dwordx4 v91, s[16:19], s4 offen lds
    s_add_u32 m0, s58, 3072
    s_add_u32 s4, s64, 21504
    buffer_load_dwordx4 v91, s[16:19], s4 offen lds
    ds_read_b64_tr_b16 a[244:245], v14 offset:7168
    ds_read_b64_tr_b16 a[246:247], v15 offset:7168
    s_waitcnt lgkmcnt(10)
    v_mfma_f32_32x32x16_bf16 v[112:127], a[248:251], v[136:139], v[112:127]
    v_mfma_f32_32x32x16_bf16 v[16:31], a[248:251], v[248:251], v[16:31]
    s_add_u32 m0, s58, 4096
    s_add_u32 s4, s64, 28672
    buffer_load_dwordx4 v91, s[16:19], s4 offen lds
    s_add_u32 m0, s58, 5120
    s_add_u32 s4, s64, 35840
    buffer_load_dwordx4 v91, s[16:19], s4 offen lds
    ds_read_b64_tr_b16 a[248:249], v14 offset:8192
    ds_read_b64_tr_b16 a[250:251], v15 offset:8192
    s_waitcnt lgkmcnt(10)
    v_mfma_f32_32x32x16_bf16 v[112:127], a[252:255], v[140:143], v[112:127]
    v_mfma_f32_32x32x16_bf16 v[16:31], a[252:255], v[248:251], v[16:31]
    s_add_u32 m0, s58, 6144
    s_add_u32 s4, s64, 43008
    buffer_load_dwordx4 v91, s[16:19], s4 offen lds
    s_add_u32 m0, s58, 7168
    s_add_u32 s4, s64, 50176
    buffer_load_dwordx4 v91, s[16:19], s4 offen lds
    ds_read_b64_tr_b16 a[252:253], v14 offset:9216
    ds_read_b64_tr_b16 a[254:255], v15 offset:9216
    s_waitcnt lgkmcnt(10)
    v_mfma_f32_32x32x16_bf16 v[112:127], v[72:75], v[144:147], v[112:127]
    v_mfma_f32_32x32x16_bf16 v[16:31], v[72:75], v[248:251], v[16:31]
    s_add_u32 m0, s58, 8192
    s_add_u32 s4, s64, 57344
    buffer_load_dwordx4 v91, s[16:19], s4 offen lds
    s_add_u32 m0, s58, 9216
    s_add_u32 s4, s64, 64512
    buffer_load_dwordx4 v91, s[16:19], s4 offen lds
    ds_read_b64_tr_b16 v[72:73], v14 offset:10240
    ds_read_b64_tr_b16 v[74:75], v15 offset:10240
    s_waitcnt lgkmcnt(10)
    v_mfma_f32_32x32x16_bf16 v[112:127], v[76:79], v[148:151], v[112:127]
    v_mfma_f32_32x32x16_bf16 v[16:31], v[76:79], v[248:251], v[16:31]
    s_add_u32 m0, s58, 10240
    s_add_u32 s4, s64, 71680
    buffer_load_dwordx4 v91, s[16:19], s4 offen lds
    s_add_u32 m0, s58, 11264
    s_add_u32 s4, s64, 78848
    buffer_load_dwordx4 v91, s[16:19], s4 offen lds
    ds_read_b64_tr_b16 v[76:77], v14 offset:11264
    ds_read_b64_tr_b16 v[78:79], v15 offset:11264
    s_waitcnt lgkmcnt(10)
    v_mfma_f32_32x32x16_bf16 v[112:127], a[240:243], v[152:155], v[112:127]
    v_mfma_f32_32x32x16_bf16 v[16:31], a[240:243], v[248:251], v[16:31]
    s_add_u32 m0, s58, 12288
    s_add_u32 s4, s64, 86016
    buffer_load_dwordx4 v91, s[16:19], s4 offen lds
    s_add_u32 m0, s58, 13312
    s_add_u32 s4, s64, 93184
    buffer_load_dwordx4 v91, s[16:19], s4 offen lds
    ds_read_b64_tr_b16 a[240:241], v14 offset:12288
    ds_read_b64_tr_b16 a[242:243], v15 offset:12288
    s_waitcnt lgkmcnt(10)
    v_mfma_f32_32x32x16_bf16 v[112:127], a[244:247], v[156:159], v[112:127]
    v_mfma_f32_32x32x16_bf16 v[16:31], a[244:247], v[248:251], v[16:31]
    s_add_u32 m0, s58, 14336
    s_add_u32 s4, s64, 100352
    buffer_load_dwordx4 v91, s[16:19], s4 offen lds
    s_add_u32 s4, s1, 0
    buffer_store_dwordx4 v[240:243], v1, s[28:31], s4 offen offset:0 sc0 sc1
    ds_read_b64_tr_b16 a[244:245], v14 offset:13312
    ds_read_b64_tr_b16 a[246:247], v15 offset:13312
    s_waitcnt lgkmcnt(10)
    v_mfma_f32_32x32x16_bf16 v[112:127], a[248:251], v[160:163], v[112:127]
    v_mfma_f32_32x32x16_bf16 v[16:31], a[248:251], v[248:251], v[16:31]
    s_add_u32 s4, s1, 114688
    buffer_store_dwordx4 v[240:243], v1, s[28:31], s4 offen offset:0 sc0 sc1
    ds_read_b64_tr_b16 a[248:249], v14 offset:14336
    ds_read_b64_tr_b16 a[250:251], v15 offset:14336
    s_waitcnt lgkmcnt(10)
    v_mfma_f32_32x32x16_bf16 v[112:127], a[252:255], v[164:167], v[112:127]
    v_mfma_f32_32x32x16_bf16 v[16:31], a[252:255], v[248:251], v[16:31]
    s_add_u32 s4, s81, 3145728
    buffer_store_dwordx2 v[240:241], v2, s[28:31], s4 offen offset:0 sc0 sc1
    ds_read_b64_tr_b16 a[252:253], v14 offset:15360
    ds_read_b64_tr_b16 a[254:255], v15 offset:15360
    s_waitcnt lgkmcnt(10)
    v_mfma_f32_32x32x16_bf16 v[112:127], v[72:75], v[168:171], v[112:127]
    v_mfma_f32_32x32x16_bf16 v[16:31], v[72:75], v[248:251], v[16:31]
    s_add_u32 s4, s0, 0
    buffer_store_dwordx4 v[240:243], v1, s[28:31], s4 offen offset:0 sc0 sc1
    v_and_b32 v93, 3, v0
    v_lshlrev_b32 v93, 2, v93
    v_and_b32 v92, 4, v0
    v_lshl_add_u32 v93, v92, 5, v93
    buffer_load_dword v92, v93, s[44:47], 0 offen sc1
    ds_read_b64_tr_b16 v[72:73], v14 offset:16384
    ds_read_b64_tr_b16 v[74:75], v15 offset:16384
    s_waitcnt lgkmcnt(10)
    v_mfma_f32_32x32x16_bf16 v[112:127], v[76:79], v[172:175], v[112:127]
    v_mfma_f32_32x32x16_bf16 v[16:31], v[76:79], v[248:251], v[16:31]
    s_add_u32 s4, s0, 0
    buffer_store_dwordx4 v[240:243], v1, s[28:31], s4 offen offset:2048 sc0 sc1
    ds_read_b64_tr_b16 v[76:77], v14 offset:17408
    ds_read_b64_tr_b16 v[78:79], v15 offset:17408
    s_waitcnt lgkmcnt(10)
    v_mfma_f32_32x32x16_bf16 v[112:127], a[240:243], v[176:179], v[112:127]
    v_mfma_f32_32x32x16_bf16 v[16:31], a[240:243], v[248:251], v[16:31]
    s_add_u32 s4, s74, 458752
    buffer_store_dword v240, v244, s[28:31], s4 offen offset:0 sc0 sc1
    ds_read_b64_tr_b16 a[240:241], v14 offset:18432
    ds_read_b64_tr_b16 a[242:243], v15 offset:18432
    s_waitcnt lgkmcnt(10)
    v_mfma_f32_32x32x16_bf16 v[112:127], a[244:247], v[180:183], v[112:127]
    v_mfma_f32_32x32x16_bf16 v[16:31], a[244:247], v[248:251], v[16:31]
    s_add_u32 s4, s69, 3145728
    buffer_store_dwordx4 v[240:243], v1, s[28:31], s4 offen offset:0 sc0 sc1
    ds_read_b64_tr_b16 a[244:245], v14 offset:19456
    ds_read_b64_tr_b16 a[246:247], v15 offset:19456
    s_waitcnt lgkmcnt(10)
    v_mfma_f32_32x32x16_bf16 v[112:127], a[248:251], v[184:187], v[112:127]
    v_mfma_f32_32x32x16_bf16 v[16:31], a[248:251], v[248:251], v[16:31]
    s_add_u32 s4, s69, 3145728
    buffer_store_dwordx4 v[240:243], v1, s[28:31], s4 offen offset:1024 sc0 sc1
    ds_read_b64_tr_b16 a[248:249], v14 offset:20480
    ds_read_b64_tr_b16 a[250:251], v15 offset:20480
    s_waitcnt lgkmcnt(10)
    v_mfma_f32_32x32x16_bf16 v[112:127], a[252:255], v[188:191], v[112:127]
    v_mfma_f32_32x32x16_bf16 v[16:31], a[252:255], v[248:251], v[16:31]
    s_add_u32 s4, s57, 4194304
    buffer_store_dwordx4 v[240:243], v1, s[28:31], s4 offen offset:0 sc0 sc1
    ds_read_b64_tr_b16 a[252:253], v14 offset:21504
    ds_read_b64_tr_b16 a[254:255], v15 offset:21504
    s_waitcnt lgkmcnt(10)
    v_mfma_f32_32x32x16_bf16 v[112:127], v[72:75], v[192:195], v[112:127]
    v_mfma_f32_32x32x16_bf16 v[16:31], v[72:75], v[248:251], v[16:31]
    s_add_u32 s4, s57, 4202496
    buffer_store_dwordx4 v[240:243], v1, s[28:31], s4 offen offset:0 sc0 sc1
    buffer_load_dword v90, v89, s[28:31], s80 offen sc1
    ds_read_b64_tr_b16 v[72:73], v14 offset:22528
    ds_read_b64_tr_b16 v[74:75], v15 offset:22528
    s_waitcnt lgkmcnt(10)
    v_mfma_f32_32x32x16_bf16 v[112:127], v[76:79], v[196:199], v[112:127]
    v_mfma_f32_32x32x16_bf16 v[16:31], v[76:79], v[248:251], v[16:31]
    s_waitcnt vmcnt(12)
    ds_read_b64_tr_b16 a[128:129], v3 offset:0
    ds_read_b64_tr_b16 a[130:131], v3 offset:1024
    ds_read_b64_tr_b16 a[132:133], v3 offset:512
    ds_read_b64_tr_b16 v[76:77], v14 offset:23552
    ds_read_b64_tr_b16 v[78:79], v15 offset:23552
    s_waitcnt lgkmcnt(13)
    v_mfma_f32_32x32x16_bf16 v[112:127], a[240:243], v[200:203], v[112:127]
    v_mfma_f32_32x32x16_bf16 v[16:31], a[240:243], v[248:251], v[16:31]
    ds_read_b64_tr_b16 a[134:135], v3 offset:1536
    ds_read_b64_tr_b16 a[136:137], v3 offset:2048
    ds_read_b64_tr_b16 a[138:139], v3 offset:3072
    ds_read_b64_tr_b16 a[140:141], v3 offset:2560
    ds_read_b64_tr_b16 a[240:241], v14 offset:24576
    ds_read_b64_tr_b16 a[242:243], v15 offset:24576
    s_waitcnt lgkmcnt(15)
    v_mfma_f32_32x32x16_bf16 v[112:127], a[244:247], v[204:207], v[112:127]
    v_mfma_f32_32x32x16_bf16 v[16:31], a[244:247], v[248:251], v[16:31]
    ds_read_b64_tr_b16 a[142:143], v3 offset:3584
    ds_read_b64_tr_b16 a[144:145], v88 offset:3072
    ds_read_b64_tr_b16 a[146:147], v88 offset:4096
    ds_read_b64_tr_b16 a[148:149], v88 offset:3584
    ds_read_b64_tr_b16 a[244:245], v14 offset:25600
    ds_read_b64_tr_b16 a[246:247], v15 offset:25600
    v_mfma_f32_32x32x16_bf16 v[112:127], a[248:251], v[208:211], v[112:127]
    v_mfma_f32_32x32x16_bf16 v[16:31], a[248:251], v[248:251], v[16:31]
    ds_read_b64_tr_b16 a[150:151], v88 offset:4608
    ds_read_b64_tr_b16 a[152:153], v88 offset:5120
    ds_read_b64_tr_b16 a[154:155], v88 offset:6144
    ds_read_b64_tr_b16 a[156:157], v88 offset:5632
    ds_read_b64_tr_b16 a[248:249], v14 offset:26624
    ds_read_b64_tr_b16 a[250:251], v15 offset:26624
    s_waitcnt lgkmcnt(15)
    v_mfma_f32_32x32x16_bf16 v[112:127], a[252:255], v[212:215], v[112:127]
    v_mfma_f32_32x32x16_bf16 v[16:31], a[252:255], v[248:251], v[16:31]
    ds_read_b64_tr_b16 a[158:159], v88 offset:6656
    ds_read_b64_tr_b16 a[160:161], v3 offset:7168
    ds_read_b64_tr_b16 a[162:163], v3 offset:8192
    ds_read_b64_tr_b16 a[164:165], v3 offset:7680
    ds_read_b64_tr_b16 a[252:253], v14 offset:27648
    ds_read_b64_tr_b16 a[254:255], v15 offset:27648
    v_mfma_f32_32x32x16_bf16 v[112:127], v[72:75], v[216:219], v[112:127]
    v_mfma_f32_32x32x16_bf16 v[16:31], v[72:75], v[248:251], v[16:31]
    ds_read_b64_tr_b16 a[166:167], v3 offset:8704
    ds_read_b64_tr_b16 a[168:169], v3 offset:9216
    ds_read_b64_tr_b16 a[170:171], v3 offset:10240
    ds_read_b64_tr_b16 a[172:173], v3 offset:9728
    v_mfma_f32_32x32x16_bf16 v[112:127], v[76:79], v[220:223], v[112:127]
    v_mfma_f32_32x32x16_bf16 v[16:31], v[76:79], v[248:251], v[16:31]
    ds_read_b64_tr_b16 a[174:175], v3 offset:10752
    ds_read_b64_tr_b16 a[176:177], v88 offset:10240
    ds_read_b64_tr_b16 a[178:179], v88 offset:11264
    ds_read_b64_tr_b16 a[180:181], v88 offset:10752
    s_waitcnt lgkmcnt(15)
    v_mfma_f32_32x32x16_bf16 v[112:127], a[240:243], v[224:227], v[112:127]
    v_mfma_f32_32x32x16_bf16 v[16:31], a[240:243], v[248:251], v[16:31]
    ds_read_b64_tr_b16 a[182:183], v88 offset:11776
    ds_read_b64_tr_b16 a[184:185], v88 offset:12288
    ds_read_b64_tr_b16 a[186:187], v88 offset:13312
    ds_read_b64_tr_b16 a[188:189], v88 offset:12800
    v_mfma_f32_32x32x16_bf16 v[112:127], a[244:247], v[228:231], v[112:127]
    v_mfma_f32_32x32x16_bf16 v[16:31], a[244:247], v[248:251], v[16:31]
    ds_read_b64_tr_b16 a[190:191], v88 offset:13824
    s_waitcnt lgkmcnt(15)
    v_mfma_f32_32x32x16_bf16 v[112:127], a[248:251], v[232:235], v[112:127]
    v_mfma_f32_32x32x16_bf16 v[16:31], a[248:251], v[248:251], v[16:31]
    s_waitcnt lgkmcnt(13)
    v_mfma_f32_32x32x16_bf16 v[112:127], a[252:255], v[236:239], v[112:127]
    v_mfma_f32_32x32x16_bf16 v[16:31], a[252:255], v[248:251], v[16:31]
    s_waitcnt vmcnt(7)
    v_and_b32 v62, 32, v92
    v_cmp_eq_u32 vcc, 0, v62
    s_cbranch_vccz IK9
IB8:
    s_sleep 2
    buffer_load_dword v92, v93, s[44:47], 0 offen sc1
    s_add_u32 s56, s56, 8
    s_waitcnt vmcnt(0)
    v_and_b32 v62, 32, v92
    v_cmp_eq_u32 vcc, 0, v62
    s_cbranch_vccz IG10
    s_cmp_gt_u32 s56, 200000
    s_cbranch_scc0 IB8
IG10:
    v_mov_b32 v90, -1
IK9:
    s_and_b32 s3, s2, 7
    v_readlane_b32 s76, v92, s3
    s_lshl_b32 s79, s79, 5
    s_nop 0
    s_cmp_eq_u32 s79, s76
    s_cselect_b32 s79, 1, 0
    s_waitcnt vmcnt(0)
PS11:
    v_cmp_eq_u32 vcc, -1, v90
    s_cbranch_vccz PK12
    buffer_load_dword v90, v89, s[28:31], s80 offen sc1
    s_add_u32 s56, s56, 1
    s_cmp_gt_u32 s56, 200000
    s_waitcnt vmcnt(0)
    s_cbranch_scc0 PS11
PK12:
    s_add_u32 s76, s80, 0
    buffer_load_dwordx2 v[128:129], v2, s[28:31], s76 offen offset:0 sc1
    buffer_load_dwordx2 v[130:131], v2, s[28:31], s76 offen offset:2048 sc1
    s_add_u32 s76, s80, 4096
    buffer_load_dwordx2 v[132:133], v2, s[28:31], s76 offen offset:0 sc1
    buffer_load_dwordx2 v[134:135], v2, s[28:31], s76 offen offset:2048 sc1
    v_pk_fma_f32 v[96:97], v[16:17], v[254:255], v[10:11] op_sel:[0,1,0] op_sel_hi:[1,1,1]
    v_pk_fma_f32 v[98:99], v[18:19], v[254:255], v[10:11] op_sel:[0,1,0] op_sel_hi:[1,1,1]
    v_pk_fma_f32 v[100:101], v[20:21], v[254:255], v[10:11] op_sel:[0,1,0] op_sel_hi:[1,1,1]
    v_pk_fma_f32 v[102:103], v[22:23], v[254:255], v[10:11] op_sel:[0,1,0] op_sel_hi:[1,1,1]
    v_pk_fma_f32 v[104:105], v[24:25], v[254:255], v[10:11] op_sel:[0,1,0] op_sel_hi:[1,1,1]
    v_pk_fma_f32 v[106:107], v[26:27], v[254:255], v[10:11] op_sel:[0,1,0] op_sel_hi:[1,1,1]
    s_add_u32 s76, s80, 8192
    buffer_load_dwordx2 v[136:137], v2, s[28:31], s76 offen offset:0 sc1
    v_pk_fma_f32 v[108:109], v[28:29], v[254:255], v[10:11] op_sel:[0,1,0] op_sel_hi:[1,1,1]
    v_pk_fma_f32 v[110:111], v[30:31], v[254:255], v[10:11] op_sel:[0,1,0] op_sel_hi:[1,1,1]
    v_pk_fma_f32 v[112:113], v[112:113], v[254:255], v[96:97] op_sel_hi:[1,0,1] neg_lo:[0,0,1] neg_hi:[0,0,1]
    v_pk_fma_f32 v[114:115], v[114:115], v[254:255], v[98:99] op_sel_hi:[1,0,1] neg_lo:[0,0,1] neg_hi:[0,0,1]
    v_pk_fma_f32 v[116:117], v[116:117], v[254:255], v[100:101] op_sel_hi:[1,0,1] neg_lo:[0,0,1] neg_hi:[0,0,1]
    v_pk_fma_f32 v[118:119], v[118:119], v[254:255], v[102:103] op_sel_hi:[1,0,1] neg_lo:[0,0,1] neg_hi:[0,0,1]
    buffer_load_dwordx2 v[138:139], v2, s[28:31], s76 offen offset:2048 sc1
    v_pk_fma_f32 v[120:121], v[120:121], v[254:255], v[104:105] op_sel_hi:[1,0,1] neg_lo:[0,0,1] neg_hi:[0,0,1]
    v_pk_fma_f32 v[122:123], v[122:123], v[254:255], v[106:107] op_sel_hi:[1,0,1] neg_lo:[0,0,1] neg_hi:[0,0,1]
    v_pk_fma_f32 v[124:125], v[124:125], v[254:255], v[108:109] op_sel_hi:[1,0,1] neg_lo:[0,0,1] neg_hi:[0,0,1]
    v_pk_fma_f32 v[126:127], v[126:127], v[254:255], v[110:111] op_sel_hi:[1,0,1] neg_lo:[0,0,1] neg_hi:[0,0,1]
    v_pk_fma_f32 v[96:97], v[112:113], s[66:67], v[8:9]
    v_pk_fma_f32 v[98:99], v[114:115], s[66:67], v[8:9]
    s_add_u32 s76, s80, 12288
    buffer_load_dwordx2 v[140:141], v2, s[28:31], s76 offen offset:0 sc1
    v_pk_fma_f32 v[100:101], v[116:117], s[66:67], v[8:9]
    v_pk_fma_f32 v[102:103], v[118:119], s[66:67], v[8:9]
    v_pk_fma_f32 v[104:105], v[120:121], s[66:67], v[8:9]
    v_pk_fma_f32 v[106:107], v[122:123], s[66:67], v[8:9]
    v_pk_fma_f32 v[108:109], v[124:125], s[66:67], v[8:9]
    v_pk_fma_f32 v[110:111], v[126:127], s[66:67], v[8:9]
    buffer_load_dwordx2 v[142:143], v2, s[28:31], s76 offen offset:2048 sc1
    v_exp_f32_e64 v96, v96 clamp
    v_max_f32 v112, 0x358637bd, v112
    v_exp_f32_e64 v97, v97 clamp
    v_max_f32 v113, 0x358637bd, v113
    v_exp_f32_e64 v98, v98 clamp
    v_max_f32 v114, 0x358637bd, v114
    s_add_u32 s76, s80, 16384
    buffer_load_dwordx2 v[144:145], v2, s[28:31], s76 offen offset:0 sc1
    v_exp_f32_e64 v99, v99 clamp
    v_max_f32 v115, 0x358637bd, v115
    v_exp_f32_e64 v100, v100 clamp
    v_max_f32 v116, 0x358637bd, v116
    v_exp_f32_e64 v101, v101 clamp
    v_max_f32 v117, 0x358637bd, v117
    buffer_load_dwordx2 v[146:147], v2, s[28:31], s76 offen offset:2048 sc1
    v_exp_f32_e64 v102, v102 clamp
    v_max_f32 v118, 0x358637bd, v118
    v_exp_f32_e64 v103, v103 clamp
    v_max_f32 v119, 0x358637bd, v119
    v_exp_f32_e64 v104, v104 clamp
    v_max_f32 v120, 0x358637bd, v120
    s_add_u32 s76, s80, 20480
    buffer_load_dwordx2 v[148:149], v2, s[28:31], s76 offen offset:0 sc1
    v_exp_f32_e64 v105, v105 clamp
    v_max_f32 v121, 0x358637bd, v121
    v_exp_f32_e64 v106, v106 clamp
    v_max_f32 v122, 0x358637bd, v122
    v_exp_f32_e64 v107, v107 clamp
    v_max_f32 v123, 0x358637bd, v123
    buffer_load_dwordx2 v[150:151], v2, s[28:31], s76 offen offset:2048 sc1
    v_exp_f32_e64 v108, v108 clamp
    v_max_f32 v124, 0x358637bd, v124
    v_exp_f32_e64 v109, v109 clamp
    v_max_f32 v125, 0x358637bd, v125
    v_exp_f32_e64 v110, v110 clamp
    v_max_f32 v126, 0x358637bd, v126
    s_add_u32 s76, s80, 24576
    buffer_load_dwordx2 v[152:153], v2, s[28:31], s76 offen offset:0 sc1
    v_exp_f32_e64 v111, v111 clamp
    v_max_f32 v127, 0x358637bd, v127
    v_pk_add_f32 v[112:113], v[112:113], v[96:97]
    v_pk_add_f32 v[114:115], v[114:115], v[98:99]
    v_pk_add_f32 v[116:117], v[116:117], v[100:101]
    v_pk_add_f32 v[118:119], v[118:119], v[102:103]
    buffer_load_dwordx2 v[154:155], v2, s[28:31], s76 offen offset:2048 sc1
    v_pk_add_f32 v[120:121], v[120:121], v[104:105]
    v_pk_add_f32 v[122:123], v[122:123], v[106:107]
    v_pk_add_f32 v[124:125], v[124:125], v[108:109]
    v_pk_add_f32 v[126:127], v[126:127], v[110:111]
    v_cvt_pk_bf16_f32 v48, v112, v113
    v_cvt_pk_bf16_f32 v49, v114, v115
    s_add_u32 s76, s80, 28672
    buffer_load_dwordx2 v[156:157], v2, s[28:31], s76 offen offset:0 sc1
    v_cvt_pk_bf16_f32 v50, v116, v117
    v_cvt_pk_bf16_f32 v51, v118, v119
    v_cvt_pk_bf16_f32 v52, v120, v121
    v_cvt_pk_bf16_f32 v53, v122, v123
    v_cvt_pk_bf16_f32 v54, v124, v125
    v_cvt_pk_bf16_f32 v55, v126, v127
    buffer_load_dwordx2 v[158:159], v2, s[28:31], s76 offen offset:2048 sc1
    v_and_b32 v54, v6, v54
    v_and_b32 v55, v6, v55
    s_waitcnt lgkmcnt(0)
    s_add_u32 m0, s58, 0
    s_add_u32 s4, s62, 0
    buffer_load_dwordx4 v58, s[20:23], s4 offen lds
    s_add_u32 m0, s58, 1024
    s_add_u32 s4, s62, 28672
    buffer_load_dwordx4 v58, s[20:23], s4 offen lds
    s_add_u32 m0, s58, 2048
    s_add_u32 s4, s62, 57344
    buffer_load_dwordx4 v58, s[20:23], s4 offen lds
    s_add_u32 m0, s58, 3072
    s_add_u32 s4, s62, 86016
    buffer_load_dwordx4 v58, s[20:23], s4 offen lds
    s_add_u32 m0, s58, 4096
    s_add_u32 s4, s62, 114688
    buffer_load_dwordx4 v58, s[20:23], s4 offen lds
    s_add_u32 m0, s58, 5120
    s_add_u32 s4, s62, 143360
    buffer_load_dwordx4 v58, s[20:23], s4 offen lds
    s_add_u32 m0, s58, 6144
    s_add_u32 s4, s62, 172032
    buffer_load_dwordx4 v58, s[20:23], s4 offen lds
    s_add_u32 m0, s58, 7168
    s_add_u32 s4, s62, 200704
    buffer_load_dwordx4 v58, s[20:23], s4 offen lds
    s_add_u32 m0, s58, 8192
    s_add_u32 s4, s62, 229376
    buffer_load_dwordx4 v58, s[20:23], s4 offen lds
    s_add_u32 m0, s58, 9216
    s_add_u32 s4, s62, 258048
    buffer_load_dwordx4 v58, s[20:23], s4 offen lds
    v_lshlrev_b32 v32, 16, v40
    v_and_b32 v33, 0xffff0000, v40
    v_lshlrev_b32 v34, 16, v41
    v_and_b32 v35, 0xffff0000, v41
    v_lshlrev_b32 v36, 16, v42
    v_and_b32 v37, 0xffff0000, v42
    v_lshlrev_b32 v38, 16, v43
    v_and_b32 v39, 0xffff0000, v43
    v_lshlrev_b32 v40, 16, v44
    v_and_b32 v41, 0xffff0000, v44
    v_lshlrev_b32 v42, 16, v45
    v_and_b32 v43, 0xffff0000, v45
    v_lshlrev_b32 v44, 16, v46
    v_and_b32 v45, 0xffff0000, v46
    v_lshlrev_b32 v60, 16, v47
    v_and_b32 v47, 0xffff0000, v47
    v_mov_b32 v46, v60
    v_lshlrev_b32 v7, 16, v7
    v_mov_b32 v168, 0x3f80
    v_mov_b32 v169, 0x3f800000
SU13:
    s_waitcnt vmcnt(22)
    v_dot2_f32_bf16 v160, v128, v168, 0
    v_dot2_f32_bf16 v161, v128, v169, 0
    v_dot2_f32_bf16 v162, v129, v168, 0
    v_dot2_f32_bf16 v163, v129, v169, 0
    v_dot2_f32_bf16 v164, v130, v168, 0
    v_dot2_f32_bf16 v165, v130, v169, 0
    v_dot2_f32_bf16 v166, v131, v168, 0
    v_dot2_f32_bf16 v167, v131, v169, 0
    v_dot2_f32_bf16 v160, v132, v168, v160
    v_dot2_f32_bf16 v161, v132, v169, v161
    v_dot2_f32_bf16 v162, v133, v168, v162
    v_dot2_f32_bf16 v163, v133, v169, v163
    v_dot2_f32_bf16 v164, v134, v168, v164
    v_dot2_f32_bf16 v165, v134, v169, v165
    v_dot2_f32_bf16 v166, v135, v168, v166
    v_dot2_f32_bf16 v167, v135, v169, v167
    v_max3_u32 v63, v129, v131, v133
    v_max_u32 v63, v63, v135
    s_waitcnt vmcnt(18)
    v_dot2_f32_bf16 v160, v136, v168, v160
    v_dot2_f32_bf16 v161, v136, v169, v161
    v_dot2_f32_bf16 v162, v137, v168, v162
    v_dot2_f32_bf16 v163, v137, v169, v163
    v_dot2_f32_bf16 v164, v138, v168, v164
    v_dot2_f32_bf16 v165, v138, v169, v165
    v_dot2_f32_bf16 v166, v139, v168, v166
    v_dot2_f32_bf16 v167, v139, v169, v167
    v_dot2_f32_bf16 v160, v140, v168, v160
    v_dot2_f32_bf16 v161, v140, v169, v161
    v_dot2_f32_bf16 v162, v141, v168, v162
    v_dot2_f32_bf16 v163, v141, v169, v163
    v_dot2_f32_bf16 v164, v142, v168, v164
    v_dot2_f32_bf16 v165, v142, v169, v165
    v_dot2_f32_bf16 v166, v143, v168, v166
    v_dot2_f32_bf16 v167, v143, v169, v167
    v_max3_u32 v63, v63, v137, v139
    v_max3_u32 v63, v63, v141, v143
    s_waitcnt vmcnt(14)
    v_dot2_f32_bf16 v160, v144, v168, v160
    v_dot2_f32_bf16 v161, v144, v169, v161
    v_dot2_f32_bf16 v162, v145, v168, v162
    v_dot2_f32_bf16 v163, v145, v169, v163
    v_dot2_f32_bf16 v164, v146, v168, v164
    v_dot2_f32_bf16 v165, v146, v169, v165
    v_dot2_f32_bf16 v166, v147, v168, v166
    v_dot2_f32_bf16 v167, v147, v169, v167
    v_dot2_f32_bf16 v160, v148, v168, v160
    v_dot2_f32_bf16 v161, v148, v169, v161
    v_dot2_f32_bf16 v162, v149, v168, v162
    v_dot2_f32_bf16 v163, v149, v169, v163
    v_dot2_f32_bf16 v164, v150, v168, v164
    v_dot2_f32_bf16 v165, v150, v169, v165
    v_dot2_f32_bf16 v166, v151, v168, v166
    v_dot2_f32_bf16 v167, v151, v169, v167
    v_max3_u32 v63, v63, v145, v147
    v_max3_u32 v63, v63, v149, v151
    s_waitcnt vmcnt(10)
    v_dot2_f32_bf16 v160, v152, v168, v160
    v_dot2_f32_bf16 v161, v152, v169, v161
    v_dot2_f32_bf16 v162, v153, v168, v162
    v_dot2_f32_bf16 v163, v153, v169, v163
    v_dot2_f32_bf16 v164, v154, v168, v164
    v_dot2_f32_bf16 v165, v154, v169, v165
    v_dot2_f32_bf16 v166, v155, v168, v166
    v_dot2_f32_bf16 v167, v155, v169, v167
    v_dot2_f32_bf16 v160, v156, v168, v160
    v_dot2_f32_bf16 v161, v156, v169, v161
    v_dot2_f32_bf16 v162, v157, v168, v162
    v_dot2_f32_bf16 v163, v157, v169, v163
    v_dot2_f32_bf16 v164, v158, v168, v164
    v_dot2_f32_bf16 v165, v158, v169, v165
    v_dot2_f32_bf16 v166, v159, v168, v166
    v_dot2_f32_bf16 v167, v159, v169, v167
    v_max3_u32 v63, v63, v153, v155
    v_max3_u32 v63, v63, v157, v159
    v_cmp_eq_u32 vcc, -1, v63
    s_cbranch_vccnz SR14
SR14x:
    s_add_u32 m0, s58, 10240
    s_add_u32 s4, s62, 286720
    buffer_load_dwordx4 v58, s[20:23], s4 offen lds
    s_add_u32 m0, s58, 11264
    s_add_u32 s4, s62, 315392
    buffer_load_dwordx4 v58, s[20:23], s4 offen lds
    s_add_u32 m0, s58, 12288
    s_add_u32 s4, s62, 344064
    buffer_load_dwordx4 v58, s[20:23], s4 offen lds
    s_add_u32 m0, s58, 13312
    s_add_u32 s4, s62, 372736
    buffer_load_dwordx4 v58, s[20:23], s4 offen lds
    s_add_u32 m0, s58, 14336
    s_add_u32 s4, s62, 401408
    buffer_load_dwordx4 v58, s[20:23], s4 offen lds
    s_add_u32 m0, s58, 15360
    s_add_u32 s4, s62, 430080
    buffer_load_dwordx4 v58, s[20:23], s4 offen lds
    v_pk_add_f32 v[160:161], v[160:161], v[164:165]
    v_pk_add_f32 v[162:163], v[162:163], v[166:167]
    v_cvt_pk_bf16_f32 v128, v160, v161
    v_cvt_pk_bf16_f32 v129, v162, v163
    v_lshl_add_u32 v60, v0, 3, s59
    v_lshlrev_b32 v61, 3, v0
    v_add_u32 v61, 151552, v61
    ds_write_b64 v60, v[128:129]
    s_add_u32 s81, s69, 0
    s_waitcnt lgkmcnt(0)
    s_barrier
    ds_read_b64 v[136:137], v61 offset:0
    ds_read_b64 v[138:139], v61 offset:3072
    ds_read_b64 v[140:141], v61 offset:6144
    ds_read_b64 v[142:143], v61 offset:9216
    s_xor_b32 s3, s48, 1
    s_lshl_b32 s3, s3, 14
    s_add_u32 s3, s3, 86016
    v_add_u32 v10, s3, v1
    s_xor_b32 s3, s48, 2
    s_lshl_b32 s3, s3, 14
    s_add_u32 s3, s3, 88064
    v_add_u32 v11, s3, v1
    s_xor_b32 s3, s48, 3
    s_lshl_b32 s3, s3, 14
    s_add_u32 s3, s3, 90112
    v_add_u32 v12, s3, v1
    s_waitcnt lgkmcnt(0)
    v_mfma_f32_32x32x16_bf16 v[64:79], v[136:139], v[48:51], 0
    v_mfma_f32_32x32x16_bf16 v[64:79], v[140:143], v[52:55], v[64:79]
    v_add_u32 v13, s58, v1
    s_lshl_b32 s80, s51, 16
    s_add_u32 s80, s80, 1048576
    s_lshl_b32 s3, s48, 13
    s_add_u32 s80, s80, s3
    s_and_b32 s3, s48, 1
    s_lshl_b32 s3, s3, 15
    s_add_u32 s6, s80, s3
    s_xor_b32 s3, s3, 32768
    s_add_u32 s7, s80, s3
    v_and_b32 v14, 3, v0
    v_lshlrev_b32 v14, 11, v14
    v_bfe_u32 v61, v0, 2, 1
    v_lshl_add_u32 v14, v61, 15, v14
    v_add_u32 v14, 2044, v14
    s_lshr_b32 s3, s48, 1
    s_lshl_b32 s3, s3, 8
    v_xor_b32 v8, s3, v1
    v_mov_b32 v60, v76
    v_mov_b32 v61, v76
    s_nop 1
    v_permlane32_swap_b32 v60, v61
    v_add_f32 v61, 0x358637bd, v61
    v_rcp_f32 v60, v61
    s_nop 0
    v_pk_mul_f32 v[64:65], v[64:65], v[60:61] op_sel_hi:[1,0]
    v_pk_mul_f32 v[66:67], v[66:67], v[60:61] op_sel_hi:[1,0]
    v_pk_mul_f32 v[68:69], v[68:69], v[60:61] op_sel_hi:[1,0]
    v_pk_mul_f32 v[70:71], v[70:71], v[60:61] op_sel_hi:[1,0]
    v_pk_mul_f32 v[72:73], v[72:73], v[60:61] op_sel_hi:[1,0]
    v_pk_mul_f32 v[74:75], v[74:75], v[60:61] op_sel_hi:[1,0]
    v_pk_mul_f32 v[76:77], v[76:77], v[60:61] op_sel_hi:[1,0]
    v_pk_mul_f32 v[78:79], v[78:79], v[60:61] op_sel_hi:[1,0]
    v_cvt_pk_bf16_f32 v48, v64, v65
    v_cvt_pk_bf16_f32 v49, v66, v67
    v_cvt_pk_bf16_f32 v50, v68, v69
    v_cvt_pk_bf16_f32 v51, v70, v71
    v_cvt_pk_bf16_f32 v52, v72, v73
    v_cvt_pk_bf16_f32 v53, v74, v75
    v_cvt_pk_bf16_f32 v54, v76, v77
    v_cvt_pk_bf16_f32 v55, v78, v79
    v_and_b32 v54, v6, v54
    v_and_b32 v55, v6, v55
    s_cmp_lg_u32 s79, 1
    s_cbranch_scc1 PL15
    buffer_store_dwordx4 v[48:51], v1, s[28:31], s81 offen
    buffer_store_dwordx4 v[52:55], v1, s[28:31], s81 offen offset:1024
PE16:
    s_cmp_eq_u32 s55, 0
    s_cbranch_scc1 L_side0
    s_waitcnt vmcnt(10)
    ds_read_b64_tr_b16 a[0:1], v3 offset:0
    ds_read_b64_tr_b16 a[2:3], v3 offset:1024
    ds_read_b64_tr_b16 a[4:5], v3 offset:512
    ds_read_b64_tr_b16 a[6:7], v3 offset:1536
    ds_read_b64_tr_b16 a[8:9], v3 offset:2048
    ds_read_b64_tr_b16 a[10:11], v3 offset:3072
    ds_read_b64_tr_b16 a[12:13], v3 offset:2560
    ds_read_b64_tr_b16 a[14:15], v3 offset:3584
    ds_read_b64_tr_b16 a[16:17], v3 offset:4096
    ds_read_b64_tr_b16 a[18:19], v3 offset:5120
    ds_read_b64_tr_b16 a[20:21], v3 offset:4608
    ds_read_b64_tr_b16 a[22:23], v3 offset:5632
    ds_read_b64_tr_b16 a[24:25], v3 offset:6144
    ds_read_b64_tr_b16 a[26:27], v3 offset:7168
    ds_read_b64_tr_b16 a[28:29], v3 offset:6656
    ds_read_b64_tr_b16 a[30:31], v3 offset:7680
    buffer_load_dword v62, v14, s[28:31], s80 offen sc1
    s_waitcnt vmcnt(0)
PS17:
    v_cmp_eq_u32 vcc, -1, v62
    s_cbranch_vccz PK18
    buffer_load_dword v62, v14, s[28:31], s80 offen sc1
    s_add_u32 s56, s56, 1
    s_cmp_gt_u32 s56, 200000
    s_waitcnt vmcnt(0)
    s_cbranch_scc0 PS17
PK18:
    s_add_u32 s76, s7, 0
    buffer_load_dwordx4 v[160:163], v1, s[28:31], s76 offen offset:0 sc1
    buffer_load_dwordx4 v[164:167], v1, s[28:31], s76 offen offset:1024 sc1
    buffer_load_dwordx4 v[168:171], v1, s[28:31], s76 offen offset:2048 sc1
    buffer_load_dwordx4 v[172:175], v1, s[28:31], s76 offen offset:3072 sc1
    s_add_u32 s76, s7, 4096
    buffer_load_dwordx4 v[176:179], v1, s[28:31], s76 offen offset:0 sc1
    buffer_load_dwordx4 v[180:183], v1, s[28:31], s76 offen offset:1024 sc1
    buffer_load_dwordx4 v[184:187], v1, s[28:31], s76 offen offset:2048 sc1
    buffer_load_dwordx4 v[188:191], v1, s[28:31], s76 offen offset:3072 sc1
    s_add_u32 s76, s6, 0
    buffer_load_dwordx4 v[128:131], v1, s[28:31], s76 offen offset:0 sc1
    buffer_load_dwordx4 v[132:135], v1, s[28:31], s76 offen offset:1024 sc1
    buffer_load_dwordx4 v[136:139], v1, s[28:31], s76 offen offset:2048 sc1
    buffer_load_dwordx4 v[140:143], v1, s[28:31], s76 offen offset:3072 sc1
    s_add_u32 s76, s6, 4096
    buffer_load_dwordx4 v[144:147], v1, s[28:31], s76 offen offset:0 sc1
    buffer_load_dwordx4 v[148:151], v1, s[28:31], s76 offen offset:1024 sc1
    buffer_load_dwordx4 v[152:155], v1, s[28:31], s76 offen offset:2048 sc1
    buffer_load_dwordx4 v[156:159], v1, s[28:31], s76 offen offset:3072 sc1
    ds_read_b64_tr_b16 a[32:33], v3 offset:8192
    ds_read_b64_tr_b16 a[34:35], v3 offset:9216
    ds_read_b64_tr_b16 a[36:37], v3 offset:8704
    ds_read_b64_tr_b16 a[38:39], v3 offset:9728
    ds_read_b64_tr_b16 a[40:41], v3 offset:10240
    ds_read_b64_tr_b16 a[42:43], v3 offset:11264
    ds_read_b64_tr_b16 a[44:45], v3 offset:10752
    ds_read_b64_tr_b16 a[46:47], v3 offset:11776
    ds_read_b64_tr_b16 a[48:49], v3 offset:12288
    ds_read_b64_tr_b16 a[50:51], v3 offset:13312
    ds_read_b64_tr_b16 a[52:53], v3 offset:12800
    ds_read_b64_tr_b16 a[54:55], v3 offset:13824
    ds_read_b64_tr_b16 a[56:57], v3 offset:14336
    ds_read_b64_tr_b16 a[58:59], v3 offset:15360
    ds_read_b64_tr_b16 a[60:61], v3 offset:14848
    ds_read_b64_tr_b16 a[62:63], v3 offset:15872
    s_waitcnt lgkmcnt(0)
    s_barrier
    s_waitcnt vmcnt(8)
    v_max3_u32 v63, v163, v167, v171
    v_max3_u32 v63, v63, v175, v179
    v_max3_u32 v63, v63, v183, v187
    v_max_u32 v63, v63, v191
    v_cmp_eq_u32 vcc, -1, v63
    s_cbranch_vccnz RT19
CD20:
    v_mfma_f32_32x32x16_bf16 v[80:95], a[128:131], v[160:163], 0
    v_mfma_f32_32x32x16_bf16 v[80:95], a[136:139], v[164:167], v[80:95]
    v_mfma_f32_32x32x16_bf16 v[80:95], a[144:147], v[168:171], v[80:95]
    v_mfma_f32_32x32x16_bf16 v[80:95], a[152:155], v[172:175], v[80:95]
    v_mfma_f32_32x32x16_bf16 v[80:95], a[160:163], v[176:179], v[80:95]
    v_mfma_f32_32x32x16_bf16 v[80:95], a[168:171], v[180:183], v[80:95]
    v_mfma_f32_32x32x16_bf16 v[80:95], a[176:179], v[184:187], v[80:95]
    v_mfma_f32_32x32x16_bf16 v[80:95], a[184:187], v[188:191], v[80:95]
    v_mfma_f32_32x32x16_bf16 v[112:127], a[132:135], v[160:163], 0
    v_mfma_f32_32x32x16_bf16 v[112:127], a[140:143], v[164:167], v[112:127]
    s_waitcnt vmcnt(0)
    v_max3_u32 v63, v131, v135, v139
    v_max3_u32 v63, v63, v143, v147
    v_mfma_f32_32x32x16_bf16 v[112:127], a[148:151], v[168:171], v[112:127]
    ds_write_b128 v10, v[80:83] offset:0
    v_max3_u32 v63, v63, v151, v155
    v_max_u32 v63, v63, v159
    v_cmp_eq_u32 vcc, -1, v63
    s_cbranch_vccnz RT21
CD22:
    v_mfma_f32_32x32x16_bf16 v[112:127], a[156:159], v[172:175], v[112:127]
    ds_write_b128 v10, v[84:87] offset:1024
    v_mfma_f32_32x32x16_bf16 v[112:127], a[164:167], v[176:179], v[112:127]
    ds_write_b128 v12, v[88:91] offset:0
    v_mfma_f32_32x32x16_bf16 v[112:127], a[172:175], v[180:183], v[112:127]
    ds_write_b128 v12, v[92:95] offset:1024
    v_mfma_f32_32x32x16_bf16 v[112:127], a[180:183], v[184:187], v[112:127]
    v_mfma_f32_32x32x16_bf16 v[112:127], a[188:191], v[188:191], v[112:127]
    v_mfma_f32_32x32x16_bf16 v[64:79], a[128:131], v[128:131], 0
    v_mfma_f32_32x32x16_bf16 v[64:79], a[136:139], v[132:135], v[64:79]
    s_add_u32 m0, s58, 12288
    s_add_u32 s4, s62, 458752
    buffer_load_dwordx4 v58, s[20:23], s4 offen lds
    v_mfma_f32_32x32x16_bf16 v[64:79], a[144:147], v[136:139], v[64:79]
    ds_write_b128 v10, v[112:115] offset:6144
    v_mfma_f32_32x32x16_bf16 v[64:79], a[152:155], v[140:143], v[64:79]
    ds_write_b128 v10, v[116:119] offset:7168
    s_add_u32 m0, s58, 13312
    s_add_u32 s4, s62, 487424
    buffer_load_dwordx4 v58, s[20:23], s4 offen lds
    v_mfma_f32_32x32x16_bf16 v[64:79], a[160:163], v[144:147], v[64:79]
    ds_write_b128 v12, v[120:123] offset:6144
    v_mfma_f32_32x32x16_bf16 v[64:79], a[168:171], v[148:151], v[64:79]
    ds_write_b128 v12, v[124:127] offset:7168
    s_add_u32 m0, s58, 14336
    s_add_u32 s4, s62, 516096
    buffer_load_dwordx4 v58, s[20:23], s4 offen lds
    v_mfma_f32_32x32x16_bf16 v[64:79], a[176:179], v[152:155], v[64:79]
    v_mfma_f32_32x32x16_bf16 v[64:79], a[184:187], v[156:159], v[64:79]
    s_add_u32 m0, s58, 15360
    s_add_u32 s4, s62, 544768
    buffer_load_dwordx4 v58, s[20:23], s4 offen lds
    v_mfma_f32_32x32x16_bf16 v[96:111], a[132:135], v[128:131], 0
    v_mfma_f32_32x32x16_bf16 v[96:111], a[140:143], v[132:135], v[96:111]
    v_mfma_f32_32x32x16_bf16 v[96:111], a[148:151], v[136:139], v[96:111]
    ds_write_b128 v11, v[72:75] offset:0
    v_mfma_f32_32x32x16_bf16 v[96:111], a[156:159], v[140:143], v[96:111]
    ds_write_b128 v11, v[76:79] offset:1024
    v_mfma_f32_32x32x16_bf16 v[96:111], a[164:167], v[144:147], v[96:111]
    v_mfma_f32_32x32x16_bf16 v[96:111], a[172:175], v[148:151], v[96:111]
    v_mfma_f32_32x32x16_bf16 v[96:111], a[180:183], v[152:155], v[96:111]
    v_mfma_f32_32x32x16_bf16 v[96:111], a[188:191], v[156:159], v[96:111]
    s_nop 11
    ds_write_b128 v11, v[104:107] offset:6144
    ds_write_b128 v11, v[108:111] offset:7168
    s_waitcnt lgkmcnt(0)
    s_barrier
    ds_read_b128 v[128:131], v13 offset:0
    ds_read_b128 v[132:135], v13 offset:1024
    ds_read_b128 v[136:139], v13 offset:2048
    ds_read_b128 v[140:143], v13 offset:3072
    ds_read_b128 v[144:147], v13 offset:4096
    ds_read_b128 v[148:151], v13 offset:5120
    ds_read_b128 v[152:155], v13 offset:6144
    ds_read_b128 v[156:159], v13 offset:7168
    ds_read_b128 v[160:163], v13 offset:8192
    ds_read_b128 v[164:167], v13 offset:9216
    ds_read_b128 v[168:171], v13 offset:10240
    ds_read_b128 v[172:175], v13 offset:11264
    v_pk_add_f32 v[32:33], v[32:33], v[64:65]
    v_pk_add_f32 v[34:35], v[34:35], v[66:67]
    v_pk_add_f32 v[36:37], v[36:37], v[68:69]
    v_pk_add_f32 v[38:39], v[38:39], v[70:71]
    v_pk_add_f32 v[40:41], v[40:41], v[96:97]
    v_pk_add_f32 v[42:43], v[42:43], v[98:99]
    v_pk_add_f32 v[44:45], v[44:45], v[100:101]
    v_pk_add_f32 v[46:47], v[46:47], v[102:103]
    s_waitcnt lgkmcnt(6)
    v_pk_add_f32 v[128:129], v[128:129], v[136:137]
    v_pk_add_f32 v[130:131], v[130:131], v[138:139]
    v_pk_add_f32 v[132:133], v[132:133], v[140:141]
    v_pk_add_f32 v[134:135], v[134:135], v[142:143]
    v_pk_add_f32 v[32:33], v[32:33], v[144:145]
    v_pk_add_f32 v[34:35], v[34:35], v[146:147]
    v_pk_add_f32 v[36:37], v[36:37], v[148:149]
    v_pk_add_f32 v[38:39], v[38:39], v[150:151]
    v_pk_add_f32 v[32:33], v[32:33], v[128:129]
    v_pk_add_f32 v[34:35], v[34:35], v[130:131]
    v_pk_add_f32 v[36:37], v[36:37], v[132:133]
    v_pk_add_f32 v[38:39], v[38:39], v[134:135]
    s_waitcnt lgkmcnt(0)
    v_pk_add_f32 v[152:153], v[152:153], v[160:161]
    v_pk_add_f32 v[154:155], v[154:155], v[162:163]
    v_pk_add_f32 v[156:157], v[156:157], v[164:165]
    v_pk_add_f32 v[158:159], v[158:159], v[166:167]
    v_pk_add_f32 v[40:41], v[40:41], v[168:169]
    v_pk_add_f32 v[42:43], v[42:43], v[170:171]
    v_pk_add_f32 v[44:45], v[44:45], v[172:173]
    v_pk_add_f32 v[46:47], v[46:47], v[174:175]
    v_pk_add_f32 v[40:41], v[40:41], v[152:153]
    v_pk_add_f32 v[42:43], v[42:43], v[154:155]
    v_pk_add_f32 v[44:45], v[44:45], v[156:157]
    v_pk_add_f32 v[46:47], v[46:47], v[158:159]
    v_pk_add_f32 v[128:129], v[32:33], v[40:41]
    v_pk_add_f32 v[130:131], v[34:35], v[42:43]
    v_pk_add_f32 v[132:133], v[36:37], v[44:45]
    v_pk_add_f32 v[134:135], v[38:39], v[46:47]
    v_pk_mul_f32 v[136:137], v[32:33], v[32:33]
    v_pk_mul_f32 v[138:139], v[34:35], v[34:35]
    v_pk_mul_f32 v[140:141], v[36:37], v[36:37]
    v_pk_mul_f32 v[142:143], v[38:39], v[38:39]
    v_pk_fma_f32 v[136:137], v[40:41], v[40:41], v[136:137]
    v_pk_fma_f32 v[138:139], v[42:43], v[42:43], v[138:139]
    v_pk_fma_f32 v[140:141], v[44:45], v[44:45], v[140:141]
    v_pk_fma_f32 v[142:143], v[46:47], v[46:47], v[142:143]
    v_pk_add_f32 v[128:129], v[128:129], v[130:131]
    v_pk_add_f32 v[132:133], v[132:133], v[134:135]
    v_pk_add_f32 v[136:137], v[136:137], v[138:139]
    v_pk_add_f32 v[140:141], v[140:141], v[142:143]
    v_pk_add_f32 v[128:129], v[128:129], v[132:133]
    v_pk_add_f32 v[136:137], v[136:137], v[140:141]
    v_add_f32 v128, v128, v129
    v_add_f32 v136, v136, v137
    v_and_b32 v62, 31, v0
    v_lshrrev_b32 v61, 5, v0
    v_lshlrev_b32 v61, 2, v61
    v_permlane32_swap_b32 v128, v136
    v_lshl_add_u32 v61, v62, 3, v61
    s_add_u32 s81, s74, 0
    v_add_f32 v128, v128, v136
    s_cmp_lg_u32 s79, 1
    s_cbranch_scc1 PL23
    buffer_store_dword v128, v61, s[28:31], s81 offen
PE24:
    s_lshl_b32 s3, s85, 8
    s_sub_u32 s80, s81, s3
    v_lshlrev_b32 v62, 3, v0
    v_and_b32 v60, 31, v0
    v_bfe_u32 v61, v0, 1, 3
    v_lshrrev_b32 v63, 5, v0
    v_xor_b32 v161, v61, v63
    v_lshl_add_u32 v160, v60, 6, s59
    v_xor_b32 v60, 0, v161
    v_lshl_add_u32 v164, v60, 3, v160
    v_xor_b32 v60, 2, v161
    v_lshl_add_u32 v165, v60, 3, v160
    v_xor_b32 v60, 4, v161
    v_lshl_add_u32 v166, v60, 3, v160
    v_xor_b32 v60, 6, v161
    v_lshl_add_u32 v167, v60, 3, v160
    v_bfe_u32 v60, v0, 2, 2
    v_lshl_add_u32 v61, v63, 2, v60
    v_bfe_u32 v60, v0, 4, 1
    v_lshlrev_b32 v9, 17, v60
    v_lshl_add_u32 v9, v63, 9, v9
    v_and_b32 v63, 15, v0
    v_lshl_add_u32 v9, v63, 4, v9
    s_lshr_b32 s3, s48, 1
    s_lshl_b32 s3, s3, 8
    v_add_u32 v9, s3, v9
    v_and_b32 v63, 3, v0
    v_lshl_add_u32 v60, v60, 2, v63
    v_lshrrev_b32 v63, 1, v61
    v_xor_b32 v60, v60, v63
    v_lshl_add_u32 v61, v61, 6, s59
    v_lshl_add_u32 v162, v60, 3, v61
    v_xor_b32 v60, 4, v60
    v_lshl_add_u32 v163, v60, 3, v61
    s_add_u32 s81, s75, 0
    buffer_load_dwordx2 v[144:145], v62, s[28:31], s80 offen offset:0 sc1
    buffer_load_dwordx2 v[146:147], v62, s[28:31], s80 offen offset:512 sc1
    buffer_load_dwordx2 v[148:149], v62, s[28:31], s80 offen offset:1024 sc1
    buffer_load_dwordx2 v[150:151], v62, s[28:31], s80 offen offset:1536 sc1
    buffer_load_dwordx2 v[152:153], v62, s[28:31], s80 offen offset:2048 sc1
    buffer_load_dwordx2 v[154:155], v62, s[28:31], s80 offen offset:2560 sc1
    buffer_load_dwordx2 v[156:157], v62, s[28:31], s80 offen offset:3072 sc1
    s_add_u32 m0, s58, 0
    s_add_u32 s4, s62, 573440
    buffer_load_dwordx4 v58, s[20:23], s4 offen lds
    s_add_u32 m0, s58, 1024
    s_add_u32 s4, s62, 602112
    buffer_load_dwordx4 v58, s[20:23], s4 offen lds
    s_add_u32 m0, s58, 2048
    s_add_u32 s4, s62, 630784
    buffer_load_dwordx4 v58, s[20:23], s4 offen lds
    s_add_u32 m0, s58, 3072
    s_add_u32 s4, s62, 659456
    buffer_load_dwordx4 v58, s[20:23], s4 offen lds
    s_waitcnt vmcnt(4)
    v_max3_u32 v63, v144, v145, v146
    v_max3_u32 v63, v63, v147, v148
    v_max3_u32 v63, v63, v149, v150
    v_max3_u32 v63, v63, v151, v152
    v_max3_u32 v63, v63, v153, v154
    v_max3_u32 v63, v63, v155, v156
    v_max_u32 v63, v63, v157
    v_cmp_eq_u32 vcc, -1, v63
    s_cbranch_vccnz RT25
CD26:
    v_pk_add_f32 v[144:145], v[144:145], v[146:147]
    v_pk_add_f32 v[148:149], v[148:149], v[150:151]
    v_pk_add_f32 v[152:153], v[152:153], v[154:155]
    v_pk_add_f32 v[144:145], v[144:145], v[148:149]
    v_pk_add_f32 v[152:153], v[152:153], v[156:157]
    v_pk_add_f32 v[144:145], v[144:145], v[152:153]
    s_nop 1
    v_permlane32_swap_b32 v144, v145
    v_add_f32 v144, v144, v145
    v_mov_b32 v61, v144
    v_mov_b32 v60, v144
    s_nop 1
    v_permlane32_swap_b32 v60, v61
    v_mul_f32 v60, 0x3b124925, v60
    v_mul_f32 v61, 0x3b124925, v61
    v_fma_f32 v61, -v60, v60, v61
    v_max_f32 v61, 0, v61
    v_add_f32 v62, 0x3727c5ac, v61
    v_rsq_f32 v62, v62
    v_mov_b32 v63, 0x3727c5ac
    v_mul_f32 v61, v61, v62
    v_fma_f32 v61, v61, v62, v63
    v_rsq_f32 v61, v61
    s_nop 0
    v_mul_f32 v62, v62, v61
    v_mul_f32 v63, v60, v62
    v_pk_fma_f32 v[64:65], v[32:33], v[62:63], v[62:63] op_sel:[0,0,1] op_sel_hi:[1,0,1] neg_lo:[0,0,1] neg_hi:[0,0,1]
    v_pk_fma_f32 v[66:67], v[34:35], v[62:63], v[62:63] op_sel:[0,0,1] op_sel_hi:[1,0,1] neg_lo:[0,0,1] neg_hi:[0,0,1]
    v_pk_fma_f32 v[68:69], v[36:37], v[62:63], v[62:63] op_sel:[0,0,1] op_sel_hi:[1,0,1] neg_lo:[0,0,1] neg_hi:[0,0,1]
    v_pk_fma_f32 v[70:71], v[38:39], v[62:63], v[62:63] op_sel:[0,0,1] op_sel_hi:[1,0,1] neg_lo:[0,0,1] neg_hi:[0,0,1]
    v_pk_fma_f32 v[72:73], v[40:41], v[62:63], v[62:63] op_sel:[0,0,1] op_sel_hi:[1,0,1] neg_lo:[0,0,1] neg_hi:[0,0,1]
    v_pk_fma_f32 v[74:75], v[42:43], v[62:63], v[62:63] op_sel:[0,0,1] op_sel_hi:[1,0,1] neg_lo:[0,0,1] neg_hi:[0,0,1]
    v_pk_fma_f32 v[76:77], v[44:45], v[62:63], v[62:63] op_sel:[0,0,1] op_sel_hi:[1,0,1] neg_lo:[0,0,1] neg_hi:[0,0,1]
    v_pk_fma_f32 v[78:79], v[46:47], v[62:63], v[62:63] op_sel:[0,0,1] op_sel_hi:[1,0,1] neg_lo:[0,0,1] neg_hi:[0,0,1]
    v_cvt_pk_bf16_f32 v128, v64, v65
    v_cvt_pk_bf16_f32 v129, v66, v67
    v_cvt_pk_bf16_f32 v130, v68, v69
    v_cvt_pk_bf16_f32 v131, v70, v71
    v_cvt_pk_bf16_f32 v132, v72, v73
    v_cvt_pk_bf16_f32 v133, v74, v75
    v_cvt_pk_bf16_f32 v134, v76, v77
    v_cvt_pk_bf16_f32 v135, v78, v79
    ds_write_b64 v164, v[128:129]
    ds_write_b64 v165, v[130:131]
    ds_write_b64 v166, v[132:133]
    ds_write_b64 v167, v[134:135]
    ds_read_b64_tr_b16 v[80:81], v162 offset:0
    ds_read_b64_tr_b16 v[82:83], v163 offset:512
    ds_read_b64_tr_b16 v[84:85], v162 offset:1024
    ds_read_b64_tr_b16 v[86:87], v163 offset:1536
    s_waitcnt lgkmcnt(0)
    buffer_store_dwordx4 v[80:83], v9, s[28:31], s81 offen sc0 sc1
    buffer_store_dwordx4 v[84:87], v9, s[28:31], s81 offen offset:1024 sc0 sc1
    s_add_u32 m0, s58, 4096
    s_add_u32 s4, s62, 688128
    buffer_load_dwordx4 v58, s[20:23], s4 offen lds
    s_add_u32 m0, s58, 5120
    s_add_u32 s4, s62, 716800
    buffer_load_dwordx4 v58, s[20:23], s4 offen lds
    s_add_u32 m0, s58, 6144
    s_add_u32 s4, s62, 745472
    buffer_load_dwordx4 v58, s[20:23], s4 offen lds
    s_add_u32 m0, s58, 7168
    s_add_u32 s4, s62, 774144
    buffer_load_dwordx4 v58, s[20:23], s4 offen lds
    s_add_u32 m0, s58, 8192
    s_add_u32 s4, s62, 802816
    buffer_load_dwordx4 v58, s[20:23], s4 offen lds
    s_add_u32 m0, s58, 9216
    s_add_u32 s4, s62, 831488
    buffer_load_dwordx4 v58, s[20:23], s4 offen lds
    s_add_u32 m0, s58, 10240
    s_add_u32 s4, s62, 860160
    buffer_load_dwordx4 v58, s[20:23], s4 offen lds
    s_add_u32 m0, s58, 11264
    s_add_u32 s4, s62, 888832
    buffer_load_dwordx4 v58, s[20:23], s4 offen lds
    s_lshl_b32 s3, s54, 7
    s_and_b32 s76, s48, 1
    s_lshl_b32 s76, s76, 6
    s_add_u32 s76, s76, s3
    s_lshr_b32 s3, s48, 1
    s_lshl_b32 s3, s3, 5
    s_add_u32 s76, s76, s3
    v_lshrrev_b32 v61, 5, v0
    v_lshlrev_b32 v61, 3, v61
    buffer_load_dwordx2 v[248:249], v61, s[36:39], s76 offen offset:0
    buffer_load_dwordx2 v[250:251], v61, s[36:39], s76 offen offset:16
    s_and_b32 s3, s53, 1
    s_lshl_b32 s3, s3, 2
    s_add_u32 s3, s3, s48
    s_mul_i32 s4, s3, 16384
    s_add_u32 s4, s4, 6291456
    s_and_b32 s3, s53, 6
    s_mul_i32 s80, s3, 262144
    s_add_u32 s80, s80, s4
    s_cmp_eq_u32 s3, 6
    s_cselect_b32 s3, 1073741824, 0
    s_cselect_b32 s4, 0, 262144
    s_add_u32 s3, s3, s4
    s_add_u32 s4, s80, s3
    s_bitcmp1_b32 s53, 0
    s_cselect_b32 s6, s80, s4
    s_cselect_b32 s7, s4, s80
    v_bfe_u32 v60, v0, 4, 1
    v_mul_lo_u32 v60, v60, s3
    v_and_b32 v14, 1, v0
    v_lshl_add_u32 v14, v14, 8, v60
    v_bfe_u32 v60, v0, 1, 3
    v_lshl_add_u32 v14, v60, 11, v14
    v_add_u32 v14, 1788, v14
    s_and_b32 s3, s52, 1
    s_lshl_b32 s3, s3, 2
    s_add_u32 s3, s3, s48
    s_mul_i32 s4, s3, 14336
    s_add_u32 s4, s4, 9961472
    s_and_b32 s3, s52, 6
    s_mul_i32 s10, s3, 229376
    s_add_u32 s10, s10, s4
    s_cmp_eq_u32 s3, 6
    s_cselect_b32 s3, 1073741824, 0
    s_cselect_b32 s4, 0, 229376
    s_add_u32 s3, s3, s4
    s_add_u32 s4, s10, s3
    s_bitcmp1_b32 s52, 0
    s_cselect_b32 s8, s10, s4
    s_cselect_b32 s9, s4, s10
    v_and_b32 v15, 15, v0
    v_min_u32 v15, 13, v15
    v_lshlrev_b32 v15, 10, v15
    v_bfe_u32 v60, v0, 4, 1
    v_mul_lo_u32 v60, v60, s3
    v_add3_u32 v15, v15, v60, 4
    v_and_b32 v61, 31, v0
    v_lshrrev_b32 v60, 5, v0
    v_mul_u32_u24 v9, 896, v61
    v_lshl_add_u32 v9, v60, 4, v9
    ds_read_b64_tr_b16 a[64:65], v3 offset:12288
    ds_read_b64_tr_b16 a[66:67], v3 offset:13312
    ds_read_b64_tr_b16 a[68:69], v3 offset:12800
    ds_read_b64_tr_b16 a[70:71], v3 offset:13824
    ds_read_b64_tr_b16 a[72:73], v3 offset:14336
    ds_read_b64_tr_b16 a[74:75], v3 offset:15360
    ds_read_b64_tr_b16 a[76:77], v3 offset:14848
    ds_read_b64_tr_b16 a[78:79], v3 offset:15872
    s_waitcnt lgkmcnt(0)
    s_add_u32 m0, s58, 12288
    s_add_u32 s4, s63, 0
    buffer_load_dwordx4 v59, s[24:27], s4 offen lds
    s_add_u32 m0, s58, 13312
    s_add_u32 s4, s63, 32768
    buffer_load_dwordx4 v59, s[24:27], s4 offen lds
    s_add_u32 m0, s58, 14336
    s_add_u32 s4, s63, 65536
    buffer_load_dwordx4 v59, s[24:27], s4 offen lds
    s_add_u32 m0, s58, 15360
    s_add_u32 s4, s63, 98304
    buffer_load_dwordx4 v59, s[24:27], s4 offen lds
    s_waitcnt vmcnt(6)
    ds_read_b64_tr_b16 a[80:81], v3 offset:0
    ds_read_b64_tr_b16 a[82:83], v3 offset:1024
    ds_read_b64_tr_b16 a[84:85], v3 offset:512
    ds_read_b64_tr_b16 a[86:87], v3 offset:1536
    ds_read_b64_tr_b16 a[88:89], v3 offset:2048
    ds_read_b64_tr_b16 a[90:91], v3 offset:3072
    ds_read_b64_tr_b16 a[92:93], v3 offset:2560
    ds_read_b64_tr_b16 a[94:95], v3 offset:3584
    ds_read_b64_tr_b16 a[96:97], v3 offset:4096
    ds_read_b64_tr_b16 a[98:99], v3 offset:5120
    ds_read_b64_tr_b16 a[100:101], v3 offset:4608
    ds_read_b64_tr_b16 a[102:103], v3 offset:5632
    ds_read_b64_tr_b16 a[104:105], v3 offset:6144
    ds_read_b64_tr_b16 a[106:107], v3 offset:7168
    ds_read_b64_tr_b16 a[108:109], v3 offset:6656
    ds_read_b64_tr_b16 a[110:111], v3 offset:7680
    ds_read_b64_tr_b16 a[112:113], v3 offset:8192
    ds_read_b64_tr_b16 a[114:115], v3 offset:9216
    ds_read_b64_tr_b16 a[116:117], v3 offset:8704
    ds_read_b64_tr_b16 a[118:119], v3 offset:9728
    ds_read_b64_tr_b16 a[120:121], v3 offset:10240
    ds_read_b64_tr_b16 a[122:123], v3 offset:11264
    ds_read_b64_tr_b16 a[124:125], v3 offset:10752
    ds_read_b64_tr_b16 a[126:127], v3 offset:11776
    s_waitcnt lgkmcnt(0)
    s_add_u32 m0, s58, 0
    s_add_u32 s4, s63, 131072
    buffer_load_dwordx4 v59, s[24:27], s4 offen lds
    s_add_u32 m0, s58, 1024
    s_add_u32 s4, s63, 163840
    buffer_load_dwordx4 v59, s[24:27], s4 offen lds
    s_add_u32 m0, s58, 2048
    s_add_u32 s4, s63, 196608
    buffer_load_dwordx4 v59, s[24:27], s4 offen lds
    s_add_u32 m0, s58, 3072
    s_add_u32 s4, s63, 229376
    buffer_load_dwordx4 v59, s[24:27], s4 offen lds
    s_add_u32 m0, s58, 4096
    s_add_u32 s4, s63, 262144
    buffer_load_dwordx4 v59, s[24:27], s4 offen lds
    s_add_u32 m0, s58, 5120
    s_add_u32 s4, s63, 294912
    buffer_load_dwordx4 v59, s[24:27], s4 offen lds
    s_add_u32 m0, s58, 6144
    s_add_u32 s4, s63, 327680
    buffer_load_dwordx4 v59, s[24:27], s4 offen lds
    s_add_u32 m0, s58, 7168
    s_add_u32 s4, s63, 360448
    buffer_load_dwordx4 v59, s[24:27], s4 offen lds
    s_add_u32 m0, s58, 8192
    s_add_u32 s4, s63, 393216
    buffer_load_dwordx4 v59, s[24:27], s4 offen lds
    s_add_u32 m0, s58, 9216
    s_add_u32 s4, s63, 425984
    buffer_load_dwordx4 v59, s[24:27], s4 offen lds
    s_add_u32 m0, s58, 10240
    s_add_u32 s4, s63, 458752
    buffer_load_dwordx4 v59, s[24:27], s4 offen lds
    s_add_u32 m0, s58, 11264
    s_add_u32 s4, s63, 491520
    buffer_load_dwordx4 v59, s[24:27], s4 offen lds
    buffer_load_dword v62, v14, s[28:31], s80 offen sc1
    s_add_u32 s77, s6, 0
    buffer_load_dwordx4 v[128:131], v1, s[28:31], s77 offen offset:0 sc1
    buffer_load_dwordx4 v[132:135], v1, s[28:31], s77 offen offset:1024 sc1
    buffer_load_dwordx4 v[136:139], v1, s[28:31], s77 offen offset:2048 sc1
    buffer_load_dwordx4 v[140:143], v1, s[28:31], s77 offen offset:3072 sc1
    s_add_u32 s77, s6, 4096
    buffer_load_dwordx4 v[144:147], v1, s[28:31], s77 offen offset:0 sc1
    buffer_load_dwordx4 v[148:151], v1, s[28:31], s77 offen offset:1024 sc1
    buffer_load_dwordx4 v[152:155], v1, s[28:31], s77 offen offset:2048 sc1
    buffer_load_dwordx4 v[156:159], v1, s[28:31], s77 offen offset:3072 sc1
    s_add_u32 s77, s6, 8192
    buffer_load_dwordx4 v[160:163], v1, s[28:31], s77 offen offset:0 sc1
    buffer_load_dwordx4 v[164:167], v1, s[28:31], s77 offen offset:1024 sc1
    buffer_load_dwordx4 v[168:171], v1, s[28:31], s77 offen offset:2048 sc1
    buffer_load_dwordx4 v[172:175], v1, s[28:31], s77 offen offset:3072 sc1
    s_add_u32 s77, s6, 12288
    buffer_load_dwordx4 v[176:179], v1, s[28:31], s77 offen offset:0 sc1
    buffer_load_dwordx4 v[180:183], v1, s[28:31], s77 offen offset:1024 sc1
    buffer_load_dwordx4 v[184:187], v1, s[28:31], s77 offen offset:2048 sc1
    buffer_load_dwordx4 v[188:191], v1, s[28:31], s77 offen offset:3072 sc1
    s_waitcnt vmcnt(33)
    v_lshlrev_b32 v48, 16, v248
    v_and_b32 v49, 0xffff0000, v248
    v_lshlrev_b32 v50, 16, v249
    v_and_b32 v51, 0xffff0000, v249
    v_lshlrev_b32 v52, 16, v250
    v_and_b32 v53, 0xffff0000, v250
    v_lshlrev_b32 v54, 16, v251
    v_and_b32 v55, 0xffff0000, v251
    s_waitcnt vmcnt(12)
    v_max3_u32 v63, v131, v135, v139
    v_max3_u32 v63, v63, v143, v62
    v_cmp_eq_u32 vcc, -1, v63
    s_cbranch_vccnz RT27
CD28:
    v_mfma_f32_32x32x16_bf16 v[64:79], a[0:3], v[128:131], 0
    s_add_u32 s77, s7, 0
    buffer_load_dwordx4 v[192:195], v1, s[28:31], s77 offen offset:0 sc1
    ds_read_b64_tr_b16 a[128:129], v3 offset:12288
    ds_read_b64_tr_b16 a[130:131], v3 offset:13312
    ds_read_b64_tr_b16 a[132:133], v3 offset:12800
    v_mfma_f32_32x32x16_bf16 v[80:95], a[4:7], v[128:131], 0
    ds_read_b64_tr_b16 a[134:135], v3 offset:13824
    ds_read_b64_tr_b16 a[136:137], v3 offset:14336
    ds_read_b64_tr_b16 a[138:139], v3 offset:15360
    ds_read_b64_tr_b16 a[140:141], v3 offset:14848
    v_mfma_f32_32x32x16_bf16 v[64:79], a[8:11], v[132:135], v[64:79]
    buffer_load_dwordx4 v[196:199], v1, s[28:31], s77 offen offset:1024 sc1
    ds_read_b64_tr_b16 a[142:143], v3 offset:15872
    ds_read_b64_tr_b16 a[144:145], v3 offset:0
    ds_read_b64_tr_b16 a[146:147], v3 offset:1024
    v_mfma_f32_32x32x16_bf16 v[80:95], a[12:15], v[132:135], v[80:95]
    ds_read_b64_tr_b16 a[148:149], v3 offset:512
    ds_read_b64_tr_b16 a[150:151], v3 offset:1536
    ds_read_b64_tr_b16 a[152:153], v3 offset:2048
    ds_read_b64_tr_b16 a[154:155], v3 offset:3072
    v_mfma_f32_32x32x16_bf16 v[64:79], a[16:19], v[136:139], v[64:79]
    buffer_load_dwordx4 v[200:203], v1, s[28:31], s77 offen offset:2048 sc1
    s_waitcnt vmcnt(11)
    v_max3_u32 v63, v147, v151, v155
    v_max_u32 v63, v63, v159
    v_mfma_f32_32x32x16_bf16 v[80:95], a[20:23], v[136:139], v[80:95]
    v_cmp_eq_u32 s[40:41], -1, v63
    ds_read_b64_tr_b16 a[156:157], v3 offset:2560
    ds_read_b64_tr_b16 a[158:159], v3 offset:3584
    ds_read_b64_tr_b16 a[160:161], v3 offset:4096
    ds_read_b64_tr_b16 a[162:163], v3 offset:5120
    v_mfma_f32_32x32x16_bf16 v[64:79], a[24:27], v[140:143], v[64:79]
    buffer_load_dwordx4 v[204:207], v1, s[28:31], s77 offen offset:3072 sc1
    s_cmp_lg_u64 s[40:41], 0
    s_cbranch_scc1 RT29
CD30:
    ds_read_b64_tr_b16 a[164:165], v3 offset:4608
    v_mfma_f32_32x32x16_bf16 v[80:95], a[28:31], v[140:143], v[80:95]
    ds_read_b64_tr_b16 a[166:167], v3 offset:5632
    ds_read_b64_tr_b16 a[168:169], v3 offset:6144
    ds_read_b64_tr_b16 a[170:171], v3 offset:7168
    ds_read_b64_tr_b16 a[172:173], v3 offset:6656
    v_mfma_f32_32x32x16_bf16 v[64:79], a[32:35], v[144:147], v[64:79]
    s_add_u32 s77, s7, 4096
    buffer_load_dwordx4 v[208:211], v1, s[28:31], s77 offen offset:0 sc1
    ds_read_b64_tr_b16 a[174:175], v3 offset:7680
    ds_read_b64_tr_b16 a[176:177], v3 offset:8192
    ds_read_b64_tr_b16 a[178:179], v3 offset:9216
    v_mfma_f32_32x32x16_bf16 v[80:95], a[36:39], v[144:147], v[80:95]
    ds_read_b64_tr_b16 a[180:181], v3 offset:8704
    ds_read_b64_tr_b16 a[182:183], v3 offset:9728
    ds_read_b64_tr_b16 a[184:185], v3 offset:10240
    ds_read_b64_tr_b16 a[186:187], v3 offset:11264
    v_mfma_f32_32x32x16_bf16 v[64:79], a[40:43], v[148:151], v[64:79]
    buffer_load_dwordx4 v[212:215], v1, s[28:31], s77 offen offset:1024 sc1
    ds_read_b64_tr_b16 a[188:189], v3 offset:10752
    ds_read_b64_tr_b16 a[190:191], v3 offset:11776
    s_waitcnt lgkmcnt(0)
    s_barrier
    v_mfma_f32_32x32x16_bf16 v[80:95], a[44:47], v[148:151], v[80:95]
    s_add_u32 m0, s58, 12288
    s_add_u32 s4, s63, 524288
    buffer_load_dwordx4 v59, s[24:27], s4 offen lds
    s_add_u32 m0, s58, 13312
    s_add_u32 s4, s63, 557056
    buffer_load_dwordx4 v59, s[24:27], s4 offen lds
    v_mfma_f32_32x32x16_bf16 v[64:79], a[48:51], v[152:155], v[64:79]
    buffer_load_dwordx4 v[128:131], v1, s[28:31], s77 offen offset:2048 sc1
    s_waitcnt vmcnt(13)
    v_max3_u32 v63, v163, v167, v171
    v_max_u32 v63, v63, v175
    v_mfma_f32_32x32x16_bf16 v[80:95], a[52:55], v[152:155], v[80:95]
    v_cmp_eq_u32 s[40:41], -1, v63
    s_add_u32 m0, s58, 14336
    s_add_u32 s4, s63, 589824
    buffer_load_dwordx4 v59, s[24:27], s4 offen lds
    s_add_u32 m0, s58, 15360
    s_add_u32 s4, s63, 622592
    buffer_load_dwordx4 v59, s[24:27], s4 offen lds
    v_mfma_f32_32x32x16_bf16 v[64:79], a[56:59], v[156:159], v[64:79]
    buffer_load_dwordx4 v[132:135], v1, s[28:31], s77 offen offset:3072 sc1
    s_cmp_lg_u64 s[40:41], 0
    s_cbranch_scc1 RT31
CD32:
    v_mfma_f32_32x32x16_bf16 v[80:95], a[60:63], v[156:159], v[80:95]
    v_mfma_f32_32x32x16_bf16 v[64:79], a[64:67], v[160:163], v[64:79]
    s_add_u32 s77, s7, 8192
    buffer_load_dwordx4 v[136:139], v1, s[28:31], s77 offen offset:0 sc1
    v_mfma_f32_32x32x16_bf16 v[80:95], a[68:71], v[160:163], v[80:95]
    v_mfma_f32_32x32x16_bf16 v[64:79], a[72:75], v[164:167], v[64:79]
    buffer_load_dwordx4 v[140:143], v1, s[28:31], s77 offen offset:1024 sc1
    v_mfma_f32_32x32x16_bf16 v[80:95], a[76:79], v[164:167], v[80:95]
    v_mfma_f32_32x32x16_bf16 v[64:79], a[80:83], v[168:171], v[64:79]
    buffer_load_dwordx4 v[144:147], v1, s[28:31], s77 offen offset:2048 sc1
    s_waitcnt vmcnt(15)
    v_max3_u32 v63, v179, v183, v187
    v_max_u32 v63, v63, v191
    v_mfma_f32_32x32x16_bf16 v[80:95], a[84:87], v[168:171], v[80:95]
    v_cmp_eq_u32 s[40:41], -1, v63
    v_mfma_f32_32x32x16_bf16 v[64:79], a[88:91], v[172:175], v[64:79]
    buffer_load_dwordx4 v[148:151], v1, s[28:31], s77 offen offset:3072 sc1
    s_cmp_lg_u64 s[40:41], 0
    s_cbranch_scc1 RT33
CD34:
    v_mfma_f32_32x32x16_bf16 v[80:95], a[92:95], v[172:175], v[80:95]
    v_mfma_f32_32x32x16_bf16 v[64:79], a[96:99], v[176:179], v[64:79]
    s_add_u32 s77, s7, 12288
    buffer_load_dwordx4 v[152:155], v1, s[28:31], s77 offen offset:0 sc1
    v_mfma_f32_32x32x16_bf16 v[80:95], a[100:103], v[176:179], v[80:95]
    v_mfma_f32_32x32x16_bf16 v[64:79], a[104:107], v[180:183], v[64:79]
    buffer_load_dwordx4 v[156:159], v1, s[28:31], s77 offen offset:1024 sc1
    v_mfma_f32_32x32x16_bf16 v[80:95], a[108:111], v[180:183], v[80:95]
    v_mfma_f32_32x32x16_bf16 v[64:79], a[112:115], v[184:187], v[64:79]
    buffer_load_dwordx4 v[160:163], v1, s[28:31], s77 offen offset:2048 sc1
    s_waitcnt vmcnt(15)
    v_max3_u32 v63, v195, v199, v203
    v_max_u32 v63, v63, v207
    v_mfma_f32_32x32x16_bf16 v[80:95], a[116:119], v[184:187], v[80:95]
    v_cmp_eq_u32 s[40:41], -1, v63
    v_mfma_f32_32x32x16_bf16 v[64:79], a[120:123], v[188:191], v[64:79]
    buffer_load_dwordx4 v[164:167], v1, s[28:31], s77 offen offset:3072 sc1
    s_cmp_lg_u64 s[40:41], 0
    s_cbranch_scc1 RT35
CD36:
    v_mfma_f32_32x32x16_bf16 v[80:95], a[124:127], v[188:191], v[80:95]
    v_mfma_f32_32x32x16_bf16 v[96:111], a[0:3], v[192:195], 0
    s_add_u32 s77, s6, 131072
    buffer_load_dwordx4 v[168:171], v1, s[28:31], s77 offen offset:0 sc1
    v_mfma_f32_32x32x16_bf16 v[112:127], a[4:7], v[192:195], 0
    v_mfma_f32_32x32x16_bf16 v[96:111], a[8:11], v[196:199], v[96:111]
    buffer_load_dwordx4 v[172:175], v1, s[28:31], s77 offen offset:1024 sc1
    ds_write_b128 v10, v[80:83] offset:0
    v_mfma_f32_32x32x16_bf16 v[112:127], a[12:15], v[196:199], v[112:127]
    ds_write_b128 v10, v[84:87] offset:1024
    v_mfma_f32_32x32x16_bf16 v[96:111], a[16:19], v[200:203], v[96:111]
    buffer_load_dwordx4 v[176:179], v1, s[28:31], s77 offen offset:2048 sc1
    s_waitcnt vmcnt(11)
    v_max3_u32 v63, v211, v215, v131
    v_max_u32 v63, v63, v135
    v_mfma_f32_32x32x16_bf16 v[112:127], a[20:23], v[200:203], v[112:127]
    v_cmp_eq_u32 s[40:41], -1, v63
    ds_write_b128 v12, v[88:91] offset:0
    v_mfma_f32_32x32x16_bf16 v[96:111], a[24:27], v[204:207], v[96:111]
    buffer_load_dwordx4 v[180:183], v1, s[28:31], s77 offen offset:3072 sc1
    s_cmp_lg_u64 s[40:41], 0
    s_cbranch_scc1 RT37
CD38:
    ds_write_b128 v12, v[92:95] offset:1024
    v_mfma_f32_32x32x16_bf16 v[112:127], a[28:31], v[204:207], v[112:127]
    ds_write_b128 v11, v[72:75] offset:0
    v_mfma_f32_32x32x16_bf16 v[96:111], a[32:35], v[208:211], v[96:111]
    s_add_u32 s77, s6, 135168
    buffer_load_dwordx4 v[184:187], v1, s[28:31], s77 offen offset:0 sc1
    ds_write_b128 v11, v[76:79] offset:1024
    v_mfma_f32_32x32x16_bf16 v[112:127], a[36:39], v[208:211], v[112:127]
    v_mfma_f32_32x32x16_bf16 v[96:111], a[40:43], v[212:215], v[96:111]
    buffer_load_dwordx4 v[188:191], v1, s[28:31], s77 offen offset:1024 sc1
    v_mfma_f32_32x32x16_bf16 v[112:127], a[44:47], v[212:215], v[112:127]
    v_mfma_f32_32x32x16_bf16 v[96:111], a[48:51], v[128:131], v[96:111]
    buffer_load_dwordx4 v[192:195], v1, s[28:31], s77 offen offset:2048 sc1
    s_waitcnt vmcnt(11)
    v_max3_u32 v63, v139, v143, v147
    v_max_u32 v63, v63, v151
    v_mfma_f32_32x32x16_bf16 v[112:127], a[52:55], v[128:131], v[112:127]
    v_cmp_eq_u32 s[40:41], -1, v63
    s_waitcnt lgkmcnt(0)
    s_barrier
    ds_read_b128 v[224:227], v13 offset:0
    ds_read_b128 v[228:231], v13 offset:1024
    ds_read_b128 v[232:235], v13 offset:2048
    v_mfma_f32_32x32x16_bf16 v[96:111], a[56:59], v[132:135], v[96:111]
    buffer_load_dwordx4 v[196:199], v1, s[28:31], s77 offen offset:3072 sc1
    s_cmp_lg_u64 s[40:41], 0
    s_cbranch_scc1 RT39
CD40:
    ds_read_b128 v[236:239], v13 offset:3072
    v_mfma_f32_32x32x16_bf16 v[112:127], a[60:63], v[132:135], v[112:127]
    ds_read_b128 v[240:243], v13 offset:4096
    ds_read_b128 v[244:247], v13 offset:5120
    v_mfma_f32_32x32x16_bf16 v[96:111], a[64:67], v[136:139], v[96:111]
    s_add_u32 s77, s6, 139264
    buffer_load_dwordx4 v[200:203], v1, s[28:31], s77 offen offset:0 sc1
    v_mfma_f32_32x32x16_bf16 v[112:127], a[68:71], v[136:139], v[112:127]
    v_mfma_f32_32x32x16_bf16 v[96:111], a[72:75], v[140:143], v[96:111]
    buffer_load_dwordx4 v[204:207], v1, s[28:31], s77 offen offset:1024 sc1
    s_waitcnt lgkmcnt(0)
    v_add_f32 v224, v224, v232
    v_add_f32 v225, v225, v233
    v_add_f32 v226, v226, v234
    v_mfma_f32_32x32x16_bf16 v[112:127], a[76:79], v[140:143], v[112:127]
    v_add_f32 v227, v227, v235
    v_add_f32 v228, v228, v236
    v_add_f32 v229, v229, v237
    v_add_f32 v230, v230, v238
    v_add_f32 v231, v231, v239
    v_mfma_f32_32x32x16_bf16 v[96:111], a[80:83], v[144:147], v[96:111]
    buffer_load_dwordx4 v[208:211], v1, s[28:31], s77 offen offset:2048 sc1
    s_waitcnt vmcnt(11)
    v_max3_u32 v63, v155, v159, v163
    v_max_u32 v63, v63, v167
    v_mfma_f32_32x32x16_bf16 v[112:127], a[84:87], v[144:147], v[112:127]
    v_cmp_eq_u32 s[40:41], -1, v63
    ds_read_b64_tr_b16 a[192:193], v3 offset:12288
    ds_read_b64_tr_b16 a[194:195], v3 offset:13312
    ds_read_b64_tr_b16 a[196:197], v3 offset:12800
    ds_read_b64_tr_b16 a[198:199], v3 offset:13824
    v_mfma_f32_32x32x16_bf16 v[96:111], a[88:91], v[148:151], v[96:111]
    buffer_load_dwordx4 v[212:215], v1, s[28:31], s77 offen offset:3072 sc1
    s_cmp_lg_u64 s[40:41], 0
    s_cbranch_scc1 RT41
CD42:
    v_add_f32 v64, v64, v240
    v_add_f32 v65, v65, v241
    v_mfma_f32_32x32x16_bf16 v[112:127], a[92:95], v[148:151], v[112:127]
    v_add_f32 v66, v66, v242
    v_add_f32 v67, v67, v243
    v_add_f32 v68, v68, v244
    v_add_f32 v69, v69, v245
    v_add_f32 v70, v70, v246
    v_mfma_f32_32x32x16_bf16 v[96:111], a[96:99], v[152:155], v[96:111]
    s_add_u32 s77, s6, 143360
    buffer_load_dwordx4 v[128:131], v1, s[28:31], s77 offen offset:0 sc1
    v_add_f32 v71, v71, v247
    v_add_f32 v64, v64, v224
    v_add_f32 v65, v65, v225
    v_mfma_f32_32x32x16_bf16 v[112:127], a[100:103], v[152:155], v[112:127]
    ds_read_b64_tr_b16 a[200:201], v3 offset:14336
    ds_read_b64_tr_b16 a[202:203], v3 offset:15360
    ds_read_b64_tr_b16 a[204:205], v3 offset:14848
    ds_read_b64_tr_b16 a[206:207], v3 offset:15872
    v_mfma_f32_32x32x16_bf16 v[96:111], a[104:107], v[156:159], v[96:111]
    buffer_load_dwordx4 v[132:135], v1, s[28:31], s77 offen offset:1024 sc1
    v_add_f32 v66, v66, v226
    v_add_f32 v67, v67, v227
    v_add_f32 v68, v68, v228
    v_mfma_f32_32x32x16_bf16 v[112:127], a[108:111], v[156:159], v[112:127]
    v_add_f32 v69, v69, v229
    v_add_f32 v70, v70, v230
    v_add_f32 v71, v71, v231
    v_cvt_pk_bf16_f32 v64, v64, v65
    v_cvt_pk_bf16_f32 v65, v66, v67
    v_mfma_f32_32x32x16_bf16 v[96:111], a[112:115], v[160:163], v[96:111]
    buffer_load_dwordx4 v[136:139], v1, s[28:31], s77 offen offset:2048 sc1
    s_waitcnt vmcnt(11)
    v_max3_u32 v63, v171, v175, v179
    v_max_u32 v63, v63, v183
    v_mfma_f32_32x32x16_bf16 v[112:127], a[116:119], v[160:163], v[112:127]
    v_cmp_eq_u32 s[40:41], -1, v63
    s_waitcnt lgkmcnt(0)
    s_add_u32 m0, s58, 12288
    s_add_u32 s4, s63, 655360
    buffer_load_dwordx4 v59, s[24:27], s4 offen lds
    v_mfma_f32_32x32x16_bf16 v[96:111], a[120:123], v[164:167], v[96:111]
    buffer_load_dwordx4 v[140:143], v1, s[28:31], s77 offen offset:3072 sc1
    s_cmp_lg_u64 s[40:41], 0
    s_cbranch_scc1 RT43
CD44:
    v_cvt_pk_bf16_f32 v66, v68, v69
    v_mfma_f32_32x32x16_bf16 v[112:127], a[124:127], v[164:167], v[112:127]
    v_cvt_pk_bf16_f32 v67, v70, v71
    s_add_u32 s81, s57, 0
    s_cmp_lg_u32 s79, 1
    s_cbranch_scc1 PL45
    buffer_store_dwordx4 v[64:67], v1, s[28:31], s81 offen
PE46:
    s_nop 1
    v_mfma_f32_32x32x16_bf16 v[64:79], a[0:3], v[168:171], 0
    s_add_u32 s77, s7, 131072
    buffer_load_dwordx4 v[144:147], v1, s[28:31], s77 offen offset:0 sc1
    s_add_u32 m0, s58, 13312
    s_add_u32 s4, s63, 688128
    buffer_load_dwordx4 v59, s[24:27], s4 offen lds
    v_mfma_f32_32x32x16_bf16 v[80:95], a[4:7], v[168:171], 0
    s_add_u32 m0, s58, 14336
    s_add_u32 s4, s63, 720896
    buffer_load_dwordx4 v59, s[24:27], s4 offen lds
    s_add_u32 m0, s58, 15360
    s_add_u32 s4, s63, 753664
    buffer_load_dwordx4 v59, s[24:27], s4 offen lds
    s_add_u32 s81, s82, 0
    buffer_load_dwordx4 v[216:219], v1, s[28:31], s81 offen sc1
    v_mfma_f32_32x32x16_bf16 v[64:79], a[8:11], v[172:175], v[64:79]
    buffer_load_dwordx4 v[148:151], v1, s[28:31], s77 offen offset:1024 sc1
    ds_write_b128 v10, v[112:115] offset:6144
    v_mfma_f32_32x32x16_bf16 v[80:95], a[12:15], v[172:175], v[80:95]
    ds_write_b128 v10, v[116:119] offset:7168
    v_mfma_f32_32x32x16_bf16 v[64:79], a[16:19], v[176:179], v[64:79]
    buffer_load_dwordx4 v[152:155], v1, s[28:31], s77 offen offset:2048 sc1
    s_waitcnt vmcnt(17)
    v_max3_u32 v63, v187, v191, v195
    v_max_u32 v63, v63, v199
    v_mfma_f32_32x32x16_bf16 v[80:95], a[20:23], v[176:179], v[80:95]
    v_cmp_eq_u32 s[40:41], -1, v63
    ds_write_b128 v12, v[120:123] offset:6144
    v_mfma_f32_32x32x16_bf16 v[64:79], a[24:27], v[180:183], v[64:79]
    buffer_load_dwordx4 v[156:159], v1, s[28:31], s77 offen offset:3072 sc1
    s_cmp_lg_u64 s[40:41], 0
    s_cbranch_scc1 RT47
CD48:
    ds_write_b128 v12, v[124:127] offset:7168
    v_mfma_f32_32x32x16_bf16 v[80:95], a[28:31], v[180:183], v[80:95]
    ds_write_b128 v11, v[104:107] offset:6144
    v_mfma_f32_32x32x16_bf16 v[64:79], a[32:35], v[184:187], v[64:79]
    s_add_u32 s77, s7, 135168
    buffer_load_dwordx4 v[160:163], v1, s[28:31], s77 offen offset:0 sc1
    ds_write_b128 v11, v[108:111] offset:7168
    v_mfma_f32_32x32x16_bf16 v[80:95], a[36:39], v[184:187], v[80:95]
    v_add_f32 v96, v96, v48
    v_add_f32 v97, v97, v49
    v_add_f32 v98, v98, v50
    v_add_f32 v99, v99, v51
    v_add_f32 v100, v100, v52
    v_mfma_f32_32x32x16_bf16 v[64:79], a[40:43], v[188:191], v[64:79]
    buffer_load_dwordx4 v[164:167], v1, s[28:31], s77 offen offset:1024 sc1
    v_add_f32 v101, v101, v53
    v_add_f32 v102, v102, v54
    v_add_f32 v103, v103, v55
    v_mfma_f32_32x32x16_bf16 v[80:95], a[44:47], v[188:191], v[80:95]
    v_mfma_f32_32x32x16_bf16 v[64:79], a[48:51], v[192:195], v[64:79]
    buffer_load_dwordx4 v[168:171], v1, s[28:31], s77 offen offset:2048 sc1
    s_waitcnt vmcnt(17)
    v_max3_u32 v63, v203, v207, v211
    v_max_u32 v63, v63, v215
    v_mfma_f32_32x32x16_bf16 v[80:95], a[52:55], v[192:195], v[80:95]
    v_cmp_eq_u32 s[40:41], -1, v63
    v_mfma_f32_32x32x16_bf16 v[64:79], a[56:59], v[196:199], v[64:79]
    buffer_load_dwordx4 v[172:175], v1, s[28:31], s77 offen offset:3072 sc1
    s_cmp_lg_u64 s[40:41], 0
    s_cbranch_scc1 RT51
CD52:
    s_waitcnt lgkmcnt(0)
    s_barrier
    ds_read_b128 v[224:227], v13 offset:6144
    v_mfma_f32_32x32x16_bf16 v[80:95], a[60:63], v[196:199], v[80:95]
    ds_read_b128 v[228:231], v13 offset:7168
    ds_read_b128 v[232:235], v13 offset:8192
    ds_read_b128 v[236:239], v13 offset:9216
    ds_read_b128 v[240:243], v13 offset:10240
    v_mfma_f32_32x32x16_bf16 v[64:79], a[64:67], v[200:203], v[64:79]
    s_add_u32 s77, s7, 139264
    buffer_load_dwordx4 v[176:179], v1, s[28:31], s77 offen offset:0 sc1
    ds_read_b128 v[244:247], v13 offset:11264
    v_mfma_f32_32x32x16_bf16 v[80:95], a[68:71], v[200:203], v[80:95]
    v_mfma_f32_32x32x16_bf16 v[64:79], a[72:75], v[204:207], v[64:79]
    buffer_load_dwordx4 v[180:183], v1, s[28:31], s77 offen offset:1024 sc1
    v_mfma_f32_32x32x16_bf16 v[80:95], a[76:79], v[204:207], v[80:95]
    s_waitcnt lgkmcnt(0)
    v_add_f32 v224, v224, v232
    v_add_f32 v225, v225, v233
    v_add_f32 v226, v226, v234
    v_add_f32 v227, v227, v235
    v_add_f32 v228, v228, v236
    v_mfma_f32_32x32x16_bf16 v[64:79], a[80:83], v[208:211], v[64:79]
    buffer_load_dwordx4 v[184:187], v1, s[28:31], s77 offen offset:2048 sc1
    s_waitcnt vmcnt(16)
    v_max3_u32 v63, v131, v135, v139
    v_max_u32 v63, v63, v143
    v_mfma_f32_32x32x16_bf16 v[80:95], a[84:87], v[208:211], v[80:95]
    v_cmp_eq_u32 s[40:41], -1, v63
    v_add_f32 v229, v229, v237
    v_add_f32 v230, v230, v238
    v_add_f32 v231, v231, v239
    v_add_f32 v96, v96, v240
    v_mfma_f32_32x32x16_bf16 v[64:79], a[88:91], v[212:215], v[64:79]
    buffer_load_dwordx4 v[188:191], v1, s[28:31], s77 offen offset:3072 sc1
    s_cmp_lg_u64 s[40:41], 0
    s_cbranch_scc1 RT53
CD54:
    v_add_f32 v97, v97, v241
    v_add_f32 v98, v98, v242
    v_mfma_f32_32x32x16_bf16 v[80:95], a[92:95], v[212:215], v[80:95]
    v_add_f32 v99, v99, v243
    v_add_f32 v100, v100, v244
    v_add_f32 v101, v101, v245
    v_add_f32 v102, v102, v246
    v_add_f32 v103, v103, v247
    v_mfma_f32_32x32x16_bf16 v[64:79], a[96:99], v[128:131], v[64:79]
    s_add_u32 s77, s7, 143360
    buffer_load_dwordx4 v[192:195], v1, s[28:31], s77 offen offset:0 sc1
    v_add_f32 v96, v96, v224
    v_add_f32 v97, v97, v225
    v_add_f32 v98, v98, v226
    v_mfma_f32_32x32x16_bf16 v[80:95], a[100:103], v[128:131], v[80:95]
    s_waitcnt vmcnt(13)
    ds_read_b64_tr_b16 a[208:209], v3 offset:12288
    ds_read_b64_tr_b16 a[210:211], v3 offset:13312
    ds_read_b64_tr_b16 a[212:213], v3 offset:12800
    ds_read_b64_tr_b16 a[214:215], v3 offset:13824
    v_mfma_f32_32x32x16_bf16 v[64:79], a[104:107], v[132:135], v[64:79]
    buffer_load_dwordx4 v[196:199], v1, s[28:31], s77 offen offset:1024 sc1
    v_add_f32 v99, v99, v227
    v_add_f32 v100, v100, v228
    v_add_f32 v101, v101, v229
    v_mfma_f32_32x32x16_bf16 v[80:95], a[108:111], v[132:135], v[80:95]
    v_add_f32 v102, v102, v230
    v_add_f32 v103, v103, v231
    s_waitcnt vmcnt(13)
    v_max_u32 v61, v217, v219
    v_cmp_eq_u32 s[42:43], -1, v61
    ds_read_b64_tr_b16 a[216:217], v3 offset:14336
    v_mfma_f32_32x32x16_bf16 v[64:79], a[112:115], v[136:139], v[64:79]
    buffer_load_dwordx4 v[200:203], v1, s[28:31], s77 offen offset:2048 sc1
    s_waitcnt vmcnt(11)
    v_max3_u32 v63, v147, v151, v155
    v_max_u32 v63, v63, v159
    v_mfma_f32_32x32x16_bf16 v[80:95], a[116:119], v[136:139], v[80:95]
    v_cmp_eq_u32 s[40:41], -1, v63
    ds_read_b64_tr_b16 a[218:219], v3 offset:15360
    ds_read_b64_tr_b16 a[220:221], v3 offset:14848
    ds_read_b64_tr_b16 a[222:223], v3 offset:15872
    s_waitcnt lgkmcnt(0)
    v_mfma_f32_32x32x16_bf16 v[64:79], a[120:123], v[140:143], v[64:79]
    buffer_load_dwordx4 v[204:207], v1, s[28:31], s77 offen offset:3072 sc1
    s_cmp_lg_u64 s[40:41], 0
    s_cbranch_scc1 RT55
CD56:
    s_cmp_lg_u64 s[42:43], 0
    s_cbranch_scc1 RT49
CD50:
    v_mfma_f32_32x32x16_bf16 v[80:95], a[124:127], v[140:143], v[80:95]
    v_lshlrev_b32 v248, 16, v216
    v_and_b32 v249, 0xffff0000, v216
    v_lshlrev_b32 v250, 16, v217
    v_and_b32 v251, 0xffff0000, v217
    v_lshlrev_b32 v252, 16, v218
    v_and_b32 v253, 0xffff0000, v218
    v_lshlrev_b32 v254, 16, v219
    v_and_b32 v255, 0xffff0000, v219
    v_add_f32 v96, v96, v248
    v_add_f32 v97, v97, v249
    v_add_f32 v98, v98, v250
    v_add_f32 v99, v99, v251
    v_add_f32 v100, v100, v252
    v_add_f32 v101, v101, v253
    v_add_f32 v102, v102, v254
    v_add_f32 v103, v103, v255
    v_mul_f32 v248, v96, v96
    v_mul_f32 v249, v97, v97
    v_mul_f32 v250, v98, v98
    v_mul_f32 v251, v99, v99
    v_mul_f32 v252, v100, v100
    v_mul_f32 v253, v101, v101
    v_mul_f32 v254, v102, v102
    v_mul_f32 v255, v103, v103
    v_mov_b32 v224, s70
    v_fmaak_f32 v248, v248, v224, 0xc0135761
    v_fmaak_f32 v249, v249, v224, 0xc0135761
    v_fmaak_f32 v250, v250, v224, 0xc0135761
    v_fmaak_f32 v251, v251, v224, 0xc0135761
    v_fmaak_f32 v252, v252, v224, 0xc0135761
    v_fmaak_f32 v253, v253, v224, 0xc0135761
    v_fmaak_f32 v254, v254, v224, 0xc0135761
    v_fmaak_f32 v255, v255, v224, 0xc0135761
    v_mul_f32 v248, v248, v96
    v_mul_f32 v249, v249, v97
    v_mul_f32 v250, v250, v98
    v_mul_f32 v251, v251, v99
    v_mul_f32 v252, v252, v100
    v_mul_f32 v253, v253, v101
    v_mul_f32 v254, v254, v102
    v_mul_f32 v255, v255, v103
    v_exp_f32 v248, v248
    v_exp_f32 v249, v249
    v_exp_f32 v250, v250
    v_exp_f32 v251, v251
    v_exp_f32 v252, v252
    v_exp_f32 v253, v253
    v_exp_f32 v254, v254
    v_exp_f32 v255, v255
    v_add_f32 v248, 1.0, v248
    v_add_f32 v249, 1.0, v249
    v_add_f32 v250, 1.0, v250
    v_add_f32 v251, 1.0, v251
    v_add_f32 v252, 1.0, v252
    v_add_f32 v253, 1.0, v253
    v_add_f32 v254, 1.0, v254
    v_add_f32 v255, 1.0, v255
    v_rcp_f32 v248, v248
    v_rcp_f32 v249, v249
    v_rcp_f32 v250, v250
    v_rcp_f32 v251, v251
    v_rcp_f32 v252, v252
    v_rcp_f32 v253, v253
    v_rcp_f32 v254, v254
    v_rcp_f32 v255, v255
    v_mul_f32 v96, v96, v248
    v_mul_f32 v97, v97, v249
    v_mul_f32 v98, v98, v250
    v_mul_f32 v99, v99, v251
    v_mul_f32 v100, v100, v252
    v_mul_f32 v101, v101, v253
    v_mul_f32 v102, v102, v254
    v_mul_f32 v103, v103, v255
    v_cvt_pk_bf16_f32 v228, v96, v97
    v_cvt_pk_bf16_f32 v229, v98, v99
    v_cvt_pk_bf16_f32 v230, v100, v101
    v_cvt_pk_bf16_f32 v231, v102, v103
    s_add_u32 s81, s1, 0
    buffer_store_dwordx4 v[228:231], v1, s[28:31], s81 offen sc0 sc1
    v_mfma_f32_32x32x16_bf16 v[96:111], a[0:3], v[144:147], 0
    s_add_u32 m0, s58, 12288
    s_add_u32 s4, s63, 786432
    buffer_load_dwordx4 v59, s[24:27], s4 offen lds
    s_add_u32 m0, s58, 13312
    s_add_u32 s4, s63, 819200
    buffer_load_dwordx4 v59, s[24:27], s4 offen lds
    v_mfma_f32_32x32x16_bf16 v[112:127], a[4:7], v[144:147], 0
    s_add_u32 m0, s58, 14336
    s_add_u32 s4, s63, 851968
    buffer_load_dwordx4 v59, s[24:27], s4 offen lds
    s_add_u32 m0, s58, 15360
    s_add_u32 s4, s63, 884736
    buffer_load_dwordx4 v59, s[24:27], s4 offen lds
    v_mfma_f32_32x32x16_bf16 v[96:111], a[8:11], v[148:151], v[96:111]
    ds_write_b128 v10, v[80:83] offset:0
    v_mfma_f32_32x32x16_bf16 v[112:127], a[12:15], v[148:151], v[112:127]
    ds_write_b128 v10, v[84:87] offset:1024
    v_mfma_f32_32x32x16_bf16 v[96:111], a[16:19], v[152:155], v[96:111]
    s_waitcnt vmcnt(13)
    v_max3_u32 v63, v163, v167, v171
    v_max_u32 v63, v63, v175
    v_cmp_eq_u32 s[40:41], -1, v63
    ds_write_b128 v12, v[88:91] offset:0
    v_mfma_f32_32x32x16_bf16 v[112:127], a[20:23], v[152:155], v[112:127]
    s_cmp_lg_u64 s[40:41], 0
    s_cbranch_scc1 RT57
CD58:
    ds_write_b128 v12, v[92:95] offset:1024
    v_mfma_f32_32x32x16_bf16 v[96:111], a[24:27], v[156:159], v[96:111]
    ds_write_b128 v11, v[72:75] offset:0
    v_mfma_f32_32x32x16_bf16 v[112:127], a[28:31], v[156:159], v[112:127]
    ds_write_b128 v11, v[76:79] offset:1024
    v_mfma_f32_32x32x16_bf16 v[96:111], a[32:35], v[160:163], v[96:111]
    v_mfma_f32_32x32x16_bf16 v[112:127], a[36:39], v[160:163], v[112:127]
    v_mfma_f32_32x32x16_bf16 v[96:111], a[40:43], v[164:167], v[96:111]
    v_mfma_f32_32x32x16_bf16 v[112:127], a[44:47], v[164:167], v[112:127]
    s_waitcnt lgkmcnt(0)
    s_barrier
    ds_read_b128 v[224:227], v13 offset:0
    ds_read_b128 v[228:231], v13 offset:1024
    ds_read_b128 v[232:235], v13 offset:2048
    ds_read_b128 v[236:239], v13 offset:3072
    v_mfma_f32_32x32x16_bf16 v[96:111], a[48:51], v[168:171], v[96:111]
    s_waitcnt vmcnt(9)
    v_max3_u32 v63, v179, v183, v187
    v_max_u32 v63, v63, v191
    v_cmp_eq_u32 s[40:41], -1, v63
    ds_read_b128 v[240:243], v13 offset:4096
    v_mfma_f32_32x32x16_bf16 v[112:127], a[52:55], v[168:171], v[112:127]
    s_cmp_lg_u64 s[40:41], 0
    s_cbranch_scc1 RT59
CD60:
    ds_read_b128 v[244:247], v13 offset:5120
    v_mfma_f32_32x32x16_bf16 v[96:111], a[56:59], v[172:175], v[96:111]
    v_mfma_f32_32x32x16_bf16 v[112:127], a[60:63], v[172:175], v[112:127]
    v_mfma_f32_32x32x16_bf16 v[96:111], a[64:67], v[176:179], v[96:111]
    s_waitcnt lgkmcnt(0)
    v_add_f32 v224, v224, v232
    v_add_f32 v225, v225, v233
    v_add_f32 v226, v226, v234
    v_add_f32 v227, v227, v235
    v_add_f32 v228, v228, v236
    v_mfma_f32_32x32x16_bf16 v[112:127], a[68:71], v[176:179], v[112:127]
    v_add_f32 v229, v229, v237
    v_add_f32 v230, v230, v238
    v_add_f32 v231, v231, v239
    v_add_f32 v64, v64, v240
    v_add_f32 v65, v65, v241
    v_mfma_f32_32x32x16_bf16 v[96:111], a[72:75], v[180:183], v[96:111]
    v_add_f32 v66, v66, v242
    v_add_f32 v67, v67, v243
    v_add_f32 v68, v68, v244
    v_add_f32 v69, v69, v245
    v_add_f32 v70, v70, v246
    v_mfma_f32_32x32x16_bf16 v[112:127], a[76:79], v[180:183], v[112:127]
    v_add_f32 v71, v71, v247
    v_add_f32 v64, v64, v224
    v_add_f32 v65, v65, v225
    v_add_f32 v66, v66, v226
    v_add_f32 v67, v67, v227
    v_mfma_f32_32x32x16_bf16 v[96:111], a[80:83], v[184:187], v[96:111]
    s_waitcnt vmcnt(5)
    v_max3_u32 v63, v195, v199, v203
    v_max_u32 v63, v63, v207
    v_cmp_eq_u32 s[40:41], -1, v63
    v_add_f32 v68, v68, v228
    v_add_f32 v69, v69, v229
    v_mfma_f32_32x32x16_bf16 v[112:127], a[84:87], v[184:187], v[112:127]
    s_cmp_lg_u64 s[40:41], 0
    s_cbranch_scc1 RT61
CD62:
    v_add_f32 v70, v70, v230
    v_add_f32 v71, v71, v231
    v_cvt_pk_bf16_f32 v64, v64, v65
    v_cvt_pk_bf16_f32 v65, v66, v67
    v_mfma_f32_32x32x16_bf16 v[96:111], a[88:91], v[188:191], v[96:111]
    v_cvt_pk_bf16_f32 v66, v68, v69
    v_cvt_pk_bf16_f32 v67, v70, v71
    s_add_u32 s81, s57, 8192
    s_cmp_lg_u32 s79, 1
    s_cbranch_scc1 PL63
    buffer_store_dwordx4 v[64:67], v1, s[28:31], s81 offen
PE64:
    v_mfma_f32_32x32x16_bf16 v[112:127], a[92:95], v[188:191], v[112:127]
    v_mfma_f32_32x32x16_bf16 v[96:111], a[96:99], v[192:195], v[96:111]
    s_waitcnt vmcnt(1)
    ds_read_b64_tr_b16 a[224:225], v3 offset:12288
    ds_read_b64_tr_b16 a[226:227], v3 offset:13312
    ds_read_b64_tr_b16 a[228:229], v3 offset:12800
    ds_read_b64_tr_b16 a[230:231], v3 offset:13824
    v_mfma_f32_32x32x16_bf16 v[112:127], a[100:103], v[192:195], v[112:127]
    ds_read_b64_tr_b16 a[232:233], v3 offset:14336
    ds_read_b64_tr_b16 a[234:235], v3 offset:15360
    ds_read_b64_tr_b16 a[236:237], v3 offset:14848
    ds_read_b64_tr_b16 a[238:239], v3 offset:15872
    s_add_u32 s81, s82, 8192
    buffer_load_dwordx4 v[220:223], v1, s[28:31], s81 offen sc1
    v_mfma_f32_32x32x16_bf16 v[96:111], a[104:107], v[196:199], v[96:111]
    v_mfma_f32_32x32x16_bf16 v[112:127], a[108:111], v[196:199], v[112:127]
    v_mfma_f32_32x32x16_bf16 v[96:111], a[112:115], v[200:203], v[96:111]
    v_mfma_f32_32x32x16_bf16 v[112:127], a[116:119], v[200:203], v[112:127]
    v_mfma_f32_32x32x16_bf16 v[96:111], a[120:123], v[204:207], v[96:111]
    v_mfma_f32_32x32x16_bf16 v[112:127], a[124:127], v[204:207], v[112:127]
    s_nop 11
    ds_write_b128 v10, v[112:115] offset:6144
    ds_write_b128 v10, v[116:119] offset:7168
    ds_write_b128 v12, v[120:123] offset:6144
    ds_write_b128 v12, v[124:127] offset:7168
    ds_write_b128 v11, v[104:107] offset:6144
    ds_write_b128 v11, v[108:111] offset:7168
    v_pk_add_f32 v[96:97], v[96:97], v[48:49]
    v_pk_add_f32 v[98:99], v[98:99], v[50:51]
    buffer_load_dword v62, v15, s[28:31], s10 offen sc1
    v_pk_add_f32 v[100:101], v[100:101], v[52:53]
    v_pk_add_f32 v[102:103], v[102:103], v[54:55]
    s_waitcnt lgkmcnt(0)
    s_barrier
    ds_read_b128 v[224:227], v13 offset:6144
    ds_read_b128 v[228:231], v13 offset:7168
    ds_read_b128 v[232:235], v13 offset:8192
    ds_read_b128 v[236:239], v13 offset:9216
    ds_read_b128 v[240:243], v13 offset:10240
    s_add_u32 s77, s8, 0
    buffer_load_dwordx4 v[128:131], v8, s[28:31], s77 offen offset:0 sc1
    ds_read_b128 v[244:247], v13 offset:11264
    s_waitcnt lgkmcnt(0)
    v_pk_add_f32 v[224:225], v[224:225], v[232:233]
    v_pk_add_f32 v[226:227], v[226:227], v[234:235]
    v_pk_add_f32 v[228:229], v[228:229], v[236:237]
    v_pk_add_f32 v[230:231], v[230:231], v[238:239]
    v_pk_add_f32 v[96:97], v[96:97], v[240:241]
    v_pk_add_f32 v[98:99], v[98:99], v[242:243]
    buffer_load_dwordx4 v[132:135], v8, s[28:31], s77 offen offset:1024 sc1
    v_pk_add_f32 v[100:101], v[100:101], v[244:245]
    v_pk_add_f32 v[102:103], v[102:103], v[246:247]
    v_pk_add_f32 v[96:97], v[96:97], v[224:225]
    v_pk_add_f32 v[98:99], v[98:99], v[226:227]
    v_pk_add_f32 v[100:101], v[100:101], v[228:229]
    v_pk_add_f32 v[102:103], v[102:103], v[230:231]
    s_waitcnt vmcnt(3)
XR65:
    v_max_u32 v61, v221, v223
    v_cmp_eq_u32 vcc, -1, v61
    s_cbranch_vccz XK66
    s_add_u32 s81, s82, 8192
    buffer_load_dwordx4 v[220:223], v1, s[28:31], s81 offen sc1
    s_add_u32 s56, s56, 1
    s_cmp_gt_u32 s56, 200000
    s_waitcnt vmcnt(0)
    s_cbranch_scc0 XR65
XK66:
    buffer_load_dwordx4 v[136:139], v8, s[28:31], s77 offen offset:2048 sc1
    v_lshlrev_b32 v248, 16, v220
    v_and_b32 v249, 0xffff0000, v220
    v_lshlrev_b32 v250, 16, v221
    v_and_b32 v251, 0xffff0000, v221
    v_lshlrev_b32 v252, 16, v222
    v_and_b32 v253, 0xffff0000, v222
    v_lshlrev_b32 v254, 16, v223
    v_and_b32 v255, 0xffff0000, v223
    buffer_load_dwordx4 v[140:143], v8, s[28:31], s77 offen offset:3072 sc1
    v_pk_add_f32 v[96:97], v[96:97], v[248:249]
    v_pk_add_f32 v[98:99], v[98:99], v[250:251]
    v_pk_add_f32 v[100:101], v[100:101], v[252:253]
    v_pk_add_f32 v[102:103], v[102:103], v[254:255]
    v_pk_mul_f32 v[248:249], v[96:97], v[96:97]
    v_pk_mul_f32 v[250:251], v[98:99], v[98:99]
    v_pk_mul_f32 v[252:253], v[100:101], v[100:101]
    v_pk_mul_f32 v[254:255], v[102:103], v[102:103]
    s_add_u32 s77, s8, 4096
    buffer_load_dwordx4 v[144:147], v8, s[28:31], s77 offen offset:0 sc1
    v_mov_b32 v224, 0xc0135761
    v_mov_b32 v225, 0xc0135761
    v_pk_fma_f32 v[248:249], v[248:249], s[70:71], v[224:225]
    v_pk_fma_f32 v[250:251], v[250:251], s[70:71], v[224:225]
    v_pk_fma_f32 v[252:253], v[252:253], s[70:71], v[224:225]
    v_pk_fma_f32 v[254:255], v[254:255], s[70:71], v[224:225]
    v_pk_mul_f32 v[248:249], v[248:249], v[96:97]
    v_pk_mul_f32 v[250:251], v[250:251], v[98:99]
    buffer_load_dwordx4 v[148:151], v8, s[28:31], s77 offen offset:1024 sc1
    v_pk_mul_f32 v[252:253], v[252:253], v[100:101]
    v_pk_mul_f32 v[254:255], v[254:255], v[102:103]
    v_exp_f32 v248, v248
    v_exp_f32 v249, v249
    v_exp_f32 v250, v250
    v_exp_f32 v251, v251
    v_exp_f32 v252, v252
    v_exp_f32 v253, v253
    buffer_load_dwordx4 v[152:155], v8, s[28:31], s77 offen offset:2048 sc1
    v_exp_f32 v254, v254
    v_exp_f32 v255, v255
    v_pk_add_f32 v[248:249], v[248:249], s[72:73]
    v_pk_add_f32 v[250:251], v[250:251], s[72:73]
    v_pk_add_f32 v[252:253], v[252:253], s[72:73]
    v_pk_add_f32 v[254:255], v[254:255], s[72:73]
    v_rcp_f32 v248, v248
    v_rcp_f32 v249, v249
    buffer_load_dwordx4 v[156:159], v8, s[28:31], s77 offen offset:3072 sc1
    v_rcp_f32 v250, v250
    v_rcp_f32 v251, v251
    v_rcp_f32 v252, v252
    v_rcp_f32 v253, v253
    v_rcp_f32 v254, v254
    v_rcp_f32 v255, v255
    v_pk_mul_f32 v[96:97], v[96:97], v[248:249]
    v_pk_mul_f32 v[98:99], v[98:99], v[250:251]
    s_add_u32 s77, s8, 8192
    buffer_load_dwordx4 v[160:163], v8, s[28:31], s77 offen offset:0 sc1
    v_pk_mul_f32 v[100:101], v[100:101], v[252:253]
    v_pk_mul_f32 v[102:103], v[102:103], v[254:255]
    v_cvt_pk_bf16_f32 v228, v96, v97
    v_cvt_pk_bf16_f32 v229, v98, v99
    v_cvt_pk_bf16_f32 v230, v100, v101
    v_cvt_pk_bf16_f32 v231, v102, v103
    s_add_u32 s81, s1, 114688
    buffer_store_dwordx4 v[228:231], v1, s[28:31], s81 offen sc0 sc1
    buffer_load_dwordx4 v[164:167], v8, s[28:31], s77 offen offset:1024 sc1
    buffer_load_dwordx4 v[168:171], v8, s[28:31], s77 offen offset:2048 sc1
    buffer_load_dwordx4 v[172:175], v8, s[28:31], s77 offen offset:3072 sc1
    s_add_u32 s77, s8, 12288
    buffer_load_dwordx4 v[176:179], v8, s[28:31], s77 offen offset:0 sc1
    buffer_load_dwordx4 v[180:183], v8, s[28:31], s77 offen offset:1024 sc1
    s_add_u32 s77, s9, 0
    buffer_load_dwordx4 v[184:187], v8, s[28:31], s77 offen offset:0 sc1
    buffer_load_dwordx4 v[188:191], v8, s[28:31], s77 offen offset:1024 sc1
L_p4_0:
    v_mov_b32 v48, -1
    v_mov_b32 v49, -1
    v_mov_b32 v50, -1
    v_mov_b32 v51, -1
    v_lshlrev_b32 v52, 2, v0
    s_waitcnt lgkmcnt(0)
    v_bfe_u32 v58, v0, 2, 3
    v_mul_u32_u24 v58, 896, v58
    v_lshrrev_b32 v60, 5, v0
    v_lshl_add_u32 v58, v60, 6, v58
    v_and_b32 v60, 3, v0
    s_and_b32 s3, s48, 2
    v_xor_b32 v60, s3, v60
    v_lshl_add_u32 v58, v60, 4, v58
    s_waitcnt vmcnt(13)
    v_max3_u32 v63, v131, v135, v139
    v_max3_u32 v63, v63, v143, v62
    v_cmp_eq_u32 vcc, -1, v63
    s_cbranch_vccnz RT73
CD74:
    v_mfma_f32_32x32x16_bf16 v[64:79], v[128:131], a[128:131], 0
    buffer_load_dwordx4 v[192:195], v8, s[28:31], s77 offen offset:2048 sc1
    v_mfma_f32_32x32x16_bf16 v[80:95], v[128:131], a[132:135], 0
    v_mfma_f32_32x32x16_bf16 v[64:79], v[132:135], a[136:139], v[64:79]
    buffer_load_dwordx4 v[196:199], v8, s[28:31], s77 offen offset:3072 sc1
    v_mfma_f32_32x32x16_bf16 v[80:95], v[132:135], a[140:143], v[80:95]
    v_mfma_f32_32x32x16_bf16 v[64:79], v[136:139], a[144:147], v[64:79]
    s_add_u32 s77, s9, 4096
    buffer_load_dwordx4 v[200:203], v8, s[28:31], s77 offen offset:0 sc1
    s_waitcnt vmcnt(12)
    v_max3_u32 v63, v147, v151, v155
    v_max_u32 v63, v63, v159
    v_mfma_f32_32x32x16_bf16 v[80:95], v[136:139], a[148:151], v[80:95]
    v_cmp_eq_u32 s[40:41], -1, v63
    v_mfma_f32_32x32x16_bf16 v[64:79], v[140:143], a[152:155], v[64:79]
    buffer_load_dwordx4 v[204:207], v8, s[28:31], s77 offen offset:1024 sc1
    s_cmp_lg_u64 s[40:41], 0
    s_cbranch_scc1 RT75
CD76:
    v_mfma_f32_32x32x16_bf16 v[80:95], v[140:143], a[156:159], v[80:95]
    v_mfma_f32_32x32x16_bf16 v[64:79], v[144:147], a[160:163], v[64:79]
    buffer_load_dwordx4 v[208:211], v8, s[28:31], s77 offen offset:2048 sc1
    v_mfma_f32_32x32x16_bf16 v[80:95], v[144:147], a[164:167], v[80:95]
    v_mfma_f32_32x32x16_bf16 v[64:79], v[148:151], a[168:171], v[64:79]
    buffer_load_dwordx4 v[212:215], v8, s[28:31], s77 offen offset:3072 sc1
    v_mfma_f32_32x32x16_bf16 v[80:95], v[148:151], a[172:175], v[80:95]
    v_mfma_f32_32x32x16_bf16 v[64:79], v[152:155], a[176:179], v[64:79]
    s_add_u32 s77, s9, 8192
    buffer_load_dwordx4 v[128:131], v8, s[28:31], s77 offen offset:0 sc1
    s_waitcnt vmcnt(11)
    v_max3_u32 v63, v163, v167, v171
    v_max_u32 v63, v63, v175
    v_mfma_f32_32x32x16_bf16 v[80:95], v[152:155], a[180:183], v[80:95]
    v_cmp_eq_u32 s[40:41], -1, v63
    v_mfma_f32_32x32x16_bf16 v[64:79], v[156:159], a[184:187], v[64:79]
    buffer_load_dwordx4 v[132:135], v8, s[28:31], s77 offen offset:1024 sc1
    s_cmp_lg_u64 s[40:41], 0
    s_cbranch_scc1 RT77
CD78:
    v_mfma_f32_32x32x16_bf16 v[80:95], v[156:159], a[188:191], v[80:95]
    v_mfma_f32_32x32x16_bf16 v[64:79], v[160:163], a[192:195], v[64:79]
    buffer_load_dwordx4 v[136:139], v8, s[28:31], s77 offen offset:2048 sc1
    v_mfma_f32_32x32x16_bf16 v[80:95], v[160:163], a[196:199], v[80:95]
    v_mfma_f32_32x32x16_bf16 v[64:79], v[164:167], a[200:203], v[64:79]
    buffer_load_dwordx4 v[140:143], v8, s[28:31], s77 offen offset:3072 sc1
    v_mfma_f32_32x32x16_bf16 v[80:95], v[164:167], a[204:207], v[80:95]
    v_mfma_f32_32x32x16_bf16 v[64:79], v[168:171], a[208:211], v[64:79]
    s_add_u32 s77, s9, 12288
    buffer_load_dwordx4 v[144:147], v8, s[28:31], s77 offen offset:0 sc1
    s_waitcnt vmcnt(11)
    v_max3_u32 v63, v179, v183, v187
    v_max_u32 v63, v63, v191
    v_mfma_f32_32x32x16_bf16 v[80:95], v[168:171], a[212:215], v[80:95]
    v_cmp_eq_u32 s[40:41], -1, v63
    v_mfma_f32_32x32x16_bf16 v[64:79], v[172:175], a[216:219], v[64:79]
    buffer_load_dwordx4 v[148:151], v8, s[28:31], s77 offen offset:1024 sc1
    s_cmp_lg_u64 s[40:41], 0
    s_cbranch_scc1 RT79
CD80:
    v_mfma_f32_32x32x16_bf16 v[80:95], v[172:175], a[220:223], v[80:95]
    v_mfma_f32_32x32x16_bf16 v[64:79], v[176:179], a[224:227], v[64:79]
    s_add_u32 s77, s8, 114688
    buffer_load_dwordx4 v[152:155], v8, s[28:31], s77 offen offset:0 sc1
    v_mfma_f32_32x32x16_bf16 v[80:95], v[176:179], a[228:231], v[80:95]
    v_mfma_f32_32x32x16_bf16 v[64:79], v[180:183], a[232:235], v[64:79]
    buffer_load_dwordx4 v[156:159], v8, s[28:31], s77 offen offset:1024 sc1
    v_mfma_f32_32x32x16_bf16 v[80:95], v[180:183], a[236:239], v[80:95]
    v_mfma_f32_32x32x16_bf16 v[96:111], v[184:187], a[128:131], 0
    buffer_load_dwordx4 v[160:163], v8, s[28:31], s77 offen offset:2048 sc1
    s_waitcnt vmcnt(11)
    v_max3_u32 v63, v195, v199, v203
    v_max_u32 v63, v63, v207
    v_mfma_f32_32x32x16_bf16 v[112:127], v[184:187], a[132:135], 0
    v_cmp_eq_u32 s[40:41], -1, v63
    v_mfma_f32_32x32x16_bf16 v[96:111], v[188:191], a[136:139], v[96:111]
    buffer_load_dwordx4 v[164:167], v8, s[28:31], s77 offen offset:3072 sc1
    s_cmp_lg_u64 s[40:41], 0
    s_cbranch_scc1 RT81
CD82:
    ds_write_b128 v10, v[80:83] offset:0
    v_mfma_f32_32x32x16_bf16 v[112:127], v[188:191], a[140:143], v[112:127]
    ds_write_b128 v10, v[84:87] offset:1024
    v_mfma_f32_32x32x16_bf16 v[96:111], v[192:195], a[144:147], v[96:111]
    s_add_u32 s77, s8, 118784
    buffer_load_dwordx4 v[168:171], v8, s[28:31], s77 offen offset:0 sc1
    ds_write_b128 v12, v[88:91] offset:0
    v_mfma_f32_32x32x16_bf16 v[112:127], v[192:195], a[148:151], v[112:127]
    ds_write_b128 v12, v[92:95] offset:1024
    v_mfma_f32_32x32x16_bf16 v[96:111], v[196:199], a[152:155], v[96:111]
    buffer_load_dwordx4 v[172:175], v8, s[28:31], s77 offen offset:1024 sc1
    ds_write_b128 v11, v[72:75] offset:0
    v_mfma_f32_32x32x16_bf16 v[112:127], v[196:199], a[156:159], v[112:127]
    ds_write_b128 v11, v[76:79] offset:1024
    v_mfma_f32_32x32x16_bf16 v[96:111], v[200:203], a[160:163], v[96:111]
    buffer_load_dwordx4 v[176:179], v8, s[28:31], s77 offen offset:2048 sc1
    s_waitcnt vmcnt(11)
    v_max3_u32 v63, v211, v215, v131
    v_max_u32 v63, v63, v135
    v_mfma_f32_32x32x16_bf16 v[112:127], v[200:203], a[164:167], v[112:127]
    v_cmp_eq_u32 s[40:41], -1, v63
    v_mfma_f32_32x32x16_bf16 v[96:111], v[204:207], a[168:171], v[96:111]
    buffer_load_dwordx4 v[180:183], v8, s[28:31], s77 offen offset:3072 sc1
    s_cmp_lg_u64 s[40:41], 0
    s_cbranch_scc1 RT83
CD84:
    v_mfma_f32_32x32x16_bf16 v[112:127], v[204:207], a[172:175], v[112:127]
    s_waitcnt lgkmcnt(0)
    s_barrier
    ds_read_b128 v[224:227], v13 offset:0
    ds_read_b128 v[228:231], v13 offset:1024
    ds_read_b128 v[232:235], v13 offset:2048
    ds_read_b128 v[236:239], v13 offset:3072
    v_mfma_f32_32x32x16_bf16 v[96:111], v[208:211], a[176:179], v[96:111]
    s_add_u32 s77, s8, 122880
    buffer_load_dwordx4 v[184:187], v8, s[28:31], s77 offen offset:0 sc1
    ds_read_b128 v[240:243], v13 offset:4096
    ds_read_b128 v[244:247], v13 offset:5120
    v_mfma_f32_32x32x16_bf16 v[112:127], v[208:211], a[180:183], v[112:127]
    v_mfma_f32_32x32x16_bf16 v[96:111], v[212:215], a[184:187], v[96:111]
    buffer_load_dwordx4 v[188:191], v8, s[28:31], s77 offen offset:1024 sc1
    v_mfma_f32_32x32x16_bf16 v[112:127], v[212:215], a[188:191], v[112:127]
    s_waitcnt lgkmcnt(0)
    v_add_f32 v224, v224, v232
    v_add_f32 v225, v225, v233
    v_add_f32 v226, v226, v234
    v_add_f32 v227, v227, v235
    v_add_f32 v228, v228, v236
    v_mfma_f32_32x32x16_bf16 v[96:111], v[128:131], a[192:195], v[96:111]
    buffer_load_dwordx4 v[192:195], v8, s[28:31], s77 offen offset:2048 sc1
    s_waitcnt vmcnt(11)
    v_max3_u32 v63, v139, v143, v147
    v_max_u32 v63, v63, v151
    v_mfma_f32_32x32x16_bf16 v[112:127], v[128:131], a[196:199], v[112:127]
    v_cmp_eq_u32 s[40:41], -1, v63
    v_add_f32 v229, v229, v237
    v_add_f32 v230, v230, v238
    v_add_f32 v231, v231, v239
    v_add_f32 v64, v64, v240
    v_mfma_f32_32x32x16_bf16 v[96:111], v[132:135], a[200:203], v[96:111]
    buffer_load_dwordx4 v[196:199], v8, s[28:31], s77 offen offset:3072 sc1
    s_cmp_lg_u64 s[40:41], 0
    s_cbranch_scc1 RT85
CD86:
    v_add_f32 v65, v65, v241
    v_add_f32 v66, v66, v242
    v_mfma_f32_32x32x16_bf16 v[112:127], v[132:135], a[204:207], v[112:127]
    v_add_f32 v67, v67, v243
    v_add_f32 v68, v68, v244
    v_add_f32 v69, v69, v245
    v_add_f32 v70, v70, v246
    v_add_f32 v71, v71, v247
    s_add_u32 s78, s10, 114688
    v_mfma_f32_32x32x16_bf16 v[96:111], v[136:139], a[208:211], v[96:111]
    s_add_u32 s77, s8, 126976
    buffer_load_dwordx4 v[200:203], v8, s[28:31], s77 offen offset:0 sc1
    v_add_f32 v64, v64, v224
    v_add_f32 v65, v65, v225
    v_add_f32 v66, v66, v226
    v_mfma_f32_32x32x16_bf16 v[112:127], v[136:139], a[212:215], v[112:127]
    v_add_f32 v67, v67, v227
    v_add_f32 v68, v68, v228
    v_add_f32 v69, v69, v229
    v_add_f32 v70, v70, v230
    v_add_f32 v71, v71, v231
    v_mfma_f32_32x32x16_bf16 v[96:111], v[140:143], a[216:219], v[96:111]
    buffer_load_dwordx4 v[204:207], v8, s[28:31], s77 offen offset:1024 sc1
    v_cvt_pk_bf16_f32 v64, v64, v65
    v_cvt_pk_bf16_f32 v65, v66, v67
    v_cvt_pk_bf16_f32 v66, v68, v69
    v_mfma_f32_32x32x16_bf16 v[112:127], v[140:143], a[220:223], v[112:127]
    v_cvt_pk_bf16_f32 v67, v70, v71
    s_add_u32 s81, s57, 4194304
    s_cmp_lg_u32 s79, 1
    s_cbranch_scc1 PL89
    buffer_store_dwordx4 v[64:67], v1, s[28:31], s81 offen
PE90:
    v_mfma_f32_32x32x16_bf16 v[96:111], v[144:147], a[224:227], v[96:111]
    s_add_u32 s77, s9, 114688
    buffer_load_dwordx4 v[208:211], v8, s[28:31], s77 offen offset:0 sc1
    s_waitcnt vmcnt(12)
    v_max3_u32 v63, v155, v159, v163
    v_max_u32 v63, v63, v167
    v_mfma_f32_32x32x16_bf16 v[112:127], v[144:147], a[228:231], v[112:127]
    v_cmp_eq_u32 s[40:41], -1, v63
    v_mfma_f32_32x32x16_bf16 v[96:111], v[148:151], a[232:235], v[96:111]
    buffer_load_dwordx4 v[212:215], v8, s[28:31], s77 offen offset:1024 sc1
    s_cmp_lg_u64 s[40:41], 0
    s_cbranch_scc1 RT87
CD88:
    v_mfma_f32_32x32x16_bf16 v[112:127], v[148:151], a[236:239], v[112:127]
    v_mfma_f32_32x32x16_bf16 v[64:79], v[152:155], a[128:131], 0
    buffer_load_dwordx4 v[128:131], v8, s[28:31], s77 offen offset:2048 sc1
    v_mfma_f32_32x32x16_bf16 v[80:95], v[152:155], a[132:135], 0
    v_mfma_f32_32x32x16_bf16 v[64:79], v[156:159], a[136:139], v[64:79]
    buffer_load_dwordx4 v[132:135], v8, s[28:31], s77 offen offset:3072 sc1
    ds_write_b128 v10, v[112:115] offset:6144
    v_mfma_f32_32x32x16_bf16 v[80:95], v[156:159], a[140:143], v[80:95]
    ds_write_b128 v10, v[116:119] offset:7168
    v_mfma_f32_32x32x16_bf16 v[64:79], v[160:163], a[144:147], v[64:79]
    s_add_u32 s77, s9, 118784
    buffer_load_dwordx4 v[136:139], v8, s[28:31], s77 offen offset:0 sc1
    s_waitcnt vmcnt(12)
    v_max3_u32 v63, v171, v175, v179
    v_max_u32 v63, v63, v183
    v_mfma_f32_32x32x16_bf16 v[80:95], v[160:163], a[148:151], v[80:95]
    v_cmp_eq_u32 s[40:41], -1, v63
    ds_write_b128 v12, v[120:123] offset:6144
    v_mfma_f32_32x32x16_bf16 v[64:79], v[164:167], a[152:155], v[64:79]
    buffer_load_dwordx4 v[140:143], v8, s[28:31], s77 offen offset:1024 sc1
    s_cmp_lg_u64 s[40:41], 0
    s_cbranch_scc1 RT91
CD92:
    ds_write_b128 v12, v[124:127] offset:7168
    v_mfma_f32_32x32x16_bf16 v[80:95], v[164:167], a[156:159], v[80:95]
    ds_write_b128 v11, v[104:107] offset:6144
    v_mfma_f32_32x32x16_bf16 v[64:79], v[168:171], a[160:163], v[64:79]
    buffer_load_dwordx4 v[144:147], v8, s[28:31], s77 offen offset:2048 sc1
    ds_write_b128 v11, v[108:111] offset:7168
    v_mfma_f32_32x32x16_bf16 v[80:95], v[168:171], a[164:167], v[80:95]
    v_add_f32 v96, v96, v32
    v_add_f32 v97, v97, v33
    v_add_f32 v98, v98, v34
    v_add_f32 v99, v99, v35
    v_add_f32 v100, v100, v36
    v_mfma_f32_32x32x16_bf16 v[64:79], v[172:175], a[168:171], v[64:79]
    buffer_load_dwordx4 v[148:151], v8, s[28:31], s77 offen offset:3072 sc1
    v_add_f32 v101, v101, v37
    v_add_f32 v102, v102, v38
    v_add_f32 v103, v103, v39
    v_mfma_f32_32x32x16_bf16 v[80:95], v[172:175], a[172:175], v[80:95]
    v_add_f32 v96, v7, v96
    v_add_f32 v97, v7, v97
    v_add_f32 v98, v7, v98
    v_add_f32 v99, v7, v99
    v_add_f32 v100, v7, v100
    v_mfma_f32_32x32x16_bf16 v[64:79], v[176:179], a[176:179], v[64:79]
    s_add_u32 s77, s9, 122880
    buffer_load_dwordx4 v[152:155], v8, s[28:31], s77 offen offset:0 sc1
    s_waitcnt vmcnt(12)
    v_max3_u32 v63, v187, v191, v195
    v_max_u32 v63, v63, v199
    v_mfma_f32_32x32x16_bf16 v[80:95], v[176:179], a[180:183], v[80:95]
    v_cmp_eq_u32 s[40:41], -1, v63
    v_add_f32 v101, v7, v101
    v_add_f32 v102, v7, v102
    v_add_f32 v103, v7, v103
    v_mfma_f32_32x32x16_bf16 v[64:79], v[180:183], a[184:187], v[64:79]
    buffer_load_dwordx4 v[156:159], v8, s[28:31], s77 offen offset:1024 sc1
    s_cmp_lg_u64 s[40:41], 0
    s_cbranch_scc1 RT93
CD94:
    v_mfma_f32_32x32x16_bf16 v[80:95], v[180:183], a[188:191], v[80:95]
    v_mfma_f32_32x32x16_bf16 v[64:79], v[184:187], a[192:195], v[64:79]
    buffer_load_dwordx4 v[160:163], v8, s[28:31], s77 offen offset:2048 sc1
    v_mfma_f32_32x32x16_bf16 v[80:95], v[184:187], a[196:199], v[80:95]
    s_waitcnt lgkmcnt(0)
    s_barrier
    ds_read_b128 v[224:227], v13 offset:6144
    ds_read_b128 v[228:231], v13 offset:7168
    ds_read_b128 v[232:235], v13 offset:8192
    ds_read_b128 v[236:239], v13 offset:9216
    v_mfma_f32_32x32x16_bf16 v[64:79], v[188:191], a[200:203], v[64:79]
    buffer_load_dwordx4 v[164:167], v8, s[28:31], s77 offen offset:3072 sc1
    ds_read_b128 v[240:243], v13 offset:10240
    ds_read_b128 v[244:247], v13 offset:11264
    v_mfma_f32_32x32x16_bf16 v[80:95], v[188:191], a[204:207], v[80:95]
    s_add_u32 s81, s83, 4194304
    buffer_load_dwordx4 v[216:219], v1, s[28:31], s81 offen sc1
    v_mfma_f32_32x32x16_bf16 v[64:79], v[192:195], a[208:211], v[64:79]
    s_add_u32 s77, s9, 126976
    buffer_load_dwordx4 v[168:171], v8, s[28:31], s77 offen offset:0 sc1
    s_waitcnt vmcnt(12)
    v_max3_u32 v63, v203, v207, v211
    v_max_u32 v63, v63, v215
    v_mfma_f32_32x32x16_bf16 v[80:95], v[192:195], a[212:215], v[80:95]
    v_cmp_eq_u32 s[40:41], -1, v63
    s_waitcnt lgkmcnt(0)
    v_add_f32 v224, v224, v232
    v_add_f32 v225, v225, v233
    v_add_f32 v226, v226, v234
    v_add_f32 v227, v227, v235
    v_mfma_f32_32x32x16_bf16 v[64:79], v[196:199], a[216:219], v[64:79]
    buffer_load_dwordx4 v[172:175], v8, s[28:31], s77 offen offset:1024 sc1
    s_cmp_lg_u64 s[40:41], 0
    s_cbranch_scc1 RT95
CD96:
    v_add_f32 v228, v228, v236
    v_add_f32 v229, v229, v237
    v_mfma_f32_32x32x16_bf16 v[80:95], v[196:199], a[220:223], v[80:95]
    v_add_f32 v230, v230, v238
    v_add_f32 v231, v231, v239
    v_add_f32 v96, v96, v240
    v_add_f32 v97, v97, v241
    v_add_f32 v98, v98, v242
    v_mfma_f32_32x32x16_bf16 v[64:79], v[200:203], a[224:227], v[64:79]
    s_add_u32 s4, s74, 229376
    s_cmp_lg_u32 s79, 1
    s_cbranch_scc1 PL99
    buffer_store_dword v48, v52, s[28:31], s4 offen offset:0
PE100:
    v_add_f32 v99, v99, v243
    v_add_f32 v100, v100, v244
    v_add_f32 v101, v101, v245
    v_mfma_f32_32x32x16_bf16 v[80:95], v[200:203], a[228:231], v[80:95]
    v_add_f32 v102, v102, v246
    v_add_f32 v103, v103, v247
    v_add_f32 v32, v96, v224
    v_add_f32 v33, v97, v225
    v_add_f32 v34, v98, v226
    v_mfma_f32_32x32x16_bf16 v[64:79], v[204:207], a[232:235], v[64:79]
    s_add_u32 s4, s61, 1835008
    buffer_store_dwordx4 v[48:51], v1, s[28:31], s4 offen offset:0 sc0 sc1
    v_add_f32 v35, v99, v227
    v_add_f32 v36, v100, v228
    v_add_f32 v37, v101, v229
    v_mfma_f32_32x32x16_bf16 v[80:95], v[204:207], a[236:239], v[80:95]
    v_add_f32 v38, v102, v230
    v_add_f32 v39, v103, v231
    v_mfma_f32_32x32x16_bf16 v[96:111], v[208:211], a[128:131], 0
    s_add_u32 s4, s61, 1835008
    buffer_store_dwordx4 v[48:51], v1, s[28:31], s4 offen offset:1024 sc0 sc1
    s_waitcnt vmcnt(12)
    v_max3_u32 v63, v131, v135, v139
    v_max_u32 v63, v63, v143
    v_mfma_f32_32x32x16_bf16 v[112:127], v[208:211], a[132:135], 0
    v_cmp_eq_u32 s[40:41], -1, v63
    v_mfma_f32_32x32x16_bf16 v[96:111], v[212:215], a[136:139], v[96:111]
    s_add_u32 s4, s1, 1605632
    buffer_store_dwordx4 v[48:51], v1, s[28:31], s4 offen offset:0 sc0 sc1
    s_cmp_lg_u64 s[40:41], 0
    s_cbranch_scc1 RT97
CD98:
    ds_write_b128 v10, v[80:83] offset:0
    v_mfma_f32_32x32x16_bf16 v[112:127], v[212:215], a[140:143], v[112:127]
    ds_write_b128 v10, v[84:87] offset:1024
    v_mfma_f32_32x32x16_bf16 v[96:111], v[128:131], a[144:147], v[96:111]
    s_add_u32 s4, s1, 1720320
    buffer_store_dwordx4 v[48:51], v1, s[28:31], s4 offen offset:0 sc0 sc1
    ds_write_b128 v12, v[88:91] offset:0
    v_mfma_f32_32x32x16_bf16 v[112:127], v[128:131], a[148:151], v[112:127]
    ds_write_b128 v12, v[92:95] offset:1024
    v_mfma_f32_32x32x16_bf16 v[96:111], v[132:135], a[152:155], v[96:111]
    s_add_u32 s4, s57, 8388608
    s_cmp_lg_u32 s79, 1
    s_cbranch_scc1 PL105
    buffer_store_dwordx4 v[48:51], v1, s[28:31], s4 offen offset:0
PE106:
    ds_write_b128 v11, v[72:75] offset:0
    v_mfma_f32_32x32x16_bf16 v[112:127], v[132:135], a[156:159], v[112:127]
    ds_write_b128 v11, v[76:79] offset:1024
    v_mfma_f32_32x32x16_bf16 v[96:111], v[136:139], a[160:163], v[96:111]
    s_add_u32 s4, s57, 8396800
    s_cmp_lg_u32 s79, 1
    s_cbranch_scc1 PL107
    buffer_store_dwordx4 v[48:51], v1, s[28:31], s4 offen offset:0
PE108:
    s_waitcnt vmcnt(12)
    v_max3_u32 v63, v147, v151, v155
    v_max_u32 v63, v63, v159
    v_mfma_f32_32x32x16_bf16 v[112:127], v[136:139], a[164:167], v[112:127]
    v_cmp_eq_u32 s[40:41], -1, v63
    v_mfma_f32_32x32x16_bf16 v[96:111], v[140:143], a[168:171], v[96:111]
    s_add_u32 s4, s57, 12582912
    s_cmp_lg_u32 s79, 1
    s_cbranch_scc1 PL109
    buffer_store_dwordx4 v[48:51], v1, s[28:31], s4 offen offset:0
PE110:
    s_cmp_lg_u64 s[40:41], 0
    s_cbranch_scc1 RT103
CD104:
    v_mfma_f32_32x32x16_bf16 v[112:127], v[140:143], a[172:175], v[112:127]
    s_waitcnt lgkmcnt(0)
    s_barrier
    ds_read_b128 v[224:227], v13 offset:0
    ds_read_b128 v[228:231], v13 offset:1024
    ds_read_b128 v[232:235], v13 offset:2048
    ds_read_b128 v[236:239], v13 offset:3072
    v_mfma_f32_32x32x16_bf16 v[96:111], v[144:147], a[176:179], v[96:111]
    s_add_u32 s4, s57, 12591104
    s_cmp_lg_u32 s79, 1
    s_cbranch_scc1 PL113
    buffer_store_dwordx4 v[48:51], v1, s[28:31], s4 offen offset:0
PE114:
    ds_read_b128 v[240:243], v13 offset:4096
    ds_read_b128 v[244:247], v13 offset:5120
    v_mfma_f32_32x32x16_bf16 v[112:127], v[144:147], a[180:183], v[112:127]
    v_mfma_f32_32x32x16_bf16 v[96:111], v[148:151], a[184:187], v[96:111]
    v_mfma_f32_32x32x16_bf16 v[112:127], v[148:151], a[188:191], v[112:127]
    s_waitcnt lgkmcnt(0)
    v_add_f32 v224, v224, v232
    v_add_f32 v225, v225, v233
    v_add_f32 v226, v226, v234
    v_add_f32 v227, v227, v235
    v_add_f32 v228, v228, v236
    v_mfma_f32_32x32x16_bf16 v[96:111], v[152:155], a[192:195], v[96:111]
    s_waitcnt vmcnt(9)
    v_max3_u32 v63, v163, v167, v171
    v_max_u32 v63, v63, v175
    v_cmp_eq_u32 s[40:41], -1, v63
    v_add_f32 v229, v229, v237
    v_add_f32 v230, v230, v238
    v_mfma_f32_32x32x16_bf16 v[112:127], v[152:155], a[196:199], v[112:127]
    s_cmp_lg_u64 s[40:41], 0
    s_cbranch_scc1 RT111
CD112:
    v_add_f32 v231, v231, v239
    v_add_f32 v64, v64, v240
    v_add_f32 v65, v65, v241
    v_add_f32 v66, v66, v242
    v_mfma_f32_32x32x16_bf16 v[96:111], v[156:159], a[200:203], v[96:111]
    v_add_f32 v67, v67, v243
    v_add_f32 v68, v68, v244
    v_add_f32 v69, v69, v245
    v_add_f32 v70, v70, v246
    v_add_f32 v71, v71, v247
    v_mfma_f32_32x32x16_bf16 v[112:127], v[156:159], a[204:207], v[112:127]
    v_add_f32 v64, v64, v224
    v_add_f32 v65, v65, v225
    v_add_f32 v66, v66, v226
    v_add_f32 v67, v67, v227
    v_add_f32 v68, v68, v228
    v_mfma_f32_32x32x16_bf16 v[96:111], v[160:163], a[208:211], v[96:111]
    v_add_f32 v69, v69, v229
    v_add_f32 v70, v70, v230
    v_add_f32 v71, v71, v231
    v_cvt_pk_bf16_f32 v64, v64, v65
    v_cvt_pk_bf16_f32 v65, v66, v67
    v_mfma_f32_32x32x16_bf16 v[112:127], v[160:163], a[212:215], v[112:127]
    v_cvt_pk_bf16_f32 v66, v68, v69
    v_cvt_pk_bf16_f32 v67, v70, v71
    s_add_u32 s81, s57, 4202496
    s_cmp_lg_u32 s79, 1
    s_cbranch_scc1 PL115
    buffer_store_dwordx4 v[64:67], v1, s[28:31], s81 offen
PE116:
    s_add_u32 s81, s83, 4202496
    buffer_load_dwordx4 v[220:223], v1, s[28:31], s81 offen sc1
    v_mfma_f32_32x32x16_bf16 v[96:111], v[164:167], a[216:219], v[96:111]
    v_max_u32 v61, v217, v219
    v_cmp_eq_u32 s[42:43], -1, v61
    v_mfma_f32_32x32x16_bf16 v[112:127], v[164:167], a[220:223], v[112:127]
    s_cmp_lg_u64 s[42:43], 0
    s_cbranch_scc1 RT101
CD102:
    v_lshlrev_b32 v248, 16, v216
    v_and_b32 v249, 0xffff0000, v216
    v_lshlrev_b32 v250, 16, v217
    v_and_b32 v251, 0xffff0000, v217
    v_mfma_f32_32x32x16_bf16 v[96:111], v[168:171], a[224:227], v[96:111]
    v_lshlrev_b32 v252, 16, v218
    v_and_b32 v253, 0xffff0000, v218
    v_lshlrev_b32 v254, 16, v219
    v_and_b32 v255, 0xffff0000, v219
    v_add_f32 v32, v32, v248
    v_mfma_f32_32x32x16_bf16 v[112:127], v[168:171], a[228:231], v[112:127]
    v_add_f32 v33, v33, v249
    v_add_f32 v34, v34, v250
    v_add_f32 v35, v35, v251
    v_add_f32 v36, v36, v252
    v_add_f32 v37, v37, v253
    v_mfma_f32_32x32x16_bf16 v[96:111], v[172:175], a[232:235], v[96:111]
    v_add_f32 v38, v38, v254
    v_add_f32 v39, v39, v255
    v_cvt_pk_bf16_f32 v228, v32, v33
    v_cvt_pk_bf16_f32 v229, v34, v35
    v_cvt_pk_bf16_f32 v230, v36, v37
    v_mfma_f32_32x32x16_bf16 v[112:127], v[172:175], a[236:239], v[112:127]
    v_cvt_pk_bf16_f32 v231, v38, v39
    s_cmp_lg_u32 s79, 1
    s_cbranch_scc1 PL117
    buffer_store_dwordx4 v[228:231], v1, s[28:31], s0 offen offset:0
PE118:
    v_lshlrev_b32 v32, 16, v228
    v_and_b32 v33, 0xffff0000, v228
    v_lshlrev_b32 v34, 16, v229
    v_and_b32 v35, 0xffff0000, v229
    v_lshlrev_b32 v36, 16, v230
    v_and_b32 v37, 0xffff0000, v230
    v_lshlrev_b32 v38, 16, v231
    v_and_b32 v39, 0xffff0000, v231
    s_mul_i32 s80, s5, 28672
    s_add_u32 s80, s80, 13172736
    ds_write_b128 v10, v[112:115] offset:6144
    ds_write_b128 v10, v[116:119] offset:7168
    ds_write_b128 v12, v[120:123] offset:6144
    ds_write_b128 v12, v[124:127] offset:7168
    ds_write_b128 v11, v[104:107] offset:6144
    ds_write_b128 v11, v[108:111] offset:7168
    v_pk_add_f32 v[96:97], v[96:97], v[40:41]
    v_pk_add_f32 v[98:99], v[98:99], v[42:43]
    v_pk_add_f32 v[100:101], v[100:101], v[44:45]
    v_pk_add_f32 v[102:103], v[102:103], v[46:47]
    v_add_f32 v96, v7, v96
    v_add_f32 v97, v7, v97
    v_add_f32 v98, v7, v98
    v_add_f32 v99, v7, v99
    v_add_f32 v100, v7, v100
    v_add_f32 v101, v7, v101
    v_add_f32 v102, v7, v102
    v_add_f32 v103, v7, v103
    s_waitcnt lgkmcnt(0)
    s_barrier
    ds_read_b128 v[224:227], v13 offset:6144
    ds_read_b128 v[228:231], v13 offset:7168
    ds_read_b128 v[232:235], v13 offset:8192
    ds_read_b128 v[236:239], v13 offset:9216
    ds_read_b128 v[240:243], v13 offset:10240
    ds_read_b128 v[244:247], v13 offset:11264
    s_waitcnt lgkmcnt(0)
    v_pk_add_f32 v[224:225], v[224:225], v[232:233]
    v_pk_add_f32 v[226:227], v[226:227], v[234:235]
    v_pk_add_f32 v[228:229], v[228:229], v[236:237]
    v_pk_add_f32 v[230:231], v[230:231], v[238:239]
    v_pk_add_f32 v[96:97], v[96:97], v[240:241]
    v_pk_add_f32 v[98:99], v[98:99], v[242:243]
    v_pk_add_f32 v[100:101], v[100:101], v[244:245]
    v_pk_add_f32 v[102:103], v[102:103], v[246:247]
    v_pk_add_f32 v[40:41], v[96:97], v[224:225]
    v_pk_add_f32 v[42:43], v[98:99], v[226:227]
    v_pk_add_f32 v[44:45], v[100:101], v[228:229]
    v_pk_add_f32 v[46:47], v[102:103], v[230:231]
    s_waitcnt vmcnt(1)
XR119:
    v_max_u32 v61, v221, v223
    v_cmp_eq_u32 vcc, -1, v61
    s_cbranch_vccz XK120
    s_add_u32 s81, s83, 4202496
    buffer_load_dwordx4 v[220:223], v1, s[28:31], s81 offen sc1
    s_add_u32 s56, s56, 1
    s_cmp_gt_u32 s56, 200000
    s_waitcnt vmcnt(0)
    s_cbranch_scc0 XR119
XK120:
    v_lshlrev_b32 v248, 16, v220
    v_and_b32 v249, 0xffff0000, v220
    v_lshlrev_b32 v250, 16, v221
    v_and_b32 v251, 0xffff0000, v221
    v_lshlrev_b32 v252, 16, v222
    v_and_b32 v253, 0xffff0000, v222
    v_lshlrev_b32 v254, 16, v223
    v_and_b32 v255, 0xffff0000, v223
    v_pk_add_f32 v[40:41], v[40:41], v[248:249]
    v_pk_add_f32 v[42:43], v[42:43], v[250:251]
    v_pk_add_f32 v[44:45], v[44:45], v[252:253]
    v_pk_add_f32 v[46:47], v[46:47], v[254:255]
    v_cvt_pk_bf16_f32 v232, v40, v41
    v_cvt_pk_bf16_f32 v233, v42, v43
    v_cvt_pk_bf16_f32 v234, v44, v45
    v_cvt_pk_bf16_f32 v235, v46, v47
    s_cmp_lg_u32 s79, 1
    s_cbranch_scc1 PL121
    buffer_store_dwordx4 v[232:235], v1, s[28:31], s0 offen offset:2048
PE122:
    v_lshlrev_b32 v40, 16, v232
    v_and_b32 v41, 0xffff0000, v232
    v_lshlrev_b32 v42, 16, v233
    v_and_b32 v43, 0xffff0000, v233
    v_lshlrev_b32 v44, 16, v234
    v_and_b32 v45, 0xffff0000, v234
    v_lshlrev_b32 v46, 16, v235
    v_and_b32 v47, 0xffff0000, v235
    v_pk_add_f32 v[192:193], v[32:33], v[40:41]
    v_pk_add_f32 v[194:195], v[34:35], v[42:43]
    v_pk_add_f32 v[196:197], v[36:37], v[44:45]
    v_pk_add_f32 v[198:199], v[38:39], v[46:47]
    v_pk_mul_f32 v[200:201], v[32:33], v[32:33]
    v_pk_mul_f32 v[202:203], v[34:35], v[34:35]
    v_pk_mul_f32 v[204:205], v[36:37], v[36:37]
    v_pk_mul_f32 v[206:207], v[38:39], v[38:39]
    v_pk_fma_f32 v[200:201], v[40:41], v[40:41], v[200:201]
    v_pk_fma_f32 v[202:203], v[42:43], v[42:43], v[202:203]
    v_pk_fma_f32 v[204:205], v[44:45], v[44:45], v[204:205]
    v_pk_fma_f32 v[206:207], v[46:47], v[46:47], v[206:207]
    v_pk_add_f32 v[192:193], v[192:193], v[194:195]
    v_pk_add_f32 v[196:197], v[196:197], v[198:199]
    v_pk_add_f32 v[200:201], v[200:201], v[202:203]
    v_pk_add_f32 v[204:205], v[204:205], v[206:207]
    v_pk_add_f32 v[192:193], v[192:193], v[196:197]
    v_pk_add_f32 v[200:201], v[200:201], v[204:205]
    v_add_f32 v192, v192, v193
    v_add_f32 v200, v200, v201
    v_and_b32 v62, 31, v0
    v_lshrrev_b32 v61, 5, v0
    v_lshlrev_b32 v61, 2, v61
    v_permlane32_swap_b32 v192, v200
    v_lshl_add_u32 v61, v62, 3, v61
    s_add_u32 s81, s74, 458752
    v_add_f32 v192, v192, v200
    s_cmp_lg_u32 s79, 1
    s_cbranch_scc1 PL123
    buffer_store_dword v192, v61, s[28:31], s81 offen
PE124:
    s_add_u32 s76, s80, 0
    buffer_load_dwordx4 v[128:131], v1, s[28:31], s76 offen offset:0 sc1
    s_add_u32 s76, s80, 0
    buffer_load_dwordx4 v[132:135], v1, s[28:31], s76 offen offset:1024 sc1
    s_add_u32 s76, s80, 4096
    buffer_load_dwordx4 v[136:139], v1, s[28:31], s76 offen offset:0 sc1
    s_add_u32 s76, s80, 4096
    buffer_load_dwordx4 v[140:143], v1, s[28:31], s76 offen offset:1024 sc1
    s_add_u32 s76, s80, 8192
    buffer_load_dwordx4 v[144:147], v1, s[28:31], s76 offen offset:0 sc1
    s_add_u32 s76, s80, 8192
    buffer_load_dwordx4 v[148:151], v1, s[28:31], s76 offen offset:1024 sc1
    s_add_u32 s76, s80, 12288
    buffer_load_dwordx4 v[152:155], v1, s[28:31], s76 offen offset:0 sc1
    s_add_u32 s76, s80, 12288
    buffer_load_dwordx4 v[156:159], v1, s[28:31], s76 offen offset:1024 sc1
    s_add_u32 s76, s80, 16384
    buffer_load_dwordx4 v[160:163], v1, s[28:31], s76 offen offset:0 sc1
    s_add_u32 s76, s80, 16384
    buffer_load_dwordx4 v[164:167], v1, s[28:31], s76 offen offset:1024 sc1
    s_add_u32 s76, s80, 20480
    buffer_load_dwordx4 v[168:171], v1, s[28:31], s76 offen offset:0 sc1
    s_add_u32 s76, s80, 20480
    buffer_load_dwordx4 v[172:175], v1, s[28:31], s76 offen offset:1024 sc1
    s_add_u32 s76, s80, 24576
    buffer_load_dwordx4 v[176:179], v1, s[28:31], s76 offen offset:0 sc1
    s_add_u32 s76, s80, 24576
    buffer_load_dwordx4 v[180:183], v1, s[28:31], s76 offen offset:1024 sc1
    s_and_b32 s3, s50, 1
    s_lshl_b32 s3, s3, 3
    s_sub_u32 s3, s3, s58
    v_add_u32 v12, s3, v3
    v_add_u32 v13, 512, v12
    v_add_u32 v14, 57344, v12
    v_add_u32 v15, 57344, v13
    s_mul_i32 s81, s5, 3584
    s_add_u32 s81, s81, 15466496
    v_min_u32 v8, 27, v0
    v_lshlrev_b32 v8, 10, v8
    v_add_u32 v8, 1020, v8
    ds_read_b64_tr_b16 a[240:241], v12 offset:0
    ds_read_b64_tr_b16 a[242:243], v13 offset:0
    ds_read_b64_tr_b16 a[244:245], v12 offset:28672
    ds_read_b64_tr_b16 a[246:247], v13 offset:28672
    ds_read_b64_tr_b16 a[248:249], v12 offset:1024
    ds_read_b64_tr_b16 a[250:251], v13 offset:1024
    ds_read_b64_tr_b16 a[252:253], v12 offset:29696
    ds_read_b64_tr_b16 a[254:255], v13 offset:29696
    ds_read_b64_tr_b16 v[48:49], v12 offset:4096
    ds_read_b64_tr_b16 v[50:51], v13 offset:4096
    ds_read_b64_tr_b16 v[52:53], v12 offset:32768
    ds_read_b64_tr_b16 v[54:55], v13 offset:32768
    s_waitcnt vmcnt(10)
    v_max3_u32 v63, v131, v135, v139
    v_max_u32 v63, v63, v143
    v_cmp_eq_u32 s[40:41], -1, v63
    s_nop 0
    s_cmp_lg_u64 s[40:41], 0
    s_cbranch_scc1 RT125
CD126:
    s_waitcnt lgkmcnt(8)
    v_mfma_f32_32x32x16_bf16 v[64:79], v[128:131], a[240:243], 0
    ds_read_b64_tr_b16 v[112:113], v12 offset:5120
    ds_read_b64_tr_b16 v[114:115], v13 offset:5120
    v_mfma_f32_32x32x16_bf16 v[80:95], v[128:131], a[244:247], 0
    ds_read_b64_tr_b16 v[116:117], v12 offset:33792
    ds_read_b64_tr_b16 v[118:119], v13 offset:33792
    s_waitcnt lgkmcnt(8)
    v_mfma_f32_32x32x16_bf16 v[64:79], v[132:135], a[248:251], v[64:79]
    ds_read_b64_tr_b16 a[240:241], v12 offset:8192
    ds_read_b64_tr_b16 a[242:243], v13 offset:8192
    v_mfma_f32_32x32x16_bf16 v[80:95], v[132:135], a[252:255], v[80:95]
    ds_read_b64_tr_b16 a[244:245], v12 offset:36864
    ds_read_b64_tr_b16 a[246:247], v13 offset:36864
    s_waitcnt lgkmcnt(8)
    v_mfma_f32_32x32x16_bf16 v[64:79], v[136:139], v[48:51], v[64:79]
    ds_read_b64_tr_b16 a[248:249], v12 offset:9216
    ds_read_b64_tr_b16 a[250:251], v13 offset:9216
    s_add_u32 s76, s80, 0
    buffer_load_dwordx4 v[184:187], v1, s[28:31], s76 offen offset:2048 sc1
    v_mfma_f32_32x32x16_bf16 v[80:95], v[136:139], v[52:55], v[80:95]
    ds_read_b64_tr_b16 a[252:253], v12 offset:37888
    ds_read_b64_tr_b16 a[254:255], v13 offset:37888
    s_waitcnt vmcnt(7)
    v_max3_u32 v63, v147, v151, v155
    v_max_u32 v63, v63, v159
    v_cmp_eq_u32 s[40:41], -1, v63
    s_waitcnt lgkmcnt(8)
    v_mfma_f32_32x32x16_bf16 v[64:79], v[140:143], v[112:115], v[64:79]
    ds_read_b64_tr_b16 v[48:49], v12 offset:12288
    ds_read_b64_tr_b16 v[50:51], v13 offset:12288
    s_add_u32 s76, s80, 0
    buffer_load_dwordx4 v[188:191], v1, s[28:31], s76 offen offset:3072 sc1
    v_mfma_f32_32x32x16_bf16 v[80:95], v[140:143], v[116:119], v[80:95]
    ds_read_b64_tr_b16 v[52:53], v12 offset:40960
    ds_read_b64_tr_b16 v[54:55], v13 offset:40960
    s_cmp_lg_u64 s[40:41], 0
    s_cbranch_scc1 RT127
CD128:
    s_waitcnt lgkmcnt(8)
    v_mfma_f32_32x32x16_bf16 v[64:79], v[144:147], a[240:243], v[64:79]
    ds_read_b64_tr_b16 v[112:113], v12 offset:13312
    ds_read_b64_tr_b16 v[114:115], v13 offset:13312
    s_add_u32 s76, s80, 4096
    buffer_load_dwordx4 v[192:195], v1, s[28:31], s76 offen offset:2048 sc1
    v_mfma_f32_32x32x16_bf16 v[80:95], v[144:147], a[244:247], v[80:95]
    ds_read_b64_tr_b16 v[116:117], v12 offset:41984
    ds_read_b64_tr_b16 v[118:119], v13 offset:41984
    s_waitcnt lgkmcnt(8)
    v_mfma_f32_32x32x16_bf16 v[64:79], v[148:151], a[248:251], v[64:79]
    ds_read_b64_tr_b16 a[240:241], v12 offset:16384
    ds_read_b64_tr_b16 a[242:243], v13 offset:16384
    s_add_u32 s76, s80, 4096
    buffer_load_dwordx4 v[196:199], v1, s[28:31], s76 offen offset:3072 sc1
    buffer_load_dwordx2 v[240:241], v2, s[28:31], s81 offen offset:0 sc1
    v_mfma_f32_32x32x16_bf16 v[80:95], v[148:151], a[252:255], v[80:95]
    ds_read_b64_tr_b16 a[244:245], v12 offset:45056
    ds_read_b64_tr_b16 a[246:247], v13 offset:45056
    s_waitcnt lgkmcnt(8)
    v_mfma_f32_32x32x16_bf16 v[64:79], v[152:155], v[48:51], v[64:79]
    ds_read_b64_tr_b16 a[248:249], v12 offset:17408
    ds_read_b64_tr_b16 a[250:251], v13 offset:17408
    s_add_u32 s76, s80, 8192
    buffer_load_dwordx4 v[200:203], v1, s[28:31], s76 offen offset:2048 sc1
    buffer_load_dwordx2 v[242:243], v2, s[28:31], s81 offen offset:512 sc1
    v_mfma_f32_32x32x16_bf16 v[80:95], v[152:155], v[52:55], v[80:95]
    ds_read_b64_tr_b16 a[252:253], v12 offset:46080
    ds_read_b64_tr_b16 a[254:255], v13 offset:46080
    s_waitcnt vmcnt(9)
    v_max3_u32 v63, v163, v167, v171
    v_max_u32 v63, v63, v175
    v_cmp_eq_u32 s[40:41], -1, v63
    s_waitcnt lgkmcnt(8)
    v_mfma_f32_32x32x16_bf16 v[64:79], v[156:159], v[112:115], v[64:79]
    ds_read_b64_tr_b16 v[48:49], v12 offset:20480
    ds_read_b64_tr_b16 v[50:51], v13 offset:20480
    s_add_u32 s76, s80, 8192
    buffer_load_dwordx4 v[204:207], v1, s[28:31], s76 offen offset:3072 sc1
    buffer_load_dwordx2 v[244:245], v2, s[28:31], s81 offen offset:1024 sc1
    v_mfma_f32_32x32x16_bf16 v[80:95], v[156:159], v[116:119], v[80:95]
    ds_read_b64_tr_b16 v[52:53], v12 offset:49152
    ds_read_b64_tr_b16 v[54:55], v13 offset:49152
    s_cmp_lg_u64 s[40:41], 0
    s_cbranch_scc1 RT129
CD130:
    s_waitcnt lgkmcnt(8)
    v_mfma_f32_32x32x16_bf16 v[64:79], v[160:163], a[240:243], v[64:79]
    ds_read_b64_tr_b16 v[112:113], v12 offset:21504
    ds_read_b64_tr_b16 v[114:115], v13 offset:21504
    s_add_u32 s76, s80, 12288
    buffer_load_dwordx4 v[208:211], v1, s[28:31], s76 offen offset:2048 sc1
    buffer_load_dwordx2 v[246:247], v2, s[28:31], s81 offen offset:1536 sc1
    v_mfma_f32_32x32x16_bf16 v[80:95], v[160:163], a[244:247], v[80:95]
    ds_read_b64_tr_b16 v[116:117], v12 offset:50176
    ds_read_b64_tr_b16 v[118:119], v13 offset:50176
    s_waitcnt lgkmcnt(8)
    v_mfma_f32_32x32x16_bf16 v[64:79], v[164:167], a[248:251], v[64:79]
    ds_read_b64_tr_b16 a[240:241], v12 offset:24576
    ds_read_b64_tr_b16 a[242:243], v13 offset:24576
    s_add_u32 s76, s80, 12288
    buffer_load_dwordx4 v[212:215], v1, s[28:31], s76 offen offset:3072 sc1
    buffer_load_dwordx2 v[248:249], v2, s[28:31], s81 offen offset:2048 sc1
    v_mfma_f32_32x32x16_bf16 v[80:95], v[164:167], a[252:255], v[80:95]
    ds_read_b64_tr_b16 a[244:245], v12 offset:53248
    ds_read_b64_tr_b16 a[246:247], v13 offset:53248
    s_waitcnt lgkmcnt(8)
    v_mfma_f32_32x32x16_bf16 v[64:79], v[168:171], v[48:51], v[64:79]
    ds_read_b64_tr_b16 a[248:249], v12 offset:25600
    ds_read_b64_tr_b16 a[250:251], v13 offset:25600
    s_add_u32 s76, s80, 16384
    buffer_load_dwordx4 v[216:219], v1, s[28:31], s76 offen offset:2048 sc1
    buffer_load_dwordx2 v[250:251], v2, s[28:31], s81 offen offset:2560 sc1
    v_mfma_f32_32x32x16_bf16 v[80:95], v[168:171], v[52:55], v[80:95]
    ds_read_b64_tr_b16 a[252:253], v12 offset:54272
    ds_read_b64_tr_b16 a[254:255], v13 offset:54272
    s_waitcnt vmcnt(15)
    v_max_u32 v63, v179, v183
    v_cmp_eq_u32 s[40:41], -1, v63
    s_waitcnt lgkmcnt(8)
    v_mfma_f32_32x32x16_bf16 v[64:79], v[172:175], v[112:115], v[64:79]
    ds_read_b64_tr_b16 v[48:49], v12 offset:2048
    ds_read_b64_tr_b16 v[50:51], v13 offset:2048
    s_add_u32 s76, s80, 16384
    buffer_load_dwordx4 v[220:223], v1, s[28:31], s76 offen offset:3072 sc1
    buffer_load_dwordx2 v[252:253], v2, s[28:31], s81 offen offset:3072 sc1
    v_mfma_f32_32x32x16_bf16 v[80:95], v[172:175], v[116:119], v[80:95]
    ds_read_b64_tr_b16 v[52:53], v12 offset:30720
    ds_read_b64_tr_b16 v[54:55], v13 offset:30720
    s_cmp_lg_u64 s[40:41], 0
    s_cbranch_scc1 RT131
CD132:
    s_waitcnt lgkmcnt(8)
    v_mfma_f32_32x32x16_bf16 v[64:79], v[176:179], a[240:243], v[64:79]
    ds_read_b64_tr_b16 v[112:113], v12 offset:3072
    ds_read_b64_tr_b16 v[114:115], v13 offset:3072
    s_add_u32 s76, s80, 20480
    buffer_load_dwordx4 v[224:227], v1, s[28:31], s76 offen offset:2048 sc1
    v_mfma_f32_32x32x16_bf16 v[80:95], v[176:179], a[244:247], v[80:95]
    ds_read_b64_tr_b16 v[116:117], v12 offset:31744
    ds_read_b64_tr_b16 v[118:119], v13 offset:31744
    s_waitcnt vmcnt(14)
    v_max3_u32 v63, v187, v191, v195
    v_max_u32 v63, v63, v199
    v_cmp_eq_u32 s[40:41], -1, v63
    s_waitcnt lgkmcnt(8)
    v_mfma_f32_32x32x16_bf16 v[64:79], v[180:183], a[248:251], v[64:79]
    ds_read_b64_tr_b16 a[240:241], v12 offset:6144
    ds_read_b64_tr_b16 a[242:243], v13 offset:6144
    s_add_u32 s76, s80, 20480
    buffer_load_dwordx4 v[228:231], v1, s[28:31], s76 offen offset:3072 sc1
    v_mfma_f32_32x32x16_bf16 v[80:95], v[180:183], a[252:255], v[80:95]
    ds_read_b64_tr_b16 a[244:245], v12 offset:34816
    ds_read_b64_tr_b16 a[246:247], v13 offset:34816
    s_cmp_lg_u64 s[40:41], 0
    s_cbranch_scc1 RT133
CD134:
    s_waitcnt lgkmcnt(8)
    v_mfma_f32_32x32x16_bf16 v[64:79], v[184:187], v[48:51], v[64:79]
    ds_read_b64_tr_b16 a[248:249], v12 offset:7168
    ds_read_b64_tr_b16 a[250:251], v13 offset:7168
    s_add_u32 s76, s80, 24576
    buffer_load_dwordx4 v[232:235], v1, s[28:31], s76 offen offset:2048 sc1
    v_mfma_f32_32x32x16_bf16 v[80:95], v[184:187], v[52:55], v[80:95]
    ds_read_b64_tr_b16 a[252:253], v12 offset:35840
    ds_read_b64_tr_b16 a[254:255], v13 offset:35840
    s_waitcnt lgkmcnt(8)
    v_mfma_f32_32x32x16_bf16 v[64:79], v[188:191], v[112:115], v[64:79]
    ds_read_b64_tr_b16 v[48:49], v12 offset:10240
    ds_read_b64_tr_b16 v[50:51], v13 offset:10240
    s_add_u32 s76, s80, 24576
    buffer_load_dwordx4 v[236:239], v1, s[28:31], s76 offen offset:3072 sc1
    v_mfma_f32_32x32x16_bf16 v[80:95], v[188:191], v[116:119], v[80:95]
    ds_read_b64_tr_b16 v[52:53], v12 offset:38912
    ds_read_b64_tr_b16 v[54:55], v13 offset:38912
    s_waitcnt lgkmcnt(8)
    v_mfma_f32_32x32x16_bf16 v[64:79], v[192:195], a[240:243], v[64:79]
    ds_read_b64_tr_b16 v[112:113], v12 offset:11264
    ds_read_b64_tr_b16 v[114:115], v13 offset:11264
    v_mfma_f32_32x32x16_bf16 v[80:95], v[192:195], a[244:247], v[80:95]
    ds_read_b64_tr_b16 v[116:117], v12 offset:39936
    ds_read_b64_tr_b16 v[118:119], v13 offset:39936
    s_waitcnt vmcnt(9)
    v_max3_u32 v63, v203, v207, v211
    v_max_u32 v63, v63, v215
    v_cmp_eq_u32 s[40:41], -1, v63
    s_nop 0
    s_cmp_lg_u64 s[40:41], 0
    s_cbranch_scc1 RT135
CD136:
    s_waitcnt lgkmcnt(8)
    v_mfma_f32_32x32x16_bf16 v[64:79], v[196:199], a[248:251], v[64:79]
    ds_read_b64_tr_b16 a[240:241], v12 offset:14336
    ds_read_b64_tr_b16 a[242:243], v13 offset:14336
    v_mfma_f32_32x32x16_bf16 v[80:95], v[196:199], a[252:255], v[80:95]
    ds_read_b64_tr_b16 a[244:245], v12 offset:43008
    ds_read_b64_tr_b16 a[246:247], v13 offset:43008
    s_waitcnt lgkmcnt(8)
    v_mfma_f32_32x32x16_bf16 v[64:79], v[200:203], v[48:51], v[64:79]
    ds_read_b64_tr_b16 a[248:249], v12 offset:15360
    ds_read_b64_tr_b16 a[250:251], v13 offset:15360
    v_mfma_f32_32x32x16_bf16 v[80:95], v[200:203], v[52:55], v[80:95]
    ds_read_b64_tr_b16 a[252:253], v12 offset:44032
    ds_read_b64_tr_b16 a[254:255], v13 offset:44032
    s_waitcnt vmcnt(4)
    v_max3_u32 v62, v240, v241, v242
    v_max3_u32 v62, v62, v243, v244
    v_max3_u32 v62, v62, v245, v246
    v_max3_u32 v62, v62, v247, v248
    v_max3_u32 v62, v62, v249, v250
    s_waitcnt lgkmcnt(8)
    v_mfma_f32_32x32x16_bf16 v[64:79], v[204:207], v[112:115], v[64:79]
    ds_read_b64_tr_b16 v[48:49], v12 offset:18432
    ds_read_b64_tr_b16 v[50:51], v13 offset:18432
    v_mfma_f32_32x32x16_bf16 v[80:95], v[204:207], v[116:119], v[80:95]
    ds_read_b64_tr_b16 v[52:53], v12 offset:47104
    ds_read_b64_tr_b16 v[54:55], v13 offset:47104
    v_max3_u32 v62, v62, v251, v252
    v_max_u32 v62, v62, v253
    v_cmp_eq_u32 s[42:43], -1, v62
    s_nop 0
    s_cmp_lg_u64 s[42:43], 0
    s_cbranch_scc1 RT137
CD138:
    v_pk_add_f32 v[240:241], v[240:241], v[242:243]
    s_waitcnt lgkmcnt(8)
    v_mfma_f32_32x32x16_bf16 v[64:79], v[208:211], a[240:243], v[64:79]
    ds_read_b64_tr_b16 v[112:113], v12 offset:19456
    ds_read_b64_tr_b16 v[114:115], v13 offset:19456
    v_mfma_f32_32x32x16_bf16 v[80:95], v[208:211], a[244:247], v[80:95]
    ds_read_b64_tr_b16 v[116:117], v12 offset:48128
    ds_read_b64_tr_b16 v[118:119], v13 offset:48128
    s_waitcnt vmcnt(2)
    v_max3_u32 v63, v219, v223, v227
    v_max_u32 v63, v63, v231
    v_cmp_eq_u32 s[40:41], -1, v63
    s_nop 0
    s_cmp_lg_u64 s[40:41], 0
    s_cbranch_scc1 RT139
CD140:
    v_pk_add_f32 v[244:245], v[244:245], v[246:247]
    s_waitcnt lgkmcnt(8)
    v_mfma_f32_32x32x16_bf16 v[64:79], v[212:215], a[248:251], v[64:79]
    ds_read_b64_tr_b16 a[240:241], v12 offset:22528
    ds_read_b64_tr_b16 a[242:243], v13 offset:22528
    v_mfma_f32_32x32x16_bf16 v[80:95], v[212:215], a[252:255], v[80:95]
    ds_read_b64_tr_b16 a[244:245], v12 offset:51200
    ds_read_b64_tr_b16 a[246:247], v13 offset:51200
    v_pk_add_f32 v[248:249], v[248:249], v[250:251]
    v_pk_add_f32 v[240:241], v[240:241], v[244:245]
    s_waitcnt lgkmcnt(8)
    v_mfma_f32_32x32x16_bf16 v[64:79], v[216:219], v[48:51], v[64:79]
    ds_read_b64_tr_b16 a[248:249], v12 offset:23552
    ds_read_b64_tr_b16 a[250:251], v13 offset:23552
    v_mfma_f32_32x32x16_bf16 v[80:95], v[216:219], v[52:55], v[80:95]
    ds_read_b64_tr_b16 a[252:253], v12 offset:52224
    ds_read_b64_tr_b16 a[254:255], v13 offset:52224
    v_pk_add_f32 v[248:249], v[248:249], v[252:253]
    v_pk_add_f32 v[240:241], v[240:241], v[248:249]
    s_waitcnt lgkmcnt(8)
    v_mfma_f32_32x32x16_bf16 v[64:79], v[220:223], v[112:115], v[64:79]
    ds_read_b64_tr_b16 v[48:49], v12 offset:26624
    ds_read_b64_tr_b16 v[50:51], v13 offset:26624
    v_mfma_f32_32x32x16_bf16 v[80:95], v[220:223], v[116:119], v[80:95]
    ds_read_b64_tr_b16 v[52:53], v12 offset:55296
    ds_read_b64_tr_b16 v[54:55], v13 offset:55296
    v_permlane32_swap_b32 v240, v241
    v_add_f32 v240, v240, v241
    v_mov_b32 v61, v240
    v_mov_b32 v60, v240
    s_nop 1
    v_permlane32_swap_b32 v60, v61
    v_mul_f32 v60, 0x3b124925, v60
    v_mul_f32 v61, 0x3b124925, v61
    v_fma_f32 v61, -v60, v60, v61
    v_max_f32 v61, 0, v61
    v_add_f32 v61, 0x3727c5ac, v61
    v_rsq_f32 v254, v61
    v_lshl_add_u32 v61, v0, 2, s58
    v_mul_f32 v255, v60, v254
    v_bfi_b32 v60, v6, v254, v255
    ds_write_b32 v61, v60 offset:15616
    v_lshrrev_b32 v60, 5, v0
    v_lshl_add_u32 v61, v60, 4, s58
    ds_read_b128 v[96:99], v61 offset:15616
    ds_read_b128 v[100:103], v61 offset:15648
    ds_read_b128 v[104:107], v61 offset:15680
    ds_read_b128 v[108:111], v61 offset:15712
    s_waitcnt lgkmcnt(13)
    v_mfma_f32_32x32x16_bf16 v[64:79], v[224:227], a[240:243], v[64:79]
    ds_read_b64_tr_b16 v[240:241], v12 offset:27648
    ds_read_b64_tr_b16 v[242:243], v13 offset:27648
    v_mfma_f32_32x32x16_bf16 v[80:95], v[224:227], a[244:247], v[80:95]
    ds_read_b64_tr_b16 v[244:245], v12 offset:56320
    ds_read_b64_tr_b16 v[246:247], v13 offset:56320
    s_waitcnt vmcnt(0)
    v_max_u32 v63, v235, v239
    v_cmp_eq_u32 s[40:41], -1, v63
    ds_read_b128 v[112:115], v61 offset:15744
    s_cmp_lg_u64 s[40:41], 0
    s_cbranch_scc1 RT141
CD142:
    ds_read_b128 v[116:119], v61 offset:15776
    ds_read_b128 v[120:123], v61 offset:15808
    s_waitcnt lgkmcnt(15)
    v_mfma_f32_32x32x16_bf16 v[64:79], v[228:231], a[248:251], v[64:79]
    v_mfma_f32_32x32x16_bf16 v[80:95], v[228:231], a[252:255], v[80:95]
    ds_read_b128 v[124:127], v61 offset:15840
    s_waitcnt lgkmcnt(13)
    v_mfma_f32_32x32x16_bf16 v[64:79], v[232:235], v[48:51], v[64:79]
    v_mfma_f32_32x32x16_bf16 v[80:95], v[232:235], v[52:55], v[80:95]
    s_waitcnt lgkmcnt(4)
    v_mfma_f32_32x32x16_bf16 v[64:79], v[236:239], v[240:243], v[64:79]
    v_mfma_f32_32x32x16_bf16 v[80:95], v[236:239], v[244:247], v[80:95]
    v_mov_b32 v8, 0xb5c1a2a0
    v_mov_b32 v9, 0xb5c1a2a0
    v_mov_b32 v10, 0xb58637bd
    v_mov_b32 v11, 0xb58637bd
    s_sub_u32 s3, s48, 1
    s_and_b32 s3, s3, 3
    s_lshl_b32 s3, s3, 10
    s_add_u32 s3, s3, 151552
    v_add_u32 v48, s3, v1
    s_sub_u32 s3, s48, 2
    s_and_b32 s3, s3, 3
    s_lshl_b32 s3, s3, 10
    s_add_u32 s3, s3, 154624
    v_add_u32 v49, s3, v1
    s_sub_u32 s3, s48, 3
    s_and_b32 s3, s3, 3
    s_lshl_b32 s3, s3, 10
    s_add_u32 s3, s3, 157696
    v_add_u32 v50, s3, v1
    s_sub_u32 s3, s48, 4
    s_and_b32 s3, s3, 3
    s_lshl_b32 s3, s3, 10
    s_add_u32 s3, s3, 160768
    v_add_u32 v51, s3, v1
    s_waitcnt lgkmcnt(0)
    v_pk_mul_f32 v[240:241], v[112:113], v[56:57] op_sel:[0,1] op_sel_hi:[1,1]
    v_pk_mul_f32 v[242:243], v[114:115], v[56:57] op_sel:[0,1] op_sel_hi:[1,1]
    v_pk_mul_f32 v[244:245], v[116:117], v[56:57] op_sel:[0,1] op_sel_hi:[1,1]
    v_pk_mul_f32 v[246:247], v[118:119], v[56:57] op_sel:[0,1] op_sel_hi:[1,1]
    v_pk_fma_f32 v[80:81], v[80:81], v[96:97], v[240:241] neg_lo:[0,0,1] neg_hi:[0,0,1]
    v_pk_fma_f32 v[82:83], v[82:83], v[98:99], v[242:243] neg_lo:[0,0,1] neg_hi:[0,0,1]
    v_pk_fma_f32 v[84:85], v[84:85], v[100:101], v[244:245] neg_lo:[0,0,1] neg_hi:[0,0,1]
    v_pk_fma_f32 v[86:87], v[86:87], v[102:103], v[246:247] neg_lo:[0,0,1] neg_hi:[0,0,1]
    v_pk_mul_f32 v[240:241], v[120:121], v[56:57] op_sel:[0,1] op_sel_hi:[1,1]
    v_pk_mul_f32 v[242:243], v[122:123], v[56:57] op_sel:[0,1] op_sel_hi:[1,1]
    v_pk_mul_f32 v[244:245], v[124:125], v[56:57] op_sel:[0,1] op_sel_hi:[1,1]
    v_pk_mul_f32 v[246:247], v[126:127], v[56:57] op_sel:[0,1] op_sel_hi:[1,1]
    v_pk_fma_f32 v[88:89], v[88:89], v[104:105], v[240:241] neg_lo:[0,0,1] neg_hi:[0,0,1]
    v_pk_fma_f32 v[90:91], v[90:91], v[106:107], v[242:243] neg_lo:[0,0,1] neg_hi:[0,0,1]
    v_pk_fma_f32 v[92:93], v[92:93], v[108:109], v[244:245] neg_lo:[0,0,1] neg_hi:[0,0,1]
    v_pk_fma_f32 v[94:95], v[94:95], v[110:111], v[246:247] neg_lo:[0,0,1] neg_hi:[0,0,1]
    v_cvt_pk_bf16_f32 v80, v80, v81
    v_cvt_pk_bf16_f32 v81, v82, v83
    v_cvt_pk_bf16_f32 v82, v84, v85
    v_cvt_pk_bf16_f32 v83, v86, v87
    v_cvt_pk_bf16_f32 v84, v88, v89
    v_cvt_pk_bf16_f32 v85, v90, v91
    v_cvt_pk_bf16_f32 v86, v92, v93
    v_cvt_pk_bf16_f32 v87, v94, v95
    v_and_or_b32 v80, v80, v4, v5
    v_and_or_b32 v81, v81, v4, v5
    v_and_or_b32 v82, v82, v4, v5
    v_and_or_b32 v83, v83, v4, v5
    v_and_or_b32 v84, v84, v4, v5
    v_and_or_b32 v85, v85, v4, v5
    v_and_or_b32 v86, v86, v4, v5
    v_and_or_b32 v87, v87, v4, v5
    v_pk_fma_f32 v[112:113], v[112:113], v[56:57], v[10:11] op_sel_hi:[1,0,1]
    v_pk_fma_f32 v[114:115], v[114:115], v[56:57], v[10:11] op_sel_hi:[1,0,1]
    v_pk_fma_f32 v[116:117], v[116:117], v[56:57], v[10:11] op_sel_hi:[1,0,1]
    v_pk_fma_f32 v[118:119], v[118:119], v[56:57], v[10:11] op_sel_hi:[1,0,1]
    v_pk_fma_f32 v[120:121], v[120:121], v[56:57], v[10:11] op_sel_hi:[1,0,1]
    v_pk_fma_f32 v[122:123], v[122:123], v[56:57], v[10:11] op_sel_hi:[1,0,1]
    v_pk_fma_f32 v[124:125], v[124:125], v[56:57], v[10:11] op_sel_hi:[1,0,1]
    v_pk_fma_f32 v[126:127], v[126:127], v[56:57], v[10:11] op_sel_hi:[1,0,1]
    v_pk_fma_f32 v[64:65], v[64:65], v[96:97], v[112:113] neg_lo:[0,0,1] neg_hi:[0,0,1]
    v_pk_fma_f32 v[66:67], v[66:67], v[98:99], v[114:115] neg_lo:[0,0,1] neg_hi:[0,0,1]
    v_pk_fma_f32 v[68:69], v[68:69], v[100:101], v[116:117] neg_lo:[0,0,1] neg_hi:[0,0,1]
    v_pk_fma_f32 v[70:71], v[70:71], v[102:103], v[118:119] neg_lo:[0,0,1] neg_hi:[0,0,1]
    v_pk_fma_f32 v[72:73], v[72:73], v[104:105], v[120:121] neg_lo:[0,0,1] neg_hi:[0,0,1]
    v_pk_fma_f32 v[74:75], v[74:75], v[106:107], v[122:123] neg_lo:[0,0,1] neg_hi:[0,0,1]
    v_pk_fma_f32 v[76:77], v[76:77], v[108:109], v[124:125] neg_lo:[0,0,1] neg_hi:[0,0,1]
    v_pk_fma_f32 v[78:79], v[78:79], v[110:111], v[126:127] neg_lo:[0,0,1] neg_hi:[0,0,1]
    v_pk_fma_f32 v[112:113], v[64:65], s[66:67], v[8:9]
    v_pk_fma_f32 v[114:115], v[66:67], s[66:67], v[8:9]
    v_pk_fma_f32 v[116:117], v[68:69], s[66:67], v[8:9]
    v_pk_fma_f32 v[118:119], v[70:71], s[66:67], v[8:9]
    v_pk_fma_f32 v[120:121], v[72:73], s[66:67], v[8:9]
    v_pk_fma_f32 v[122:123], v[74:75], s[66:67], v[8:9]
    v_pk_fma_f32 v[124:125], v[76:77], s[66:67], v[8:9]
    v_pk_fma_f32 v[126:127], v[78:79], s[66:67], v[8:9]
    v_exp_f32_e64 v112, v112 clamp
    v_max_f32 v64, 0x358637bd, v64
    v_exp_f32_e64 v113, v113 clamp
    v_max_f32 v65, 0x358637bd, v65
    v_exp_f32_e64 v114, v114 clamp
    v_max_f32 v66, 0x358637bd, v66
    v_exp_f32_e64 v115, v115 clamp
    v_max_f32 v67, 0x358637bd, v67
    v_exp_f32_e64 v116, v116 clamp
    v_max_f32 v68, 0x358637bd, v68
    v_exp_f32_e64 v117, v117 clamp
    v_max_f32 v69, 0x358637bd, v69
    v_exp_f32_e64 v118, v118 clamp
    v_max_f32 v70, 0x358637bd, v70
    v_exp_f32_e64 v119, v119 clamp
    v_max_f32 v71, 0x358637bd, v71
    v_exp_f32_e64 v120, v120 clamp
    v_max_f32 v72, 0x358637bd, v72
    v_exp_f32_e64 v121, v121 clamp
    v_max_f32 v73, 0x358637bd, v73
    v_exp_f32_e64 v122, v122 clamp
    v_max_f32 v74, 0x358637bd, v74
    v_exp_f32_e64 v123, v123 clamp
    v_max_f32 v75, 0x358637bd, v75
    v_exp_f32_e64 v124, v124 clamp
    v_max_f32 v76, 0x358637bd, v76
    v_exp_f32_e64 v125, v125 clamp
    v_max_f32 v77, 0x358637bd, v77
    v_exp_f32_e64 v126, v126 clamp
    v_max_f32 v78, 0x358637bd, v78
    v_exp_f32_e64 v127, v127 clamp
    v_max_f32 v79, 0x358637bd, v79
    v_pk_add_f32 v[64:65], v[64:65], v[112:113]
    v_pk_add_f32 v[66:67], v[66:67], v[114:115]
    v_pk_add_f32 v[68:69], v[68:69], v[116:117]
    v_pk_add_f32 v[70:71], v[70:71], v[118:119]
    v_pk_add_f32 v[72:73], v[72:73], v[120:121]
    v_pk_add_f32 v[74:75], v[74:75], v[122:123]
    v_pk_add_f32 v[76:77], v[76:77], v[124:125]
    v_pk_add_f32 v[78:79], v[78:79], v[126:127]
    v_cvt_pk_bf16_f32 v64, v64, v65
    v_cvt_pk_bf16_f32 v65, v66, v67
    v_cvt_pk_bf16_f32 v66, v68, v69
    v_cvt_pk_bf16_f32 v67, v70, v71
    v_cvt_pk_bf16_f32 v68, v72, v73
    v_cvt_pk_bf16_f32 v69, v74, v75
    v_cvt_pk_bf16_f32 v70, v76, v77
    v_cvt_pk_bf16_f32 v71, v78, v79
    v_and_b32 v64, v4, v64
    v_and_b32 v65, v4, v65
    v_and_b32 v66, v4, v66
    v_and_b32 v67, v4, v67
    v_and_b32 v68, v4, v68
    v_and_b32 v69, v4, v69
    v_and_b32 v70, v4, v70
    v_and_b32 v71, v4, v71
    v_mfma_f32_32x32x16_bf16 v[96:111], v[64:67], v[80:83], 0
    v_mfma_f32_32x32x16_bf16 v[96:111], v[68:71], v[84:87], v[96:111]
    v_add_u32 v60, s59, v1
    s_add_u32 s80, s68, 3145728
    s_lshl_b32 s3, s49, 11
    s_add_u32 s81, s80, s3
    ds_read_b64_tr_b16 a[240:241], v14 offset:0
    ds_read_b64_tr_b16 a[242:243], v15 offset:0
    ds_read_b64_tr_b16 a[244:245], v14 offset:1024
    ds_read_b64_tr_b16 a[246:247], v15 offset:1024
    ds_read_b64_tr_b16 a[248:249], v14 offset:4096
    ds_read_b64_tr_b16 a[250:251], v15 offset:4096
    ds_read_b64_tr_b16 a[252:253], v14 offset:5120
    ds_read_b64_tr_b16 a[254:255], v15 offset:5120
    ds_read_b64_tr_b16 v[72:73], v14 offset:8192
    ds_read_b64_tr_b16 v[74:75], v15 offset:8192
    ds_read_b64_tr_b16 v[76:77], v14 offset:9216
    ds_read_b64_tr_b16 v[78:79], v15 offset:9216
    s_waitcnt lgkmcnt(10)
    v_mfma_f32_32x32x16_bf16 v[112:127], a[240:243], v[128:131], 0
    ds_read_b64_tr_b16 a[240:241], v14 offset:12288
    ds_read_b64_tr_b16 a[242:243], v15 offset:12288
    s_waitcnt lgkmcnt(10)
    v_mfma_f32_32x32x16_bf16 v[112:127], a[244:247], v[132:135], v[112:127]
    s_cmp_eq_u32 s48, 0
    s_cselect_b64 exec, 0, -1
    ds_write_b128 v48, v[96:99]
    s_cmp_eq_u32 s48, 1
    s_cselect_b64 exec, 0, -1
    ds_write_b128 v49, v[100:103]
    s_cmp_eq_u32 s48, 2
    s_cselect_b64 exec, 0, -1
    ds_write_b128 v50, v[104:107]
    s_cmp_eq_u32 s48, 3
    s_cselect_b64 exec, 0, -1
    ds_write_b128 v51, v[108:111]
    s_mov_b64 exec, -1
OQ143:
    s_cmp_lg_u32 s48, 0
    s_cbranch_scc1 OQ144
    v_pk_mul_f32 v[92:93], v[96:97], s[72:73]
    v_pk_mul_f32 v[94:95], v[98:99], s[72:73]
    s_branch OQ147
OQ144:
    s_cmp_lg_u32 s48, 1
    s_cbranch_scc1 OQ145
    v_pk_mul_f32 v[92:93], v[100:101], s[72:73]
    v_pk_mul_f32 v[94:95], v[102:103], s[72:73]
    s_branch OQ147
OQ145:
    s_cmp_lg_u32 s48, 2
    s_cbranch_scc1 OQ146
    v_pk_mul_f32 v[92:93], v[104:105], s[72:73]
    v_pk_mul_f32 v[94:95], v[106:107], s[72:73]
    s_branch OQ147
OQ146:
    v_pk_mul_f32 v[92:93], v[108:109], s[72:73]
    v_pk_mul_f32 v[94:95], v[110:111], s[72:73]
OQ147:
    s_waitcnt lgkmcnt(0)
    s_barrier
    ds_read_b128 v[80:83], v60 offset:0
    ds_read_b128 v[84:87], v60 offset:1024
    ds_read_b128 v[88:91], v60 offset:2048
    ds_read_b64_tr_b16 a[244:245], v14 offset:13312
    ds_read_b64_tr_b16 a[246:247], v15 offset:13312
    v_mfma_f32_32x32x16_bf16 v[112:127], a[248:251], v[136:139], v[112:127]
    ds_read_b64_tr_b16 a[248:249], v14 offset:16384
    ds_read_b64_tr_b16 a[250:251], v15 offset:16384
    v_mfma_f32_32x32x16_bf16 v[112:127], a[252:255], v[140:143], v[112:127]
    s_waitcnt lgkmcnt(4)
    v_pk_add_f32 v[80:81], v[80:81], v[84:85]
    v_pk_add_f32 v[88:89], v[88:89], v[92:93]
    v_pk_add_f32 v[82:83], v[82:83], v[86:87]
    v_pk_add_f32 v[90:91], v[90:91], v[94:95]
    v_pk_add_f32 v[80:81], v[80:81], v[88:89]
    v_pk_add_f32 v[82:83], v[82:83], v[90:91]
    v_cvt_pk_bf16_f32 v80, v80, v81
    v_cvt_pk_bf16_f32 v81, v82, v83
    buffer_store_dwordx2 v[80:81], v2, s[28:31], s81 offen sc0 sc1
    v_lshrrev_b32 v60, 5, v0
    v_lshlrev_b32 v60, 9, v60
    v_add_u32 v88, 256, v3
    v_add_u32 v88, v88, v60
    v_min_u32 v89, 15, v0
    v_lshlrev_b32 v89, 11, v89
    v_add_u32 v89, 508, v89
    ds_read_b64_tr_b16 a[252:253], v14 offset:17408
    ds_read_b64_tr_b16 a[254:255], v15 offset:17408
    v_mfma_f32_32x32x16_bf16 v[112:127], v[72:75], v[144:147], v[112:127]
    s_add_u32 m0, s58, 0
    s_add_u32 s4, s64, 0
    buffer_load_dwordx4 v58, s[16:19], s4 offen lds
    ds_read_b64_tr_b16 v[72:73], v14 offset:20480
    ds_read_b64_tr_b16 v[74:75], v15 offset:20480
    v_mfma_f32_32x32x16_bf16 v[112:127], v[76:79], v[148:151], v[112:127]
    s_add_u32 m0, s58, 1024
    s_add_u32 s4, s64, 7168
    buffer_load_dwordx4 v58, s[16:19], s4 offen lds
    ds_read_b64_tr_b16 v[76:77], v14 offset:21504
    ds_read_b64_tr_b16 v[78:79], v15 offset:21504
    v_mfma_f32_32x32x16_bf16 v[112:127], a[240:243], v[152:155], v[112:127]
    s_add_u32 m0, s58, 2048
    s_add_u32 s4, s64, 14336
    buffer_load_dwordx4 v58, s[16:19], s4 offen lds
    ds_read_b64_tr_b16 a[240:241], v14 offset:24576
    ds_read_b64_tr_b16 a[242:243], v15 offset:24576
    s_waitcnt lgkmcnt(10)
    v_mfma_f32_32x32x16_bf16 v[112:127], a[244:247], v[156:159], v[112:127]
    s_add_u32 m0, s58, 3072
    s_add_u32 s4, s64, 21504
    buffer_load_dwordx4 v58, s[16:19], s4 offen lds
    ds_read_b64_tr_b16 a[244:245], v14 offset:25600
    ds_read_b64_tr_b16 a[246:247], v15 offset:25600
    s_waitcnt lgkmcnt(10)
    v_mfma_f32_32x32x16_bf16 v[112:127], a[248:251], v[160:163], v[112:127]
    s_add_u32 m0, s58, 4096
    s_add_u32 s4, s64, 28672
    buffer_load_dwordx4 v58, s[16:19], s4 offen lds
    ds_read_b64_tr_b16 a[248:249], v14 offset:2048
    ds_read_b64_tr_b16 a[250:251], v15 offset:2048
    s_waitcnt lgkmcnt(10)
    v_mfma_f32_32x32x16_bf16 v[112:127], a[252:255], v[164:167], v[112:127]
    s_add_u32 m0, s58, 5120
    s_add_u32 s4, s64, 35840
    buffer_load_dwordx4 v58, s[16:19], s4 offen lds
    ds_read_b64_tr_b16 a[252:253], v14 offset:3072
    ds_read_b64_tr_b16 a[254:255], v15 offset:3072
    s_waitcnt lgkmcnt(10)
    v_mfma_f32_32x32x16_bf16 v[112:127], v[72:75], v[168:171], v[112:127]
    s_add_u32 m0, s58, 6144
    s_add_u32 s4, s64, 43008
    buffer_load_dwordx4 v58, s[16:19], s4 offen lds
    ds_read_b64_tr_b16 v[72:73], v14 offset:6144
    ds_read_b64_tr_b16 v[74:75], v15 offset:6144
    s_waitcnt lgkmcnt(10)
    v_mfma_f32_32x32x16_bf16 v[112:127], v[76:79], v[172:175], v[112:127]
    s_add_u32 m0, s58, 7168
    s_add_u32 s4, s64, 50176
    buffer_load_dwordx4 v58, s[16:19], s4 offen lds
    ds_read_b64_tr_b16 v[76:77], v14 offset:7168
    ds_read_b64_tr_b16 v[78:79], v15 offset:7168
    s_waitcnt lgkmcnt(10)
    v_mfma_f32_32x32x16_bf16 v[112:127], a[240:243], v[176:179], v[112:127]
    s_add_u32 m0, s58, 8192
    s_add_u32 s4, s64, 57344
    buffer_load_dwordx4 v58, s[16:19], s4 offen lds
    ds_read_b64_tr_b16 a[240:241], v14 offset:10240
    ds_read_b64_tr_b16 a[242:243], v15 offset:10240
    s_waitcnt lgkmcnt(10)
    v_mfma_f32_32x32x16_bf16 v[112:127], a[244:247], v[180:183], v[112:127]
    s_add_u32 m0, s58, 9216
    s_add_u32 s4, s64, 64512
    buffer_load_dwordx4 v58, s[16:19], s4 offen lds
    ds_read_b64_tr_b16 a[244:245], v14 offset:11264
    ds_read_b64_tr_b16 a[246:247], v15 offset:11264
    s_waitcnt lgkmcnt(10)
    v_mfma_f32_32x32x16_bf16 v[112:127], a[248:251], v[184:187], v[112:127]
    s_add_u32 m0, s58, 10240
    s_add_u32 s4, s64, 71680
    buffer_load_dwordx4 v58, s[16:19], s4 offen lds
    ds_read_b64_tr_b16 a[248:249], v14 offset:14336
    ds_read_b64_tr_b16 a[250:251], v15 offset:14336
    s_waitcnt lgkmcnt(10)
    v_mfma_f32_32x32x16_bf16 v[112:127], a[252:255], v[188:191], v[112:127]
    s_add_u32 m0, s58, 11264
    s_add_u32 s4, s64, 78848
    buffer_load_dwordx4 v58, s[16:19], s4 offen lds
    ds_read_b64_tr_b16 a[252:253], v14 offset:15360
    ds_read_b64_tr_b16 a[254:255], v15 offset:15360
    s_waitcnt lgkmcnt(10)
    v_mfma_f32_32x32x16_bf16 v[112:127], v[72:75], v[192:195], v[112:127]
    s_add_u32 m0, s58, 12288
    s_add_u32 s4, s64, 86016
    buffer_load_dwordx4 v58, s[16:19], s4 offen lds
    ds_read_b64_tr_b16 v[72:73], v14 offset:18432
    ds_read_b64_tr_b16 v[74:75], v15 offset:18432
    s_waitcnt lgkmcnt(10)
    v_mfma_f32_32x32x16_bf16 v[112:127], v[76:79], v[196:199], v[112:127]
    s_add_u32 m0, s58, 13312
    s_add_u32 s4, s64, 93184
    buffer_load_dwordx4 v58, s[16:19], s4 offen lds
    ds_read_b64_tr_b16 v[76:77], v14 offset:19456
    ds_read_b64_tr_b16 v[78:79], v15 offset:19456
    s_waitcnt lgkmcnt(10)
    v_mfma_f32_32x32x16_bf16 v[112:127], a[240:243], v[200:203], v[112:127]
    s_add_u32 m0, s58, 14336
    s_add_u32 s4, s64, 100352
    buffer_load_dwordx4 v58, s[16:19], s4 offen lds
    ds_read_b64_tr_b16 a[240:241], v14 offset:22528
    ds_read_b64_tr_b16 a[242:243], v15 offset:22528
    s_waitcnt lgkmcnt(10)
    v_mfma_f32_32x32x16_bf16 v[112:127], a[244:247], v[204:207], v[112:127]
    ds_read_b64_tr_b16 a[244:245], v14 offset:23552
    ds_read_b64_tr_b16 a[246:247], v15 offset:23552
    s_waitcnt lgkmcnt(10)
    v_mfma_f32_32x32x16_bf16 v[112:127], a[248:251], v[208:211], v[112:127]
    ds_read_b64_tr_b16 a[248:249], v14 offset:26624
    ds_read_b64_tr_b16 a[250:251], v15 offset:26624
    s_waitcnt lgkmcnt(10)
    v_mfma_f32_32x32x16_bf16 v[112:127], a[252:255], v[212:215], v[112:127]
    ds_read_b64_tr_b16 a[252:253], v14 offset:27648
    ds_read_b64_tr_b16 a[254:255], v15 offset:27648
    s_waitcnt lgkmcnt(10)
    v_mfma_f32_32x32x16_bf16 v[112:127], v[72:75], v[216:219], v[112:127]
    s_waitcnt lgkmcnt(8)
    v_mfma_f32_32x32x16_bf16 v[112:127], v[76:79], v[220:223], v[112:127]
    s_waitcnt lgkmcnt(6)
    v_mfma_f32_32x32x16_bf16 v[112:127], a[240:243], v[224:227], v[112:127]
    s_waitcnt lgkmcnt(4)
    v_mfma_f32_32x32x16_bf16 v[112:127], a[244:247], v[228:231], v[112:127]
    s_waitcnt lgkmcnt(2)
    v_mfma_f32_32x32x16_bf16 v[112:127], a[248:251], v[232:235], v[112:127]
    s_waitcnt lgkmcnt(0)
    v_mfma_f32_32x32x16_bf16 v[112:127], a[252:255], v[236:239], v[112:127]
    v_pk_fma_f32 v[96:97], v[16:17], v[254:255], v[10:11] op_sel:[0,1,0] op_sel_hi:[1,1,1]
    v_pk_fma_f32 v[98:99], v[18:19], v[254:255], v[10:11] op_sel:[0,1,0] op_sel_hi:[1,1,1]
    v_pk_fma_f32 v[100:101], v[20:21], v[254:255], v[10:11] op_sel:[0,1,0] op_sel_hi:[1,1,1]
    v_pk_fma_f32 v[102:103], v[22:23], v[254:255], v[10:11] op_sel:[0,1,0] op_sel_hi:[1,1,1]
    v_pk_fma_f32 v[104:105], v[24:25], v[254:255], v[10:11] op_sel:[0,1,0] op_sel_hi:[1,1,1]
    v_pk_fma_f32 v[106:107], v[26:27], v[254:255], v[10:11] op_sel:[0,1,0] op_sel_hi:[1,1,1]
    v_pk_fma_f32 v[108:109], v[28:29], v[254:255], v[10:11] op_sel:[0,1,0] op_sel_hi:[1,1,1]
    v_pk_fma_f32 v[110:111], v[30:31], v[254:255], v[10:11] op_sel:[0,1,0] op_sel_hi:[1,1,1]
    s_nop 3
    v_pk_fma_f32 v[112:113], v[112:113], v[254:255], v[96:97] op_sel_hi:[1,0,1] neg_lo:[0,0,1] neg_hi:[0,0,1]
    v_pk_fma_f32 v[114:115], v[114:115], v[254:255], v[98:99] op_sel_hi:[1,0,1] neg_lo:[0,0,1] neg_hi:[0,0,1]
    v_pk_fma_f32 v[116:117], v[116:117], v[254:255], v[100:101] op_sel_hi:[1,0,1] neg_lo:[0,0,1] neg_hi:[0,0,1]
    v_pk_fma_f32 v[118:119], v[118:119], v[254:255], v[102:103] op_sel_hi:[1,0,1] neg_lo:[0,0,1] neg_hi:[0,0,1]
    v_pk_fma_f32 v[120:121], v[120:121], v[254:255], v[104:105] op_sel_hi:[1,0,1] neg_lo:[0,0,1] neg_hi:[0,0,1]
    v_pk_fma_f32 v[122:123], v[122:123], v[254:255], v[106:107] op_sel_hi:[1,0,1] neg_lo:[0,0,1] neg_hi:[0,0,1]
    v_pk_fma_f32 v[124:125], v[124:125], v[254:255], v[108:109] op_sel_hi:[1,0,1] neg_lo:[0,0,1] neg_hi:[0,0,1]
    v_pk_fma_f32 v[126:127], v[126:127], v[254:255], v[110:111] op_sel_hi:[1,0,1] neg_lo:[0,0,1] neg_hi:[0,0,1]
    v_pk_fma_f32 v[96:97], v[112:113], s[66:67], v[8:9]
    v_pk_fma_f32 v[98:99], v[114:115], s[66:67], v[8:9]
    v_pk_fma_f32 v[100:101], v[116:117], s[66:67], v[8:9]
    v_pk_fma_f32 v[102:103], v[118:119], s[66:67], v[8:9]
    v_pk_fma_f32 v[104:105], v[120:121], s[66:67], v[8:9]
    v_pk_fma_f32 v[106:107], v[122:123], s[66:67], v[8:9]
    v_pk_fma_f32 v[108:109], v[124:125], s[66:67], v[8:9]
    v_pk_fma_f32 v[110:111], v[126:127], s[66:67], v[8:9]
    v_exp_f32_e64 v96, v96 clamp
    v_max_f32 v112, 0x358637bd, v112
    v_exp_f32_e64 v97, v97 clamp
    v_max_f32 v113, 0x358637bd, v113
    v_exp_f32_e64 v98, v98 clamp
    v_max_f32 v114, 0x358637bd, v114
    v_exp_f32_e64 v99, v99 clamp
    v_max_f32 v115, 0x358637bd, v115
    v_exp_f32_e64 v100, v100 clamp
    v_max_f32 v116, 0x358637bd, v116
    v_exp_f32_e64 v101, v101 clamp
    v_max_f32 v117, 0x358637bd, v117
    v_exp_f32_e64 v102, v102 clamp
    v_max_f32 v118, 0x358637bd, v118
    v_exp_f32_e64 v103, v103 clamp
    v_max_f32 v119, 0x358637bd, v119
    v_exp_f32_e64 v104, v104 clamp
    v_max_f32 v120, 0x358637bd, v120
    v_exp_f32_e64 v105, v105 clamp
    v_max_f32 v121, 0x358637bd, v121
    v_exp_f32_e64 v106, v106 clamp
    v_max_f32 v122, 0x358637bd, v122
    v_exp_f32_e64 v107, v107 clamp
    v_max_f32 v123, 0x358637bd, v123
    v_exp_f32_e64 v108, v108 clamp
    v_max_f32 v124, 0x358637bd, v124
    v_exp_f32_e64 v109, v109 clamp
    v_max_f32 v125, 0x358637bd, v125
    v_exp_f32_e64 v110, v110 clamp
    v_max_f32 v126, 0x358637bd, v126
    v_exp_f32_e64 v111, v111 clamp
    v_max_f32 v127, 0x358637bd, v127
    v_pk_add_f32 v[112:113], v[112:113], v[96:97]
    v_pk_add_f32 v[114:115], v[114:115], v[98:99]
    v_pk_add_f32 v[116:117], v[116:117], v[100:101]
    v_pk_add_f32 v[118:119], v[118:119], v[102:103]
    v_pk_add_f32 v[120:121], v[120:121], v[104:105]
    v_pk_add_f32 v[122:123], v[122:123], v[106:107]
    v_pk_add_f32 v[124:125], v[124:125], v[108:109]
    v_pk_add_f32 v[126:127], v[126:127], v[110:111]
    v_cvt_pk_bf16_f32 v48, v112, v113
    v_cvt_pk_bf16_f32 v49, v114, v115
    v_cvt_pk_bf16_f32 v50, v116, v117
    v_cvt_pk_bf16_f32 v51, v118, v119
    v_cvt_pk_bf16_f32 v52, v120, v121
    v_cvt_pk_bf16_f32 v53, v122, v123
    v_cvt_pk_bf16_f32 v54, v124, v125
    v_cvt_pk_bf16_f32 v55, v126, v127
    v_and_b32 v54, v6, v54
    v_and_b32 v55, v6, v55
    s_waitcnt vmcnt(0)
    ds_read_b64_tr_b16 v[192:193], v3 offset:0
    ds_read_b64_tr_b16 v[194:195], v3 offset:1024
    ds_read_b64_tr_b16 v[196:197], v3 offset:512
    ds_read_b64_tr_b16 v[198:199], v3 offset:1536
    ds_read_b64_tr_b16 v[200:201], v3 offset:2048
    ds_read_b64_tr_b16 v[202:203], v3 offset:3072
    ds_read_b64_tr_b16 v[204:205], v3 offset:2560
    ds_read_b64_tr_b16 v[206:207], v3 offset:3584
    ds_read_b64_tr_b16 v[208:209], v88 offset:3072
    ds_read_b64_tr_b16 v[210:211], v88 offset:4096
    ds_read_b64_tr_b16 v[212:213], v88 offset:3584
    ds_read_b64_tr_b16 v[214:215], v88 offset:4608
    ds_read_b64_tr_b16 v[216:217], v88 offset:5120
    ds_read_b64_tr_b16 v[218:219], v88 offset:6144
    ds_read_b64_tr_b16 v[220:221], v88 offset:5632
    ds_read_b64_tr_b16 v[222:223], v88 offset:6656
    ds_read_b64_tr_b16 v[224:225], v3 offset:7168
    ds_read_b64_tr_b16 v[226:227], v3 offset:8192
    ds_read_b64_tr_b16 v[228:229], v3 offset:7680
    ds_read_b64_tr_b16 v[230:231], v3 offset:8704
    ds_read_b64_tr_b16 v[232:233], v3 offset:9216
    ds_read_b64_tr_b16 v[234:235], v3 offset:10240
    ds_read_b64_tr_b16 v[236:237], v3 offset:9728
    ds_read_b64_tr_b16 v[238:239], v3 offset:10752
    ds_read_b64_tr_b16 v[240:241], v88 offset:10240
    ds_read_b64_tr_b16 v[242:243], v88 offset:11264
    ds_read_b64_tr_b16 v[244:245], v88 offset:10752
    ds_read_b64_tr_b16 v[246:247], v88 offset:11776
    ds_read_b64_tr_b16 v[248:249], v88 offset:12288
    ds_read_b64_tr_b16 v[250:251], v88 offset:13312
    ds_read_b64_tr_b16 v[252:253], v88 offset:12800
    ds_read_b64_tr_b16 v[254:255], v88 offset:13824
    s_add_u32 s76, s80, 0
    buffer_load_dwordx2 v[128:129], v2, s[28:31], s76 offen offset:0 sc1
    buffer_load_dwordx2 v[130:131], v2, s[28:31], s76 offen offset:2048 sc1
    s_add_u32 s76, s80, 4096
    buffer_load_dwordx2 v[132:133], v2, s[28:31], s76 offen offset:0 sc1
    buffer_load_dwordx2 v[134:135], v2, s[28:31], s76 offen offset:2048 sc1
    s_add_u32 s76, s80, 8192
    buffer_load_dwordx2 v[136:137], v2, s[28:31], s76 offen offset:0 sc1
    buffer_load_dwordx2 v[138:139], v2, s[28:31], s76 offen offset:2048 sc1
    s_add_u32 s76, s80, 12288
    buffer_load_dwordx2 v[140:141], v2, s[28:31], s76 offen offset:0 sc1
    buffer_load_dwordx2 v[142:143], v2, s[28:31], s76 offen offset:2048 sc1
    s_add_u32 s76, s80, 16384
    buffer_load_dwordx2 v[144:145], v2, s[28:31], s76 offen offset:0 sc1
    buffer_load_dwordx2 v[146:147], v2, s[28:31], s76 offen offset:2048 sc1
    s_add_u32 s76, s80, 20480
    buffer_load_dwordx2 v[148:149], v2, s[28:31], s76 offen offset:0 sc1
    buffer_load_dwordx2 v[150:151], v2, s[28:31], s76 offen offset:2048 sc1
    s_add_u32 s76, s80, 24576
    buffer_load_dwordx2 v[152:153], v2, s[28:31], s76 offen offset:0 sc1
    buffer_load_dwordx2 v[154:155], v2, s[28:31], s76 offen offset:2048 sc1
    s_add_u32 s76, s80, 28672
    buffer_load_dwordx2 v[156:157], v2, s[28:31], s76 offen offset:0 sc1
    buffer_load_dwordx2 v[158:159], v2, s[28:31], s76 offen offset:2048 sc1
    s_waitcnt lgkmcnt(0)
    v_mov_b32 v168, 0x3f80
    v_mov_b32 v169, 0x3f800000
SU148:
    s_waitcnt vmcnt(12)
    v_dot2_f32_bf16 v160, v128, v168, 0
    v_dot2_f32_bf16 v161, v128, v169, 0
    v_dot2_f32_bf16 v162, v129, v168, 0
    v_dot2_f32_bf16 v163, v129, v169, 0
    v_dot2_f32_bf16 v164, v130, v168, 0
    v_dot2_f32_bf16 v165, v130, v169, 0
    v_dot2_f32_bf16 v166, v131, v168, 0
    v_dot2_f32_bf16 v167, v131, v169, 0
    v_dot2_f32_bf16 v160, v132, v168, v160
    v_dot2_f32_bf16 v161, v132, v169, v161
    v_dot2_f32_bf16 v162, v133, v168, v162
    v_dot2_f32_bf16 v163, v133, v169, v163
    v_dot2_f32_bf16 v164, v134, v168, v164
    v_dot2_f32_bf16 v165, v134, v169, v165
    v_dot2_f32_bf16 v166, v135, v168, v166
    v_dot2_f32_bf16 v167, v135, v169, v167
    v_max3_u32 v63, v129, v131, v133
    v_max_u32 v63, v63, v135
    s_waitcnt vmcnt(8)
    v_dot2_f32_bf16 v160, v136, v168, v160
    v_dot2_f32_bf16 v161, v136, v169, v161
    v_dot2_f32_bf16 v162, v137, v168, v162
    v_dot2_f32_bf16 v163, v137, v169, v163
    v_dot2_f32_bf16 v164, v138, v168, v164
    v_dot2_f32_bf16 v165, v138, v169, v165
    v_dot2_f32_bf16 v166, v139, v168, v166
    v_dot2_f32_bf16 v167, v139, v169, v167
    v_dot2_f32_bf16 v160, v140, v168, v160
    v_dot2_f32_bf16 v161, v140, v169, v161
    v_dot2_f32_bf16 v162, v141, v168, v162
    v_dot2_f32_bf16 v163, v141, v169, v163
    v_dot2_f32_bf16 v164, v142, v168, v164
    v_dot2_f32_bf16 v165, v142, v169, v165
    v_dot2_f32_bf16 v166, v143, v168, v166
    v_dot2_f32_bf16 v167, v143, v169, v167
    v_max3_u32 v63, v63, v137, v139
    v_max3_u32 v63, v63, v141, v143
    s_waitcnt vmcnt(4)
    v_dot2_f32_bf16 v160, v144, v168, v160
    v_dot2_f32_bf16 v161, v144, v169, v161
    v_dot2_f32_bf16 v162, v145, v168, v162
    v_dot2_f32_bf16 v163, v145, v169, v163
    v_dot2_f32_bf16 v164, v146, v168, v164
    v_dot2_f32_bf16 v165, v146, v169, v165
    v_dot2_f32_bf16 v166, v147, v168, v166
    v_dot2_f32_bf16 v167, v147, v169, v167
    v_dot2_f32_bf16 v160, v148, v168, v160
    v_dot2_f32_bf16 v161, v148, v169, v161
    v_dot2_f32_bf16 v162, v149, v168, v162
    v_dot2_f32_bf16 v163, v149, v169, v163
    v_dot2_f32_bf16 v164, v150, v168, v164
    v_dot2_f32_bf16 v165, v150, v169, v165
    v_dot2_f32_bf16 v166, v151, v168, v166
    v_dot2_f32_bf16 v167, v151, v169, v167
    v_max3_u32 v63, v63, v145, v147
    v_max3_u32 v63, v63, v149, v151
    s_waitcnt vmcnt(0)
    v_dot2_f32_bf16 v160, v152, v168, v160
    v_dot2_f32_bf16 v161, v152, v169, v161
    v_dot2_f32_bf16 v162, v153, v168, v162
    v_dot2_f32_bf16 v163, v153, v169, v163
    v_dot2_f32_bf16 v164, v154, v168, v164
    v_dot2_f32_bf16 v165, v154, v169, v165
    v_dot2_f32_bf16 v166, v155, v168, v166
    v_dot2_f32_bf16 v167, v155, v169, v167
    v_dot2_f32_bf16 v160, v156, v168, v160
    v_dot2_f32_bf16 v161, v156, v169, v161
    v_dot2_f32_bf16 v162, v157, v168, v162
    v_dot2_f32_bf16 v163, v157, v169, v163
    v_dot2_f32_bf16 v164, v158, v168, v164
    v_dot2_f32_bf16 v165, v158, v169, v165
    v_dot2_f32_bf16 v166, v159, v168, v166
    v_dot2_f32_bf16 v167, v159, v169, v167
    v_max3_u32 v63, v63, v153, v155
    v_max3_u32 v63, v63, v157, v159
    v_cmp_eq_u32 vcc, -1, v63
    s_cbranch_vccnz SR149
SR149x:
    v_pk_add_f32 v[160:161], v[160:161], v[164:165]
    v_pk_add_f32 v[162:163], v[162:163], v[166:167]
    v_cvt_pk_bf16_f32 v128, v160, v161
    v_cvt_pk_bf16_f32 v129, v162, v163
    v_lshl_add_u32 v60, v0, 3, s59
    v_lshlrev_b32 v61, 3, v0
    v_add_u32 v61, 151552, v61
    ds_write_b64 v60, v[128:129]
    s_add_u32 s81, s69, 3145728
    s_waitcnt lgkmcnt(0)
    s_barrier
    ds_read_b64 v[136:137], v61 offset:0
    ds_read_b64 v[138:139], v61 offset:3072
    ds_read_b64 v[140:141], v61 offset:6144
    ds_read_b64 v[142:143], v61 offset:9216
    s_xor_b32 s3, s48, 1
    s_lshl_b32 s3, s3, 14
    s_add_u32 s3, s3, 86016
    v_add_u32 v10, s3, v1
    s_xor_b32 s3, s48, 2
    s_lshl_b32 s3, s3, 14
    s_add_u32 s3, s3, 88064
    v_add_u32 v11, s3, v1
    s_xor_b32 s3, s48, 3
    s_lshl_b32 s3, s3, 14
    s_add_u32 s3, s3, 90112
    v_add_u32 v12, s3, v1
    s_waitcnt lgkmcnt(0)
    v_mfma_f32_32x32x16_bf16 v[64:79], v[136:139], v[48:51], 0
    v_mfma_f32_32x32x16_bf16 v[64:79], v[140:143], v[52:55], v[64:79]
    v_add_u32 v13, s58, v1
    s_lshl_b32 s80, s51, 16
    s_add_u32 s80, s80, 4194304
    s_lshl_b32 s3, s48, 13
    s_add_u32 s80, s80, s3
    s_and_b32 s3, s48, 1
    s_lshl_b32 s3, s3, 15
    s_add_u32 s6, s80, s3
    s_xor_b32 s3, s3, 32768
    s_add_u32 s7, s80, s3
    v_and_b32 v14, 3, v0
    v_lshlrev_b32 v14, 11, v14
    v_bfe_u32 v61, v0, 2, 1
    v_lshl_add_u32 v14, v61, 15, v14
    v_add_u32 v14, 2044, v14
    s_lshr_b32 s3, s48, 1
    s_lshl_b32 s3, s3, 8
    v_xor_b32 v8, s3, v1
    v_mov_b32 v60, v76
    v_mov_b32 v61, v76
    s_nop 1
    v_permlane32_swap_b32 v60, v61
    v_add_f32 v61, 0x358637bd, v61
    v_rcp_f32 v60, v61
    s_nop 0
    v_pk_mul_f32 v[64:65], v[64:65], v[60:61] op_sel_hi:[1,0]
    v_pk_mul_f32 v[66:67], v[66:67], v[60:61] op_sel_hi:[1,0]
    v_pk_mul_f32 v[68:69], v[68:69], v[60:61] op_sel_hi:[1,0]
    v_pk_mul_f32 v[70:71], v[70:71], v[60:61] op_sel_hi:[1,0]
    v_pk_mul_f32 v[72:73], v[72:73], v[60:61] op_sel_hi:[1,0]
    v_pk_mul_f32 v[74:75], v[74:75], v[60:61] op_sel_hi:[1,0]
    v_pk_mul_f32 v[76:77], v[76:77], v[60:61] op_sel_hi:[1,0]
    v_pk_mul_f32 v[78:79], v[78:79], v[60:61] op_sel_hi:[1,0]
    v_cvt_pk_bf16_f32 v48, v64, v65
    v_cvt_pk_bf16_f32 v49, v66, v67
    v_cvt_pk_bf16_f32 v50, v68, v69
    v_cvt_pk_bf16_f32 v51, v70, v71
    v_cvt_pk_bf16_f32 v52, v72, v73
    v_cvt_pk_bf16_f32 v53, v74, v75
    v_cvt_pk_bf16_f32 v54, v76, v77
    v_cvt_pk_bf16_f32 v55, v78, v79
    v_and_b32 v54, v6, v54
    v_and_b32 v55, v6, v55
    s_cmp_lg_u32 s79, 1
    s_cbranch_scc1 PL150
    buffer_store_dwordx4 v[48:51], v1, s[28:31], s81 offen
    buffer_store_dwordx4 v[52:55], v1, s[28:31], s81 offen offset:1024
PE151:
    s_cmp_eq_u32 s55, 0
    s_cbranch_scc1 L_side1
    s_waitcnt vmcnt(0)
    s_add_u32 s76, s7, 0
    buffer_load_dwordx4 v[160:163], v1, s[28:31], s76 offen offset:0 sc1
    buffer_load_dwordx4 v[164:167], v1, s[28:31], s76 offen offset:1024 sc1
    buffer_load_dwordx4 v[168:171], v1, s[28:31], s76 offen offset:2048 sc1
    buffer_load_dwordx4 v[172:175], v1, s[28:31], s76 offen offset:3072 sc1
    s_add_u32 s76, s7, 4096
    buffer_load_dwordx4 v[176:179], v1, s[28:31], s76 offen offset:0 sc1
    buffer_load_dwordx4 v[180:183], v1, s[28:31], s76 offen offset:1024 sc1
    buffer_load_dwordx4 v[184:187], v1, s[28:31], s76 offen offset:2048 sc1
    buffer_load_dwordx4 v[188:191], v1, s[28:31], s76 offen offset:3072 sc1
    s_add_u32 s76, s6, 0
    buffer_load_dwordx4 v[128:131], v1, s[28:31], s76 offen offset:0 sc1
    buffer_load_dwordx4 v[132:135], v1, s[28:31], s76 offen offset:1024 sc1
    buffer_load_dwordx4 v[136:139], v1, s[28:31], s76 offen offset:2048 sc1
    buffer_load_dwordx4 v[140:143], v1, s[28:31], s76 offen offset:3072 sc1
    s_add_u32 s76, s6, 4096
    buffer_load_dwordx4 v[144:147], v1, s[28:31], s76 offen offset:0 sc1
    buffer_load_dwordx4 v[148:151], v1, s[28:31], s76 offen offset:1024 sc1
    buffer_load_dwordx4 v[152:155], v1, s[28:31], s76 offen offset:2048 sc1
    buffer_load_dwordx4 v[156:159], v1, s[28:31], s76 offen offset:3072 sc1
    s_waitcnt vmcnt(8)
    v_max3_u32 v63, v163, v167, v171
    v_max3_u32 v63, v63, v175, v179
    v_max3_u32 v63, v63, v183, v187
    v_max_u32 v63, v63, v191
    v_cmp_eq_u32 vcc, -1, v63
    s_cbranch_vccnz RT152
CD153:
    v_mfma_f32_32x32x16_bf16 v[80:95], v[192:195], v[160:163], 0
    v_mfma_f32_32x32x16_bf16 v[80:95], v[200:203], v[164:167], v[80:95]
    v_mfma_f32_32x32x16_bf16 v[80:95], v[208:211], v[168:171], v[80:95]
    v_mfma_f32_32x32x16_bf16 v[80:95], v[216:219], v[172:175], v[80:95]
    v_mfma_f32_32x32x16_bf16 v[80:95], v[224:227], v[176:179], v[80:95]
    v_mfma_f32_32x32x16_bf16 v[80:95], v[232:235], v[180:183], v[80:95]
    v_mfma_f32_32x32x16_bf16 v[80:95], v[240:243], v[184:187], v[80:95]
    v_mfma_f32_32x32x16_bf16 v[80:95], v[248:251], v[188:191], v[80:95]
    v_mfma_f32_32x32x16_bf16 v[112:127], v[196:199], v[160:163], 0
    v_mfma_f32_32x32x16_bf16 v[112:127], v[204:207], v[164:167], v[112:127]
    s_waitcnt vmcnt(0)
    v_max3_u32 v63, v131, v135, v139
    v_max3_u32 v63, v63, v143, v147
    v_mfma_f32_32x32x16_bf16 v[112:127], v[212:215], v[168:171], v[112:127]
    ds_write_b128 v10, v[80:83] offset:0
    v_max3_u32 v63, v63, v151, v155
    v_max_u32 v63, v63, v159
    v_cmp_eq_u32 vcc, -1, v63
    s_cbranch_vccnz RT154
CD155:
    v_mfma_f32_32x32x16_bf16 v[112:127], v[220:223], v[172:175], v[112:127]
    ds_write_b128 v10, v[84:87] offset:1024
    v_mfma_f32_32x32x16_bf16 v[112:127], v[228:231], v[176:179], v[112:127]
    ds_write_b128 v12, v[88:91] offset:0
    v_mfma_f32_32x32x16_bf16 v[112:127], v[236:239], v[180:183], v[112:127]
    ds_write_b128 v12, v[92:95] offset:1024
    v_mfma_f32_32x32x16_bf16 v[112:127], v[244:247], v[184:187], v[112:127]
    v_mfma_f32_32x32x16_bf16 v[112:127], v[252:255], v[188:191], v[112:127]
    v_mfma_f32_32x32x16_bf16 v[64:79], v[192:195], v[128:131], 0
    v_mfma_f32_32x32x16_bf16 v[64:79], v[200:203], v[132:135], v[64:79]
    v_mfma_f32_32x32x16_bf16 v[64:79], v[208:211], v[136:139], v[64:79]
    ds_write_b128 v10, v[112:115] offset:6144
    v_mfma_f32_32x32x16_bf16 v[64:79], v[216:219], v[140:143], v[64:79]
    ds_write_b128 v10, v[116:119] offset:7168
    v_mfma_f32_32x32x16_bf16 v[64:79], v[224:227], v[144:147], v[64:79]
    ds_write_b128 v12, v[120:123] offset:6144
    v_mfma_f32_32x32x16_bf16 v[64:79], v[232:235], v[148:151], v[64:79]
    ds_write_b128 v12, v[124:127] offset:7168
    v_mfma_f32_32x32x16_bf16 v[64:79], v[240:243], v[152:155], v[64:79]
    v_mfma_f32_32x32x16_bf16 v[64:79], v[248:251], v[156:159], v[64:79]
    v_mfma_f32_32x32x16_bf16 v[96:111], v[196:199], v[128:131], 0
    v_mfma_f32_32x32x16_bf16 v[96:111], v[204:207], v[132:135], v[96:111]
    v_mfma_f32_32x32x16_bf16 v[96:111], v[212:215], v[136:139], v[96:111]
    ds_write_b128 v11, v[72:75] offset:0
    v_mfma_f32_32x32x16_bf16 v[96:111], v[220:223], v[140:143], v[96:111]
    ds_write_b128 v11, v[76:79] offset:1024
    v_mfma_f32_32x32x16_bf16 v[96:111], v[228:231], v[144:147], v[96:111]
    v_mfma_f32_32x32x16_bf16 v[96:111], v[236:239], v[148:151], v[96:111]
    v_mfma_f32_32x32x16_bf16 v[96:111], v[244:247], v[152:155], v[96:111]
    v_mfma_f32_32x32x16_bf16 v[96:111], v[252:255], v[156:159], v[96:111]
    s_nop 11
    ds_write_b128 v11, v[104:107] offset:6144
    ds_write_b128 v11, v[108:111] offset:7168
    s_waitcnt lgkmcnt(0)
    s_barrier
    ds_read_b128 v[128:131], v13 offset:0
    ds_read_b128 v[132:135], v13 offset:1024
    ds_read_b128 v[136:139], v13 offset:2048
    ds_read_b128 v[140:143], v13 offset:3072
    ds_read_b128 v[144:147], v13 offset:4096
    ds_read_b128 v[148:151], v13 offset:5120
    ds_read_b128 v[152:155], v13 offset:6144
    ds_read_b128 v[156:159], v13 offset:7168
    ds_read_b128 v[160:163], v13 offset:8192
    ds_read_b128 v[164:167], v13 offset:9216
    ds_read_b128 v[168:171], v13 offset:10240
    ds_read_b128 v[172:175], v13 offset:11264
    v_pk_add_f32 v[32:33], v[32:33], v[64:65]
    v_pk_add_f32 v[34:35], v[34:35], v[66:67]
    v_pk_add_f32 v[36:37], v[36:37], v[68:69]
    v_pk_add_f32 v[38:39], v[38:39], v[70:71]
    v_pk_add_f32 v[40:41], v[40:41], v[96:97]
    v_pk_add_f32 v[42:43], v[42:43], v[98:99]
    v_pk_add_f32 v[44:45], v[44:45], v[100:101]
    v_pk_add_f32 v[46:47], v[46:47], v[102:103]
    s_waitcnt lgkmcnt(6)
    v_pk_add_f32 v[128:129], v[128:129], v[136:137]
    v_pk_add_f32 v[130:131], v[130:131], v[138:139]
    v_pk_add_f32 v[132:133], v[132:133], v[140:141]
    v_pk_add_f32 v[134:135], v[134:135], v[142:143]
    v_pk_add_f32 v[32:33], v[32:33], v[144:145]
    v_pk_add_f32 v[34:35], v[34:35], v[146:147]
    v_pk_add_f32 v[36:37], v[36:37], v[148:149]
    v_pk_add_f32 v[38:39], v[38:39], v[150:151]
    v_pk_add_f32 v[32:33], v[32:33], v[128:129]
    v_pk_add_f32 v[34:35], v[34:35], v[130:131]
    v_pk_add_f32 v[36:37], v[36:37], v[132:133]
    v_pk_add_f32 v[38:39], v[38:39], v[134:135]
    s_waitcnt lgkmcnt(0)
    v_pk_add_f32 v[152:153], v[152:153], v[160:161]
    v_pk_add_f32 v[154:155], v[154:155], v[162:163]
    v_pk_add_f32 v[156:157], v[156:157], v[164:165]
    v_pk_add_f32 v[158:159], v[158:159], v[166:167]
    v_pk_add_f32 v[40:41], v[40:41], v[168:169]
    v_pk_add_f32 v[42:43], v[42:43], v[170:171]
    v_pk_add_f32 v[44:45], v[44:45], v[172:173]
    v_pk_add_f32 v[46:47], v[46:47], v[174:175]
    v_pk_add_f32 v[40:41], v[40:41], v[152:153]
    v_pk_add_f32 v[42:43], v[42:43], v[154:155]
    v_pk_add_f32 v[44:45], v[44:45], v[156:157]
    v_pk_add_f32 v[46:47], v[46:47], v[158:159]
    v_pk_add_f32 v[128:129], v[32:33], v[40:41]
    v_pk_add_f32 v[130:131], v[34:35], v[42:43]
    v_pk_add_f32 v[132:133], v[36:37], v[44:45]
    v_pk_add_f32 v[134:135], v[38:39], v[46:47]
    v_pk_mul_f32 v[136:137], v[32:33], v[32:33]
    v_pk_mul_f32 v[138:139], v[34:35], v[34:35]
    v_pk_mul_f32 v[140:141], v[36:37], v[36:37]
    v_pk_mul_f32 v[142:143], v[38:39], v[38:39]
    v_pk_fma_f32 v[136:137], v[40:41], v[40:41], v[136:137]
    v_pk_fma_f32 v[138:139], v[42:43], v[42:43], v[138:139]
    v_pk_fma_f32 v[140:141], v[44:45], v[44:45], v[140:141]
    v_pk_fma_f32 v[142:143], v[46:47], v[46:47], v[142:143]
    v_pk_add_f32 v[128:129], v[128:129], v[130:131]
    v_pk_add_f32 v[132:133], v[132:133], v[134:135]
    v_pk_add_f32 v[136:137], v[136:137], v[138:139]
    v_pk_add_f32 v[140:141], v[140:141], v[142:143]
    v_pk_add_f32 v[128:129], v[128:129], v[132:133]
    v_pk_add_f32 v[136:137], v[136:137], v[140:141]
    v_add_f32 v128, v128, v129
    v_add_f32 v136, v136, v137
    v_and_b32 v62, 31, v0
    v_lshrrev_b32 v61, 5, v0
    v_lshlrev_b32 v61, 2, v61
    v_permlane32_swap_b32 v128, v136
    v_lshl_add_u32 v61, v62, 3, v61
    s_add_u32 s81, s74, 229376
    v_add_f32 v128, v128, v136
    s_cmp_lg_u32 s79, 1
    s_cbranch_scc1 PL156
    buffer_store_dword v128, v61, s[28:31], s81 offen
PE157:
    s_lshl_b32 s3, s85, 8
    s_sub_u32 s80, s81, s3
    v_lshlrev_b32 v62, 3, v0
    v_and_b32 v60, 31, v0
    v_bfe_u32 v61, v0, 1, 3
    v_lshrrev_b32 v63, 5, v0
    v_xor_b32 v161, v61, v63
    v_lshl_add_u32 v160, v60, 6, s59
    v_xor_b32 v60, 0, v161
    v_lshl_add_u32 v164, v60, 3, v160
    v_xor_b32 v60, 2, v161
    v_lshl_add_u32 v165, v60, 3, v160
    v_xor_b32 v60, 4, v161
    v_lshl_add_u32 v166, v60, 3, v160
    v_xor_b32 v60, 6, v161
    v_lshl_add_u32 v167, v60, 3, v160
    v_bfe_u32 v60, v0, 2, 2
    v_lshl_add_u32 v61, v63, 2, v60
    v_bfe_u32 v60, v0, 4, 1
    v_lshlrev_b32 v9, 17, v60
    v_lshl_add_u32 v9, v63, 9, v9
    v_and_b32 v63, 15, v0
    v_lshl_add_u32 v9, v63, 4, v9
    s_lshr_b32 s3, s48, 1
    s_lshl_b32 s3, s3, 8
    v_add_u32 v9, s3, v9
    v_and_b32 v63, 3, v0
    v_lshl_add_u32 v60, v60, 2, v63
    v_lshrrev_b32 v63, 1, v61
    v_xor_b32 v60, v60, v63
    v_lshl_add_u32 v61, v61, 6, s59
    v_lshl_add_u32 v162, v60, 3, v61
    v_xor_b32 v60, 4, v60
    v_lshl_add_u32 v163, v60, 3, v61
    s_add_u32 s81, s75, 1835008
    buffer_load_dwordx2 v[144:145], v62, s[28:31], s80 offen offset:0 sc1
    buffer_load_dwordx2 v[146:147], v62, s[28:31], s80 offen offset:512 sc1
    buffer_load_dwordx2 v[148:149], v62, s[28:31], s80 offen offset:1024 sc1
    buffer_load_dwordx2 v[150:151], v62, s[28:31], s80 offen offset:1536 sc1
    buffer_load_dwordx2 v[152:153], v62, s[28:31], s80 offen offset:2048 sc1
    buffer_load_dwordx2 v[154:155], v62, s[28:31], s80 offen offset:2560 sc1
    buffer_load_dwordx2 v[156:157], v62, s[28:31], s80 offen offset:3072 sc1
    s_waitcnt vmcnt(0)
    v_max3_u32 v63, v144, v145, v146
    v_max3_u32 v63, v63, v147, v148
    v_max3_u32 v63, v63, v149, v150
    v_max3_u32 v63, v63, v151, v152
    v_max3_u32 v63, v63, v153, v154
    v_max3_u32 v63, v63, v155, v156
    v_max_u32 v63, v63, v157
    v_cmp_eq_u32 vcc, -1, v63
    s_cbranch_vccnz RT158
CD159:
    v_pk_add_f32 v[144:145], v[144:145], v[146:147]
    v_pk_add_f32 v[148:149], v[148:149], v[150:151]
    v_pk_add_f32 v[152:153], v[152:153], v[154:155]
    v_pk_add_f32 v[144:145], v[144:145], v[148:149]
    v_pk_add_f32 v[152:153], v[152:153], v[156:157]
    v_pk_add_f32 v[144:145], v[144:145], v[152:153]
    s_nop 1
    v_permlane32_swap_b32 v144, v145
    v_add_f32 v144, v144, v145
    v_mov_b32 v61, v144
    v_mov_b32 v60, v144
    s_nop 1
    v_permlane32_swap_b32 v60, v61
    v_mul_f32 v60, 0x3b124925, v60
    v_mul_f32 v61, 0x3b124925, v61
    v_fma_f32 v61, -v60, v60, v61
    v_max_f32 v61, 0, v61
    v_add_f32 v62, 0x3727c5ac, v61
    v_rsq_f32 v62, v62
    v_mov_b32 v63, 0x3727c5ac
    v_mul_f32 v61, v61, v62
    v_fma_f32 v61, v61, v62, v63
    v_rsq_f32 v61, v61
    s_nop 0
    v_mul_f32 v62, v62, v61
    v_mul_f32 v63, v60, v62
    v_pk_fma_f32 v[64:65], v[32:33], v[62:63], v[62:63] op_sel:[0,0,1] op_sel_hi:[1,0,1] neg_lo:[0,0,1] neg_hi:[0,0,1]
    v_pk_fma_f32 v[66:67], v[34:35], v[62:63], v[62:63] op_sel:[0,0,1] op_sel_hi:[1,0,1] neg_lo:[0,0,1] neg_hi:[0,0,1]
    v_pk_fma_f32 v[68:69], v[36:37], v[62:63], v[62:63] op_sel:[0,0,1] op_sel_hi:[1,0,1] neg_lo:[0,0,1] neg_hi:[0,0,1]
    v_pk_fma_f32 v[70:71], v[38:39], v[62:63], v[62:63] op_sel:[0,0,1] op_sel_hi:[1,0,1] neg_lo:[0,0,1] neg_hi:[0,0,1]
    v_pk_fma_f32 v[72:73], v[40:41], v[62:63], v[62:63] op_sel:[0,0,1] op_sel_hi:[1,0,1] neg_lo:[0,0,1] neg_hi:[0,0,1]
    v_pk_fma_f32 v[74:75], v[42:43], v[62:63], v[62:63] op_sel:[0,0,1] op_sel_hi:[1,0,1] neg_lo:[0,0,1] neg_hi:[0,0,1]
    v_pk_fma_f32 v[76:77], v[44:45], v[62:63], v[62:63] op_sel:[0,0,1] op_sel_hi:[1,0,1] neg_lo:[0,0,1] neg_hi:[0,0,1]
    v_pk_fma_f32 v[78:79], v[46:47], v[62:63], v[62:63] op_sel:[0,0,1] op_sel_hi:[1,0,1] neg_lo:[0,0,1] neg_hi:[0,0,1]
    v_cvt_pk_bf16_f32 v128, v64, v65
    v_cvt_pk_bf16_f32 v129, v66, v67
    v_cvt_pk_bf16_f32 v130, v68, v69
    v_cvt_pk_bf16_f32 v131, v70, v71
    v_cvt_pk_bf16_f32 v132, v72, v73
    v_cvt_pk_bf16_f32 v133, v74, v75
    v_cvt_pk_bf16_f32 v134, v76, v77
    v_cvt_pk_bf16_f32 v135, v78, v79
    ds_write_b64 v164, v[128:129]
    ds_write_b64 v165, v[130:131]
    ds_write_b64 v166, v[132:133]
    ds_write_b64 v167, v[134:135]
    ds_read_b64_tr_b16 v[80:81], v162 offset:0
    ds_read_b64_tr_b16 v[82:83], v163 offset:512
    ds_read_b64_tr_b16 v[84:85], v162 offset:1024
    ds_read_b64_tr_b16 v[86:87], v163 offset:1536
    s_waitcnt lgkmcnt(0)
    buffer_store_dwordx4 v[80:83], v9, s[28:31], s81 offen sc0 sc1
    buffer_store_dwordx4 v[84:87], v9, s[28:31], s81 offen offset:1024 sc0 sc1
    s_lshl_b32 s3, s54, 7
    s_and_b32 s76, s48, 1
    s_lshl_b32 s76, s76, 6
    s_add_u32 s76, s76, s3
    s_lshr_b32 s3, s48, 1
    s_lshl_b32 s3, s3, 5
    s_add_u32 s76, s76, s3
    v_lshrrev_b32 v61, 5, v0
    v_lshlrev_b32 v61, 3, v61
    buffer_load_dwordx2 v[248:249], v61, s[36:39], s76 offen offset:0
    buffer_load_dwordx2 v[250:251], v61, s[36:39], s76 offen offset:16
    s_and_b32 s3, s53, 1
    s_lshl_b32 s3, s3, 2
    s_add_u32 s3, s3, s48
    s_mul_i32 s4, s3, 16384
    s_add_u32 s4, s4, 8126464
    s_and_b32 s3, s53, 6
    s_mul_i32 s80, s3, 262144
    s_add_u32 s80, s80, s4
    s_cmp_eq_u32 s3, 6
    s_cselect_b32 s3, 1073741824, 0
    s_cselect_b32 s4, 0, 262144
    s_add_u32 s3, s3, s4
    s_add_u32 s4, s80, s3
    s_bitcmp1_b32 s53, 0
    s_cselect_b32 s6, s80, s4
    s_cselect_b32 s7, s4, s80
    v_bfe_u32 v60, v0, 4, 1
    v_mul_lo_u32 v60, v60, s3
    v_and_b32 v14, 1, v0
    v_lshl_add_u32 v14, v14, 8, v60
    v_bfe_u32 v60, v0, 1, 3
    v_lshl_add_u32 v14, v60, 11, v14
    v_add_u32 v14, 1788, v14
    s_and_b32 s3, s52, 1
    s_lshl_b32 s3, s3, 2
    s_add_u32 s3, s3, s48
    s_mul_i32 s4, s3, 14336
    s_add_u32 s4, s4, 11567104
    s_and_b32 s3, s52, 6
    s_mul_i32 s10, s3, 229376
    s_add_u32 s10, s10, s4
    s_cmp_eq_u32 s3, 6
    s_cselect_b32 s3, 1073741824, 0
    s_cselect_b32 s4, 0, 229376
    s_add_u32 s3, s3, s4
    s_add_u32 s4, s10, s3
    s_bitcmp1_b32 s52, 0
    s_cselect_b32 s8, s10, s4
    s_cselect_b32 s9, s4, s10
    v_and_b32 v15, 15, v0
    v_min_u32 v15, 13, v15
    v_lshlrev_b32 v15, 10, v15
    v_bfe_u32 v60, v0, 4, 1
    v_mul_lo_u32 v60, v60, s3
    v_add3_u32 v15, v15, v60, 4
    v_and_b32 v61, 31, v0
    v_lshrrev_b32 v60, 5, v0
    v_mul_u32_u24 v9, 896, v61
    v_lshl_add_u32 v9, v60, 4, v9
    s_waitcnt vmcnt(0)
    s_waitcnt lgkmcnt(0)
    s_barrier
    buffer_load_dword v62, v14, s[28:31], s80 offen sc1
    s_add_u32 s77, s6, 0
    buffer_load_dwordx4 v[128:131], v1, s[28:31], s77 offen offset:0 sc1
    buffer_load_dwordx4 v[132:135], v1, s[28:31], s77 offen offset:1024 sc1
    buffer_load_dwordx4 v[136:139], v1, s[28:31], s77 offen offset:2048 sc1
    buffer_load_dwordx4 v[140:143], v1, s[28:31], s77 offen offset:3072 sc1
    s_add_u32 s77, s6, 4096
    buffer_load_dwordx4 v[144:147], v1, s[28:31], s77 offen offset:0 sc1
    buffer_load_dwordx4 v[148:151], v1, s[28:31], s77 offen offset:1024 sc1
    buffer_load_dwordx4 v[152:155], v1, s[28:31], s77 offen offset:2048 sc1
    buffer_load_dwordx4 v[156:159], v1, s[28:31], s77 offen offset:3072 sc1
    s_add_u32 s77, s6, 8192
    buffer_load_dwordx4 v[160:163], v1, s[28:31], s77 offen offset:0 sc1
    buffer_load_dwordx4 v[164:167], v1, s[28:31], s77 offen offset:1024 sc1
    buffer_load_dwordx4 v[168:171], v1, s[28:31], s77 offen offset:2048 sc1
    buffer_load_dwordx4 v[172:175], v1, s[28:31], s77 offen offset:3072 sc1
    s_add_u32 s77, s6, 12288
    buffer_load_dwordx4 v[176:179], v1, s[28:31], s77 offen offset:0 sc1
    buffer_load_dwordx4 v[180:183], v1, s[28:31], s77 offen offset:1024 sc1
    buffer_load_dwordx4 v[184:187], v1, s[28:31], s77 offen offset:2048 sc1
    buffer_load_dwordx4 v[188:191], v1, s[28:31], s77 offen offset:3072 sc1
    v_lshlrev_b32 v48, 16, v248
    v_and_b32 v49, 0xffff0000, v248
    v_lshlrev_b32 v50, 16, v249
    v_and_b32 v51, 0xffff0000, v249
    v_lshlrev_b32 v52, 16, v250
    v_and_b32 v53, 0xffff0000, v250
    v_lshlrev_b32 v54, 16, v251
    v_and_b32 v55, 0xffff0000, v251
    s_waitcnt vmcnt(12)
    v_max3_u32 v63, v131, v135, v139
    v_max3_u32 v63, v63, v143, v62
    v_cmp_eq_u32 vcc, -1, v63
    s_cbranch_vccnz RT160
CD161:
    v_mfma_f32_32x32x16_bf16 v[64:79], a[0:3], v[128:131], 0
    s_add_u32 s77, s7, 0
    buffer_load_dwordx4 v[192:195], v1, s[28:31], s77 offen offset:0 sc1
    v_mfma_f32_32x32x16_bf16 v[80:95], a[4:7], v[128:131], 0
    v_mfma_f32_32x32x16_bf16 v[64:79], a[8:11], v[132:135], v[64:79]
    buffer_load_dwordx4 v[196:199], v1, s[28:31], s77 offen offset:1024 sc1
    v_mfma_f32_32x32x16_bf16 v[80:95], a[12:15], v[132:135], v[80:95]
    v_mfma_f32_32x32x16_bf16 v[64:79], a[16:19], v[136:139], v[64:79]
    buffer_load_dwordx4 v[200:203], v1, s[28:31], s77 offen offset:2048 sc1
    s_waitcnt vmcnt(11)
    v_max3_u32 v63, v147, v151, v155
    v_max_u32 v63, v63, v159
    v_mfma_f32_32x32x16_bf16 v[80:95], a[20:23], v[136:139], v[80:95]
    v_cmp_eq_u32 s[40:41], -1, v63
    v_mfma_f32_32x32x16_bf16 v[64:79], a[24:27], v[140:143], v[64:79]
    buffer_load_dwordx4 v[204:207], v1, s[28:31], s77 offen offset:3072 sc1
    s_cmp_lg_u64 s[40:41], 0
    s_cbranch_scc1 RT162
CD163:
    v_mfma_f32_32x32x16_bf16 v[80:95], a[28:31], v[140:143], v[80:95]
    v_mfma_f32_32x32x16_bf16 v[64:79], a[32:35], v[144:147], v[64:79]
    s_add_u32 s77, s7, 4096
    buffer_load_dwordx4 v[208:211], v1, s[28:31], s77 offen offset:0 sc1
    v_mfma_f32_32x32x16_bf16 v[80:95], a[36:39], v[144:147], v[80:95]
    v_mfma_f32_32x32x16_bf16 v[64:79], a[40:43], v[148:151], v[64:79]
    buffer_load_dwordx4 v[212:215], v1, s[28:31], s77 offen offset:1024 sc1
    v_mfma_f32_32x32x16_bf16 v[80:95], a[44:47], v[148:151], v[80:95]
    v_mfma_f32_32x32x16_bf16 v[64:79], a[48:51], v[152:155], v[64:79]
    buffer_load_dwordx4 v[128:131], v1, s[28:31], s77 offen offset:2048 sc1
    s_waitcnt vmcnt(11)
    v_max3_u32 v63, v163, v167, v171
    v_max_u32 v63, v63, v175
    v_mfma_f32_32x32x16_bf16 v[80:95], a[52:55], v[152:155], v[80:95]
    v_cmp_eq_u32 s[40:41], -1, v63
    v_mfma_f32_32x32x16_bf16 v[64:79], a[56:59], v[156:159], v[64:79]
    buffer_load_dwordx4 v[132:135], v1, s[28:31], s77 offen offset:3072 sc1
    s_cmp_lg_u64 s[40:41], 0
    s_cbranch_scc1 RT164
CD165:
    v_mfma_f32_32x32x16_bf16 v[80:95], a[60:63], v[156:159], v[80:95]
    v_mfma_f32_32x32x16_bf16 v[64:79], a[64:67], v[160:163], v[64:79]
    s_add_u32 s77, s7, 8192
    buffer_load_dwordx4 v[136:139], v1, s[28:31], s77 offen offset:0 sc1
    v_mfma_f32_32x32x16_bf16 v[80:95], a[68:71], v[160:163], v[80:95]
    v_mfma_f32_32x32x16_bf16 v[64:79], a[72:75], v[164:167], v[64:79]
    buffer_load_dwordx4 v[140:143], v1, s[28:31], s77 offen offset:1024 sc1
    v_mfma_f32_32x32x16_bf16 v[80:95], a[76:79], v[164:167], v[80:95]
    v_mfma_f32_32x32x16_bf16 v[64:79], a[80:83], v[168:171], v[64:79]
    buffer_load_dwordx4 v[144:147], v1, s[28:31], s77 offen offset:2048 sc1
    s_waitcnt vmcnt(11)
    v_max3_u32 v63, v179, v183, v187
    v_max_u32 v63, v63, v191
    v_mfma_f32_32x32x16_bf16 v[80:95], a[84:87], v[168:171], v[80:95]
    v_cmp_eq_u32 s[40:41], -1, v63
    v_mfma_f32_32x32x16_bf16 v[64:79], a[88:91], v[172:175], v[64:79]
    buffer_load_dwordx4 v[148:151], v1, s[28:31], s77 offen offset:3072 sc1
    s_cmp_lg_u64 s[40:41], 0
    s_cbranch_scc1 RT166
CD167:
    v_mfma_f32_32x32x16_bf16 v[80:95], a[92:95], v[172:175], v[80:95]
    v_mfma_f32_32x32x16_bf16 v[64:79], a[96:99], v[176:179], v[64:79]
    s_add_u32 s77, s7, 12288
    buffer_load_dwordx4 v[152:155], v1, s[28:31], s77 offen offset:0 sc1
    v_mfma_f32_32x32x16_bf16 v[80:95], a[100:103], v[176:179], v[80:95]
    v_mfma_f32_32x32x16_bf16 v[64:79], a[104:107], v[180:183], v[64:79]
    buffer_load_dwordx4 v[156:159], v1, s[28:31], s77 offen offset:1024 sc1
    v_mfma_f32_32x32x16_bf16 v[80:95], a[108:111], v[180:183], v[80:95]
    v_mfma_f32_32x32x16_bf16 v[64:79], a[112:115], v[184:187], v[64:79]
    buffer_load_dwordx4 v[160:163], v1, s[28:31], s77 offen offset:2048 sc1
    s_waitcnt vmcnt(11)
    v_max3_u32 v63, v195, v199, v203
    v_max_u32 v63, v63, v207
    v_mfma_f32_32x32x16_bf16 v[80:95], a[116:119], v[184:187], v[80:95]
    v_cmp_eq_u32 s[40:41], -1, v63
    v_mfma_f32_32x32x16_bf16 v[64:79], a[120:123], v[188:191], v[64:79]
    buffer_load_dwordx4 v[164:167], v1, s[28:31], s77 offen offset:3072 sc1
    s_cmp_lg_u64 s[40:41], 0
    s_cbranch_scc1 RT168
CD169:
    v_mfma_f32_32x32x16_bf16 v[80:95], a[124:127], v[188:191], v[80:95]
    v_mfma_f32_32x32x16_bf16 v[96:111], a[0:3], v[192:195], 0
    s_add_u32 s77, s6, 131072
    buffer_load_dwordx4 v[168:171], v1, s[28:31], s77 offen offset:0 sc1
    v_mfma_f32_32x32x16_bf16 v[112:127], a[4:7], v[192:195], 0
    v_mfma_f32_32x32x16_bf16 v[96:111], a[8:11], v[196:199], v[96:111]
    buffer_load_dwordx4 v[172:175], v1, s[28:31], s77 offen offset:1024 sc1
    ds_write_b128 v10, v[80:83] offset:0
    v_mfma_f32_32x32x16_bf16 v[112:127], a[12:15], v[196:199], v[112:127]
    ds_write_b128 v10, v[84:87] offset:1024
    v_mfma_f32_32x32x16_bf16 v[96:111], a[16:19], v[200:203], v[96:111]
    buffer_load_dwordx4 v[176:179], v1, s[28:31], s77 offen offset:2048 sc1
    s_waitcnt vmcnt(11)
    v_max3_u32 v63, v211, v215, v131
    v_max_u32 v63, v63, v135
    v_mfma_f32_32x32x16_bf16 v[112:127], a[20:23], v[200:203], v[112:127]
    v_cmp_eq_u32 s[40:41], -1, v63
    ds_write_b128 v12, v[88:91] offset:0
    v_mfma_f32_32x32x16_bf16 v[96:111], a[24:27], v[204:207], v[96:111]
    buffer_load_dwordx4 v[180:183], v1, s[28:31], s77 offen offset:3072 sc1
    s_cmp_lg_u64 s[40:41], 0
    s_cbranch_scc1 RT170
CD171:
    ds_write_b128 v12, v[92:95] offset:1024
    v_mfma_f32_32x32x16_bf16 v[112:127], a[28:31], v[204:207], v[112:127]
    ds_write_b128 v11, v[72:75] offset:0
    v_mfma_f32_32x32x16_bf16 v[96:111], a[32:35], v[208:211], v[96:111]
    s_add_u32 s77, s6, 135168
    buffer_load_dwordx4 v[184:187], v1, s[28:31], s77 offen offset:0 sc1
    ds_write_b128 v11, v[76:79] offset:1024
    v_mfma_f32_32x32x16_bf16 v[112:127], a[36:39], v[208:211], v[112:127]
    v_mfma_f32_32x32x16_bf16 v[96:111], a[40:43], v[212:215], v[96:111]
    buffer_load_dwordx4 v[188:191], v1, s[28:31], s77 offen offset:1024 sc1
    v_mfma_f32_32x32x16_bf16 v[112:127], a[44:47], v[212:215], v[112:127]
    v_mfma_f32_32x32x16_bf16 v[96:111], a[48:51], v[128:131], v[96:111]
    buffer_load_dwordx4 v[192:195], v1, s[28:31], s77 offen offset:2048 sc1
    s_waitcnt vmcnt(11)
    v_max3_u32 v63, v139, v143, v147
    v_max_u32 v63, v63, v151
    v_mfma_f32_32x32x16_bf16 v[112:127], a[52:55], v[128:131], v[112:127]
    v_cmp_eq_u32 s[40:41], -1, v63
    s_waitcnt lgkmcnt(0)
    s_barrier
    ds_read_b128 v[224:227], v13 offset:0
    ds_read_b128 v[228:231], v13 offset:1024
    ds_read_b128 v[232:235], v13 offset:2048
    v_mfma_f32_32x32x16_bf16 v[96:111], a[56:59], v[132:135], v[96:111]
    buffer_load_dwordx4 v[196:199], v1, s[28:31], s77 offen offset:3072 sc1
    s_cmp_lg_u64 s[40:41], 0
    s_cbranch_scc1 RT172
CD173:
    ds_read_b128 v[236:239], v13 offset:3072
    v_mfma_f32_32x32x16_bf16 v[112:127], a[60:63], v[132:135], v[112:127]
    ds_read_b128 v[240:243], v13 offset:4096
    ds_read_b128 v[244:247], v13 offset:5120
    v_mfma_f32_32x32x16_bf16 v[96:111], a[64:67], v[136:139], v[96:111]
    s_add_u32 s77, s6, 139264
    buffer_load_dwordx4 v[200:203], v1, s[28:31], s77 offen offset:0 sc1
    v_mfma_f32_32x32x16_bf16 v[112:127], a[68:71], v[136:139], v[112:127]
    v_mfma_f32_32x32x16_bf16 v[96:111], a[72:75], v[140:143], v[96:111]
    buffer_load_dwordx4 v[204:207], v1, s[28:31], s77 offen offset:1024 sc1
    s_waitcnt lgkmcnt(0)
    v_add_f32 v224, v224, v232
    v_add_f32 v225, v225, v233
    v_add_f32 v226, v226, v234
    v_mfma_f32_32x32x16_bf16 v[112:127], a[76:79], v[140:143], v[112:127]
    v_add_f32 v227, v227, v235
    v_add_f32 v228, v228, v236
    v_add_f32 v229, v229, v237
    v_add_f32 v230, v230, v238
    v_add_f32 v231, v231, v239
    v_mfma_f32_32x32x16_bf16 v[96:111], a[80:83], v[144:147], v[96:111]
    buffer_load_dwordx4 v[208:211], v1, s[28:31], s77 offen offset:2048 sc1
    s_waitcnt vmcnt(11)
    v_max3_u32 v63, v155, v159, v163
    v_max_u32 v63, v63, v167
    v_mfma_f32_32x32x16_bf16 v[112:127], a[84:87], v[144:147], v[112:127]
    v_cmp_eq_u32 s[40:41], -1, v63
    v_add_f32 v64, v64, v240
    v_add_f32 v65, v65, v241
    v_add_f32 v66, v66, v242
    v_add_f32 v67, v67, v243
    v_mfma_f32_32x32x16_bf16 v[96:111], a[88:91], v[148:151], v[96:111]
    buffer_load_dwordx4 v[212:215], v1, s[28:31], s77 offen offset:3072 sc1
    s_cmp_lg_u64 s[40:41], 0
    s_cbranch_scc1 RT174
CD175:
    v_add_f32 v68, v68, v244
    v_add_f32 v69, v69, v245
    v_mfma_f32_32x32x16_bf16 v[112:127], a[92:95], v[148:151], v[112:127]
    v_add_f32 v70, v70, v246
    v_add_f32 v71, v71, v247
    v_add_f32 v64, v64, v224
    v_add_f32 v65, v65, v225
    v_add_f32 v66, v66, v226
    v_mfma_f32_32x32x16_bf16 v[96:111], a[96:99], v[152:155], v[96:111]
    s_add_u32 s77, s6, 143360
    buffer_load_dwordx4 v[128:131], v1, s[28:31], s77 offen offset:0 sc1
    v_add_f32 v67, v67, v227
    v_add_f32 v68, v68, v228
    v_add_f32 v69, v69, v229
    v_mfma_f32_32x32x16_bf16 v[112:127], a[100:103], v[152:155], v[112:127]
    v_add_f32 v70, v70, v230
    v_add_f32 v71, v71, v231
    v_cvt_pk_bf16_f32 v64, v64, v65
    v_cvt_pk_bf16_f32 v65, v66, v67
    v_cvt_pk_bf16_f32 v66, v68, v69
    v_mfma_f32_32x32x16_bf16 v[96:111], a[104:107], v[156:159], v[96:111]
    buffer_load_dwordx4 v[132:135], v1, s[28:31], s77 offen offset:1024 sc1
    v_cvt_pk_bf16_f32 v67, v70, v71
    s_add_u32 s81, s57, 8388608
    s_cmp_lg_u32 s79, 1
    s_cbranch_scc1 PL178
    buffer_store_dwordx4 v[64:67], v1, s[28:31], s81 offen
PE179:
    v_mfma_f32_32x32x16_bf16 v[112:127], a[108:111], v[156:159], v[112:127]
    v_mfma_f32_32x32x16_bf16 v[96:111], a[112:115], v[160:163], v[96:111]
    buffer_load_dwordx4 v[136:139], v1, s[28:31], s77 offen offset:2048 sc1
    s_waitcnt vmcnt(12)
    v_max3_u32 v63, v171, v175, v179
    v_max_u32 v63, v63, v183
    v_mfma_f32_32x32x16_bf16 v[112:127], a[116:119], v[160:163], v[112:127]
    v_cmp_eq_u32 s[40:41], -1, v63
    v_mfma_f32_32x32x16_bf16 v[96:111], a[120:123], v[164:167], v[96:111]
    buffer_load_dwordx4 v[140:143], v1, s[28:31], s77 offen offset:3072 sc1
    s_cmp_lg_u64 s[40:41], 0
    s_cbranch_scc1 RT176
CD177:
    v_mfma_f32_32x32x16_bf16 v[112:127], a[124:127], v[164:167], v[112:127]
    v_mfma_f32_32x32x16_bf16 v[64:79], a[0:3], v[168:171], 0
    s_add_u32 s77, s7, 131072
    buffer_load_dwordx4 v[144:147], v1, s[28:31], s77 offen offset:0 sc1
    v_mfma_f32_32x32x16_bf16 v[80:95], a[4:7], v[168:171], 0
    s_add_u32 s81, s82, 8388608
    buffer_load_dwordx4 v[216:219], v1, s[28:31], s81 offen sc1
    v_mfma_f32_32x32x16_bf16 v[64:79], a[8:11], v[172:175], v[64:79]
    buffer_load_dwordx4 v[148:151], v1, s[28:31], s77 offen offset:1024 sc1
    ds_write_b128 v10, v[112:115] offset:6144
    v_mfma_f32_32x32x16_bf16 v[80:95], a[12:15], v[172:175], v[80:95]
    ds_write_b128 v10, v[116:119] offset:7168
    v_mfma_f32_32x32x16_bf16 v[64:79], a[16:19], v[176:179], v[64:79]
    buffer_load_dwordx4 v[152:155], v1, s[28:31], s77 offen offset:2048 sc1
    s_waitcnt vmcnt(13)
    v_max3_u32 v63, v187, v191, v195
    v_max_u32 v63, v63, v199
    v_mfma_f32_32x32x16_bf16 v[80:95], a[20:23], v[176:179], v[80:95]
    v_cmp_eq_u32 s[40:41], -1, v63
    ds_write_b128 v12, v[120:123] offset:6144
    v_mfma_f32_32x32x16_bf16 v[64:79], a[24:27], v[180:183], v[64:79]
    buffer_load_dwordx4 v[156:159], v1, s[28:31], s77 offen offset:3072 sc1
    s_cmp_lg_u64 s[40:41], 0
    s_cbranch_scc1 RT180
CD181:
    ds_write_b128 v12, v[124:127] offset:7168
    v_mfma_f32_32x32x16_bf16 v[80:95], a[28:31], v[180:183], v[80:95]
    ds_write_b128 v11, v[104:107] offset:6144
    v_mfma_f32_32x32x16_bf16 v[64:79], a[32:35], v[184:187], v[64:79]
    s_add_u32 s77, s7, 135168
    buffer_load_dwordx4 v[160:163], v1, s[28:31], s77 offen offset:0 sc1
    ds_write_b128 v11, v[108:111] offset:7168
    v_mfma_f32_32x32x16_bf16 v[80:95], a[36:39], v[184:187], v[80:95]
    v_add_f32 v96, v96, v48
    v_add_f32 v97, v97, v49
    v_add_f32 v98, v98, v50
    v_add_f32 v99, v99, v51
    v_add_f32 v100, v100, v52
    v_mfma_f32_32x32x16_bf16 v[64:79], a[40:43], v[188:191], v[64:79]
    buffer_load_dwordx4 v[164:167], v1, s[28:31], s77 offen offset:1024 sc1
    v_add_f32 v101, v101, v53
    v_add_f32 v102, v102, v54
    v_add_f32 v103, v103, v55
    v_mfma_f32_32x32x16_bf16 v[80:95], a[44:47], v[188:191], v[80:95]
    v_mfma_f32_32x32x16_bf16 v[64:79], a[48:51], v[192:195], v[64:79]
    buffer_load_dwordx4 v[168:171], v1, s[28:31], s77 offen offset:2048 sc1
    s_waitcnt vmcnt(13)
    v_max3_u32 v63, v203, v207, v211
    v_max_u32 v63, v63, v215
    v_mfma_f32_32x32x16_bf16 v[80:95], a[52:55], v[192:195], v[80:95]
    v_cmp_eq_u32 s[40:41], -1, v63
    v_mfma_f32_32x32x16_bf16 v[64:79], a[56:59], v[196:199], v[64:79]
    buffer_load_dwordx4 v[172:175], v1, s[28:31], s77 offen offset:3072 sc1
    s_cmp_lg_u64 s[40:41], 0
    s_cbranch_scc1 RT184
CD185:
    s_waitcnt lgkmcnt(0)
    s_barrier
    ds_read_b128 v[224:227], v13 offset:6144
    v_mfma_f32_32x32x16_bf16 v[80:95], a[60:63], v[196:199], v[80:95]
    ds_read_b128 v[228:231], v13 offset:7168
    ds_read_b128 v[232:235], v13 offset:8192
    ds_read_b128 v[236:239], v13 offset:9216
    ds_read_b128 v[240:243], v13 offset:10240
    v_mfma_f32_32x32x16_bf16 v[64:79], a[64:67], v[200:203], v[64:79]
    s_add_u32 s77, s7, 139264
    buffer_load_dwordx4 v[176:179], v1, s[28:31], s77 offen offset:0 sc1
    ds_read_b128 v[244:247], v13 offset:11264
    v_mfma_f32_32x32x16_bf16 v[80:95], a[68:71], v[200:203], v[80:95]
    v_mfma_f32_32x32x16_bf16 v[64:79], a[72:75], v[204:207], v[64:79]
    buffer_load_dwordx4 v[180:183], v1, s[28:31], s77 offen offset:1024 sc1
    v_mfma_f32_32x32x16_bf16 v[80:95], a[76:79], v[204:207], v[80:95]
    s_waitcnt lgkmcnt(0)
    v_add_f32 v224, v224, v232
    v_add_f32 v225, v225, v233
    v_add_f32 v226, v226, v234
    v_add_f32 v227, v227, v235
    v_add_f32 v228, v228, v236
    v_mfma_f32_32x32x16_bf16 v[64:79], a[80:83], v[208:211], v[64:79]
    buffer_load_dwordx4 v[184:187], v1, s[28:31], s77 offen offset:2048 sc1
    s_waitcnt vmcnt(12)
    v_max3_u32 v63, v131, v135, v139
    v_max_u32 v63, v63, v143
    v_mfma_f32_32x32x16_bf16 v[80:95], a[84:87], v[208:211], v[80:95]
    v_cmp_eq_u32 s[40:41], -1, v63
    v_add_f32 v229, v229, v237
    v_add_f32 v230, v230, v238
    v_add_f32 v231, v231, v239
    v_add_f32 v96, v96, v240
    v_mfma_f32_32x32x16_bf16 v[64:79], a[88:91], v[212:215], v[64:79]
    buffer_load_dwordx4 v[188:191], v1, s[28:31], s77 offen offset:3072 sc1
    s_cmp_lg_u64 s[40:41], 0
    s_cbranch_scc1 RT186
CD187:
    v_add_f32 v97, v97, v241
    v_add_f32 v98, v98, v242
    v_mfma_f32_32x32x16_bf16 v[80:95], a[92:95], v[212:215], v[80:95]
    v_add_f32 v99, v99, v243
    v_add_f32 v100, v100, v244
    v_add_f32 v101, v101, v245
    v_add_f32 v102, v102, v246
    v_add_f32 v103, v103, v247
    v_mfma_f32_32x32x16_bf16 v[64:79], a[96:99], v[128:131], v[64:79]
    s_add_u32 s77, s7, 143360
    buffer_load_dwordx4 v[192:195], v1, s[28:31], s77 offen offset:0 sc1
    v_add_f32 v96, v96, v224
    v_add_f32 v97, v97, v225
    v_add_f32 v98, v98, v226
    v_mfma_f32_32x32x16_bf16 v[80:95], a[100:103], v[128:131], v[80:95]
    v_add_f32 v99, v99, v227
    v_add_f32 v100, v100, v228
    v_add_f32 v101, v101, v229
    v_add_f32 v102, v102, v230
    v_add_f32 v103, v103, v231
    v_mfma_f32_32x32x16_bf16 v[64:79], a[104:107], v[132:135], v[64:79]
    buffer_load_dwordx4 v[196:199], v1, s[28:31], s77 offen offset:1024 sc1
    s_waitcnt vmcnt(13)
    v_max_u32 v61, v217, v219
    v_cmp_eq_u32 s[42:43], -1, v61
    v_mfma_f32_32x32x16_bf16 v[80:95], a[108:111], v[132:135], v[80:95]
    s_cmp_lg_u64 s[42:43], 0
    s_cbranch_scc1 RT182
CD183:
    v_lshlrev_b32 v248, 16, v216
    v_and_b32 v249, 0xffff0000, v216
    v_lshlrev_b32 v250, 16, v217
    v_and_b32 v251, 0xffff0000, v217
    v_mfma_f32_32x32x16_bf16 v[64:79], a[112:115], v[136:139], v[64:79]
    buffer_load_dwordx4 v[200:203], v1, s[28:31], s77 offen offset:2048 sc1
    s_waitcnt vmcnt(11)
    v_max3_u32 v63, v147, v151, v155
    v_max_u32 v63, v63, v159
    v_mfma_f32_32x32x16_bf16 v[80:95], a[116:119], v[136:139], v[80:95]
    v_cmp_eq_u32 s[40:41], -1, v63
    v_lshlrev_b32 v252, 16, v218
    v_and_b32 v253, 0xffff0000, v218
    v_lshlrev_b32 v254, 16, v219
    v_and_b32 v255, 0xffff0000, v219
    v_mfma_f32_32x32x16_bf16 v[64:79], a[120:123], v[140:143], v[64:79]
    buffer_load_dwordx4 v[204:207], v1, s[28:31], s77 offen offset:3072 sc1
    s_cmp_lg_u64 s[40:41], 0
    s_cbranch_scc1 RT188
CD189:
    v_add_f32 v96, v96, v248
    v_add_f32 v97, v97, v249
    v_mfma_f32_32x32x16_bf16 v[80:95], a[124:127], v[140:143], v[80:95]
    v_add_f32 v98, v98, v250
    v_add_f32 v99, v99, v251
    v_add_f32 v100, v100, v252
    v_add_f32 v101, v101, v253
    v_add_f32 v102, v102, v254
    v_add_f32 v103, v103, v255
    v_mul_f32 v248, v96, v96
    v_mul_f32 v249, v97, v97
    v_mul_f32 v250, v98, v98
    v_mul_f32 v251, v99, v99
    v_mul_f32 v252, v100, v100
    v_mul_f32 v253, v101, v101
    v_mul_f32 v254, v102, v102
    v_mul_f32 v255, v103, v103
    v_mov_b32 v224, s70
    v_fmaak_f32 v248, v248, v224, 0xc0135761
    v_fmaak_f32 v249, v249, v224, 0xc0135761
    v_fmaak_f32 v250, v250, v224, 0xc0135761
    v_fmaak_f32 v251, v251, v224, 0xc0135761
    v_fmaak_f32 v252, v252, v224, 0xc0135761
    v_fmaak_f32 v253, v253, v224, 0xc0135761
    v_fmaak_f32 v254, v254, v224, 0xc0135761
    v_fmaak_f32 v255, v255, v224, 0xc0135761
    v_mul_f32 v248, v248, v96
    v_mul_f32 v249, v249, v97
    v_mul_f32 v250, v250, v98
    v_mul_f32 v251, v251, v99
    v_mul_f32 v252, v252, v100
    v_mul_f32 v253, v253, v101
    v_mul_f32 v254, v254, v102
    v_mul_f32 v255, v255, v103
    v_exp_f32 v248, v248
    v_exp_f32 v249, v249
    v_exp_f32 v250, v250
    v_exp_f32 v251, v251
    v_exp_f32 v252, v252
    v_exp_f32 v253, v253
    v_exp_f32 v254, v254
    v_exp_f32 v255, v255
    v_add_f32 v248, 1.0, v248
    v_add_f32 v249, 1.0, v249
    v_add_f32 v250, 1.0, v250
    v_add_f32 v251, 1.0, v251
    v_add_f32 v252, 1.0, v252
    v_add_f32 v253, 1.0, v253
    v_add_f32 v254, 1.0, v254
    v_add_f32 v255, 1.0, v255
    v_rcp_f32 v248, v248
    v_rcp_f32 v249, v249
    v_rcp_f32 v250, v250
    v_rcp_f32 v251, v251
    v_rcp_f32 v252, v252
    v_rcp_f32 v253, v253
    v_rcp_f32 v254, v254
    v_rcp_f32 v255, v255
    v_mul_f32 v96, v96, v248
    v_mul_f32 v97, v97, v249
    v_mul_f32 v98, v98, v250
    v_mul_f32 v99, v99, v251
    v_mul_f32 v100, v100, v252
    v_mul_f32 v101, v101, v253
    v_mul_f32 v102, v102, v254
    v_mul_f32 v103, v103, v255
    v_cvt_pk_bf16_f32 v228, v96, v97
    v_cvt_pk_bf16_f32 v229, v98, v99
    v_cvt_pk_bf16_f32 v230, v100, v101
    v_cvt_pk_bf16_f32 v231, v102, v103
    s_add_u32 s81, s1, 1605632
    buffer_store_dwordx4 v[228:231], v1, s[28:31], s81 offen sc0 sc1
    v_mfma_f32_32x32x16_bf16 v[96:111], a[0:3], v[144:147], 0
    v_mfma_f32_32x32x16_bf16 v[112:127], a[4:7], v[144:147], 0
    v_mfma_f32_32x32x16_bf16 v[96:111], a[8:11], v[148:151], v[96:111]
    ds_write_b128 v10, v[80:83] offset:0
    v_mfma_f32_32x32x16_bf16 v[112:127], a[12:15], v[148:151], v[112:127]
    ds_write_b128 v10, v[84:87] offset:1024
    v_mfma_f32_32x32x16_bf16 v[96:111], a[16:19], v[152:155], v[96:111]
    s_waitcnt vmcnt(9)
    v_max3_u32 v63, v163, v167, v171
    v_max_u32 v63, v63, v175
    v_cmp_eq_u32 s[40:41], -1, v63
    ds_write_b128 v12, v[88:91] offset:0
    v_mfma_f32_32x32x16_bf16 v[112:127], a[20:23], v[152:155], v[112:127]
    s_cmp_lg_u64 s[40:41], 0
    s_cbranch_scc1 RT190
CD191:
    ds_write_b128 v12, v[92:95] offset:1024
    v_mfma_f32_32x32x16_bf16 v[96:111], a[24:27], v[156:159], v[96:111]
    ds_write_b128 v11, v[72:75] offset:0
    v_mfma_f32_32x32x16_bf16 v[112:127], a[28:31], v[156:159], v[112:127]
    ds_write_b128 v11, v[76:79] offset:1024
    v_mfma_f32_32x32x16_bf16 v[96:111], a[32:35], v[160:163], v[96:111]
    v_mfma_f32_32x32x16_bf16 v[112:127], a[36:39], v[160:163], v[112:127]
    v_mfma_f32_32x32x16_bf16 v[96:111], a[40:43], v[164:167], v[96:111]
    v_mfma_f32_32x32x16_bf16 v[112:127], a[44:47], v[164:167], v[112:127]
    s_waitcnt lgkmcnt(0)
    s_barrier
    ds_read_b128 v[224:227], v13 offset:0
    ds_read_b128 v[228:231], v13 offset:1024
    ds_read_b128 v[232:235], v13 offset:2048
    ds_read_b128 v[236:239], v13 offset:3072
    v_mfma_f32_32x32x16_bf16 v[96:111], a[48:51], v[168:171], v[96:111]
    s_waitcnt vmcnt(5)
    v_max3_u32 v63, v179, v183, v187
    v_max_u32 v63, v63, v191
    v_cmp_eq_u32 s[40:41], -1, v63
    ds_read_b128 v[240:243], v13 offset:4096
    v_mfma_f32_32x32x16_bf16 v[112:127], a[52:55], v[168:171], v[112:127]
    s_cmp_lg_u64 s[40:41], 0
    s_cbranch_scc1 RT192
CD193:
    ds_read_b128 v[244:247], v13 offset:5120
    v_mfma_f32_32x32x16_bf16 v[96:111], a[56:59], v[172:175], v[96:111]
    v_mfma_f32_32x32x16_bf16 v[112:127], a[60:63], v[172:175], v[112:127]
    v_mfma_f32_32x32x16_bf16 v[96:111], a[64:67], v[176:179], v[96:111]
    s_waitcnt lgkmcnt(0)
    v_add_f32 v224, v224, v232
    v_add_f32 v225, v225, v233
    v_add_f32 v226, v226, v234
    v_add_f32 v227, v227, v235
    v_add_f32 v228, v228, v236
    v_mfma_f32_32x32x16_bf16 v[112:127], a[68:71], v[176:179], v[112:127]
    v_add_f32 v229, v229, v237
    v_add_f32 v230, v230, v238
    v_add_f32 v231, v231, v239
    v_add_f32 v64, v64, v240
    v_add_f32 v65, v65, v241
    v_mfma_f32_32x32x16_bf16 v[96:111], a[72:75], v[180:183], v[96:111]
    v_add_f32 v66, v66, v242
    v_add_f32 v67, v67, v243
    v_add_f32 v68, v68, v244
    v_add_f32 v69, v69, v245
    v_add_f32 v70, v70, v246
    v_mfma_f32_32x32x16_bf16 v[112:127], a[76:79], v[180:183], v[112:127]
    v_add_f32 v71, v71, v247
    v_add_f32 v64, v64, v224
    v_add_f32 v65, v65, v225
    v_add_f32 v66, v66, v226
    v_add_f32 v67, v67, v227
    v_mfma_f32_32x32x16_bf16 v[96:111], a[80:83], v[184:187], v[96:111]
    s_waitcnt vmcnt(1)
    v_max3_u32 v63, v195, v199, v203
    v_max_u32 v63, v63, v207
    v_cmp_eq_u32 s[40:41], -1, v63
    v_add_f32 v68, v68, v228
    v_add_f32 v69, v69, v229
    v_mfma_f32_32x32x16_bf16 v[112:127], a[84:87], v[184:187], v[112:127]
    s_cmp_lg_u64 s[40:41], 0
    s_cbranch_scc1 RT194
CD195:
    v_add_f32 v70, v70, v230
    v_add_f32 v71, v71, v231
    v_cvt_pk_bf16_f32 v64, v64, v65
    v_cvt_pk_bf16_f32 v65, v66, v67
    v_mfma_f32_32x32x16_bf16 v[96:111], a[88:91], v[188:191], v[96:111]
    v_cvt_pk_bf16_f32 v66, v68, v69
    v_cvt_pk_bf16_f32 v67, v70, v71
    s_add_u32 s81, s57, 8396800
    s_cmp_lg_u32 s79, 1
    s_cbranch_scc1 PL196
    buffer_store_dwordx4 v[64:67], v1, s[28:31], s81 offen
PE197:
    v_mfma_f32_32x32x16_bf16 v[112:127], a[92:95], v[188:191], v[112:127]
    v_mfma_f32_32x32x16_bf16 v[96:111], a[96:99], v[192:195], v[96:111]
    v_mfma_f32_32x32x16_bf16 v[112:127], a[100:103], v[192:195], v[112:127]
    s_add_u32 s81, s82, 8396800
    buffer_load_dwordx4 v[220:223], v1, s[28:31], s81 offen sc1
    v_mfma_f32_32x32x16_bf16 v[96:111], a[104:107], v[196:199], v[96:111]
    v_mfma_f32_32x32x16_bf16 v[112:127], a[108:111], v[196:199], v[112:127]
    v_mfma_f32_32x32x16_bf16 v[96:111], a[112:115], v[200:203], v[96:111]
    v_mfma_f32_32x32x16_bf16 v[112:127], a[116:119], v[200:203], v[112:127]
    v_mfma_f32_32x32x16_bf16 v[96:111], a[120:123], v[204:207], v[96:111]
    v_mfma_f32_32x32x16_bf16 v[112:127], a[124:127], v[204:207], v[112:127]
    s_nop 11
    ds_write_b128 v10, v[112:115] offset:6144
    ds_write_b128 v10, v[116:119] offset:7168
    ds_write_b128 v12, v[120:123] offset:6144
    ds_write_b128 v12, v[124:127] offset:7168
    ds_write_b128 v11, v[104:107] offset:6144
    ds_write_b128 v11, v[108:111] offset:7168
    v_pk_add_f32 v[96:97], v[96:97], v[48:49]
    v_pk_add_f32 v[98:99], v[98:99], v[50:51]
    buffer_load_dword v62, v15, s[28:31], s10 offen sc1
    v_pk_add_f32 v[100:101], v[100:101], v[52:53]
    v_pk_add_f32 v[102:103], v[102:103], v[54:55]
    s_waitcnt lgkmcnt(0)
    s_barrier
    ds_read_b128 v[224:227], v13 offset:6144
    ds_read_b128 v[228:231], v13 offset:7168
    ds_read_b128 v[232:235], v13 offset:8192
    ds_read_b128 v[236:239], v13 offset:9216
    ds_read_b128 v[240:243], v13 offset:10240
    s_add_u32 s77, s8, 0
    buffer_load_dwordx4 v[128:131], v8, s[28:31], s77 offen offset:0 sc1
    ds_read_b128 v[244:247], v13 offset:11264
    s_waitcnt lgkmcnt(0)
    v_pk_add_f32 v[224:225], v[224:225], v[232:233]
    v_pk_add_f32 v[226:227], v[226:227], v[234:235]
    v_pk_add_f32 v[228:229], v[228:229], v[236:237]
    v_pk_add_f32 v[230:231], v[230:231], v[238:239]
    v_pk_add_f32 v[96:97], v[96:97], v[240:241]
    v_pk_add_f32 v[98:99], v[98:99], v[242:243]
    buffer_load_dwordx4 v[132:135], v8, s[28:31], s77 offen offset:1024 sc1
    v_pk_add_f32 v[100:101], v[100:101], v[244:245]
    v_pk_add_f32 v[102:103], v[102:103], v[246:247]
    v_pk_add_f32 v[96:97], v[96:97], v[224:225]
    v_pk_add_f32 v[98:99], v[98:99], v[226:227]
    v_pk_add_f32 v[100:101], v[100:101], v[228:229]
    v_pk_add_f32 v[102:103], v[102:103], v[230:231]
    s_waitcnt vmcnt(3)
XR198:
    v_max_u32 v61, v221, v223
    v_cmp_eq_u32 vcc, -1, v61
    s_cbranch_vccz XK199
    s_add_u32 s81, s82, 8396800
    buffer_load_dwordx4 v[220:223], v1, s[28:31], s81 offen sc1
    s_add_u32 s56, s56, 1
    s_cmp_gt_u32 s56, 200000
    s_waitcnt vmcnt(0)
    s_cbranch_scc0 XR198
XK199:
    buffer_load_dwordx4 v[136:139], v8, s[28:31], s77 offen offset:2048 sc1
    v_lshlrev_b32 v248, 16, v220
    v_and_b32 v249, 0xffff0000, v220
    v_lshlrev_b32 v250, 16, v221
    v_and_b32 v251, 0xffff0000, v221
    v_lshlrev_b32 v252, 16, v222
    v_and_b32 v253, 0xffff0000, v222
    v_lshlrev_b32 v254, 16, v223
    v_and_b32 v255, 0xffff0000, v223
    buffer_load_dwordx4 v[140:143], v8, s[28:31], s77 offen offset:3072 sc1
    v_pk_add_f32 v[96:97], v[96:97], v[248:249]
    v_pk_add_f32 v[98:99], v[98:99], v[250:251]
    v_pk_add_f32 v[100:101], v[100:101], v[252:253]
    v_pk_add_f32 v[102:103], v[102:103], v[254:255]
    v_pk_mul_f32 v[248:249], v[96:97], v[96:97]
    v_pk_mul_f32 v[250:251], v[98:99], v[98:99]
    v_pk_mul_f32 v[252:253], v[100:101], v[100:101]
    v_pk_mul_f32 v[254:255], v[102:103], v[102:103]
    s_add_u32 s77, s8, 4096
    buffer_load_dwordx4 v[144:147], v8, s[28:31], s77 offen offset:0 sc1
    v_mov_b32 v224, 0xc0135761
    v_mov_b32 v225, 0xc0135761
    v_pk_fma_f32 v[248:249], v[248:249], s[70:71], v[224:225]
    v_pk_fma_f32 v[250:251], v[250:251], s[70:71], v[224:225]
    v_pk_fma_f32 v[252:253], v[252:253], s[70:71], v[224:225]
    v_pk_fma_f32 v[254:255], v[254:255], s[70:71], v[224:225]
    v_pk_mul_f32 v[248:249], v[248:249], v[96:97]
    v_pk_mul_f32 v[250:251], v[250:251], v[98:99]
    buffer_load_dwordx4 v[148:151], v8, s[28:31], s77 offen offset:1024 sc1
    v_pk_mul_f32 v[252:253], v[252:253], v[100:101]
    v_pk_mul_f32 v[254:255], v[254:255], v[102:103]
    v_exp_f32 v248, v248
    v_exp_f32 v249, v249
    v_exp_f32 v250, v250
    v_exp_f32 v251, v251
    v_exp_f32 v252, v252
    v_exp_f32 v253, v253
    buffer_load_dwordx4 v[152:155], v8, s[28:31], s77 offen offset:2048 sc1
    v_exp_f32 v254, v254
    v_exp_f32 v255, v255
    v_pk_add_f32 v[248:249], v[248:249], s[72:73]
    v_pk_add_f32 v[250:251], v[250:251], s[72:73]
    v_pk_add_f32 v[252:253], v[252:253], s[72:73]
    v_pk_add_f32 v[254:255], v[254:255], s[72:73]
    v_rcp_f32 v248, v248
    v_rcp_f32 v249, v249
    buffer_load_dwordx4 v[156:159], v8, s[28:31], s77 offen offset:3072 sc1
    v_rcp_f32 v250, v250
    v_rcp_f32 v251, v251
    v_rcp_f32 v252, v252
    v_rcp_f32 v253, v253
    v_rcp_f32 v254, v254
    v_rcp_f32 v255, v255
    v_pk_mul_f32 v[96:97], v[96:97], v[248:249]
    v_pk_mul_f32 v[98:99], v[98:99], v[250:251]
    s_add_u32 s77, s8, 8192
    buffer_load_dwordx4 v[160:163], v8, s[28:31], s77 offen offset:0 sc1
    v_pk_mul_f32 v[100:101], v[100:101], v[252:253]
    v_pk_mul_f32 v[102:103], v[102:103], v[254:255]
    v_cvt_pk_bf16_f32 v228, v96, v97
    v_cvt_pk_bf16_f32 v229, v98, v99
    v_cvt_pk_bf16_f32 v230, v100, v101
    v_cvt_pk_bf16_f32 v231, v102, v103
    s_add_u32 s81, s1, 1720320
    buffer_store_dwordx4 v[228:231], v1, s[28:31], s81 offen sc0 sc1
    buffer_load_dwordx4 v[164:167], v8, s[28:31], s77 offen offset:1024 sc1
    buffer_load_dwordx4 v[168:171], v8, s[28:31], s77 offen offset:2048 sc1
    buffer_load_dwordx4 v[172:175], v8, s[28:31], s77 offen offset:3072 sc1
    s_add_u32 s77, s8, 12288
    buffer_load_dwordx4 v[176:179], v8, s[28:31], s77 offen offset:0 sc1
    buffer_load_dwordx4 v[180:183], v8, s[28:31], s77 offen offset:1024 sc1
    s_add_u32 s77, s9, 0
    buffer_load_dwordx4 v[184:187], v8, s[28:31], s77 offen offset:0 sc1
    buffer_load_dwordx4 v[188:191], v8, s[28:31], s77 offen offset:1024 sc1
L_p4_1:
    s_waitcnt lgkmcnt(0)
    s_waitcnt vmcnt(13)
    v_max3_u32 v63, v131, v135, v139
    v_max3_u32 v63, v63, v143, v62
    v_cmp_eq_u32 vcc, -1, v63
    s_cbranch_vccnz RT206
CD207:
    v_mfma_f32_32x32x16_bf16 v[64:79], v[128:131], a[128:131], 0
    buffer_load_dwordx4 v[192:195], v8, s[28:31], s77 offen offset:2048 sc1
    v_mfma_f32_32x32x16_bf16 v[80:95], v[128:131], a[132:135], 0
    v_mfma_f32_32x32x16_bf16 v[64:79], v[132:135], a[136:139], v[64:79]
    buffer_load_dwordx4 v[196:199], v8, s[28:31], s77 offen offset:3072 sc1
    v_mfma_f32_32x32x16_bf16 v[80:95], v[132:135], a[140:143], v[80:95]
    v_mfma_f32_32x32x16_bf16 v[64:79], v[136:139], a[144:147], v[64:79]
    s_add_u32 s77, s9, 4096
    buffer_load_dwordx4 v[200:203], v8, s[28:31], s77 offen offset:0 sc1
    s_waitcnt vmcnt(12)
    v_max3_u32 v63, v147, v151, v155
    v_max_u32 v63, v63, v159
    v_mfma_f32_32x32x16_bf16 v[80:95], v[136:139], a[148:151], v[80:95]
    v_cmp_eq_u32 s[40:41], -1, v63
    v_mfma_f32_32x32x16_bf16 v[64:79], v[140:143], a[152:155], v[64:79]
    buffer_load_dwordx4 v[204:207], v8, s[28:31], s77 offen offset:1024 sc1
    s_cmp_lg_u64 s[40:41], 0
    s_cbranch_scc1 RT208
CD209:
    v_mfma_f32_32x32x16_bf16 v[80:95], v[140:143], a[156:159], v[80:95]
    v_mfma_f32_32x32x16_bf16 v[64:79], v[144:147], a[160:163], v[64:79]
    buffer_load_dwordx4 v[208:211], v8, s[28:31], s77 offen offset:2048 sc1
    v_mfma_f32_32x32x16_bf16 v[80:95], v[144:147], a[164:167], v[80:95]
    v_mfma_f32_32x32x16_bf16 v[64:79], v[148:151], a[168:171], v[64:79]
    buffer_load_dwordx4 v[212:215], v8, s[28:31], s77 offen offset:3072 sc1
    v_mfma_f32_32x32x16_bf16 v[80:95], v[148:151], a[172:175], v[80:95]
    v_mfma_f32_32x32x16_bf16 v[64:79], v[152:155], a[176:179], v[64:79]
    s_add_u32 s77, s9, 8192
    buffer_load_dwordx4 v[128:131], v8, s[28:31], s77 offen offset:0 sc1
    s_waitcnt vmcnt(11)
    v_max3_u32 v63, v163, v167, v171
    v_max_u32 v63, v63, v175
    v_mfma_f32_32x32x16_bf16 v[80:95], v[152:155], a[180:183], v[80:95]
    v_cmp_eq_u32 s[40:41], -1, v63
    v_mfma_f32_32x32x16_bf16 v[64:79], v[156:159], a[184:187], v[64:79]
    buffer_load_dwordx4 v[132:135], v8, s[28:31], s77 offen offset:1024 sc1
    s_cmp_lg_u64 s[40:41], 0
    s_cbranch_scc1 RT210
CD211:
    v_mfma_f32_32x32x16_bf16 v[80:95], v[156:159], a[188:191], v[80:95]
    v_mfma_f32_32x32x16_bf16 v[64:79], v[160:163], a[192:195], v[64:79]
    buffer_load_dwordx4 v[136:139], v8, s[28:31], s77 offen offset:2048 sc1
    v_mfma_f32_32x32x16_bf16 v[80:95], v[160:163], a[196:199], v[80:95]
    v_mfma_f32_32x32x16_bf16 v[64:79], v[164:167], a[200:203], v[64:79]
    buffer_load_dwordx4 v[140:143], v8, s[28:31], s77 offen offset:3072 sc1
    v_mfma_f32_32x32x16_bf16 v[80:95], v[164:167], a[204:207], v[80:95]
    v_mfma_f32_32x32x16_bf16 v[64:79], v[168:171], a[208:211], v[64:79]
    s_add_u32 s77, s9, 12288
    buffer_load_dwordx4 v[144:147], v8, s[28:31], s77 offen offset:0 sc1
    s_waitcnt vmcnt(11)
    v_max3_u32 v63, v179, v183, v187
    v_max_u32 v63, v63, v191
    v_mfma_f32_32x32x16_bf16 v[80:95], v[168:171], a[212:215], v[80:95]
    v_cmp_eq_u32 s[40:41], -1, v63
    v_mfma_f32_32x32x16_bf16 v[64:79], v[172:175], a[216:219], v[64:79]
    buffer_load_dwordx4 v[148:151], v8, s[28:31], s77 offen offset:1024 sc1
    s_cmp_lg_u64 s[40:41], 0
    s_cbranch_scc1 RT212
CD213:
    v_mfma_f32_32x32x16_bf16 v[80:95], v[172:175], a[220:223], v[80:95]
    v_mfma_f32_32x32x16_bf16 v[64:79], v[176:179], a[224:227], v[64:79]
    s_add_u32 s77, s8, 114688
    buffer_load_dwordx4 v[152:155], v8, s[28:31], s77 offen offset:0 sc1
    v_mfma_f32_32x32x16_bf16 v[80:95], v[176:179], a[228:231], v[80:95]
    v_mfma_f32_32x32x16_bf16 v[64:79], v[180:183], a[232:235], v[64:79]
    buffer_load_dwordx4 v[156:159], v8, s[28:31], s77 offen offset:1024 sc1
    v_mfma_f32_32x32x16_bf16 v[80:95], v[180:183], a[236:239], v[80:95]
    v_mfma_f32_32x32x16_bf16 v[96:111], v[184:187], a[128:131], 0
    buffer_load_dwordx4 v[160:163], v8, s[28:31], s77 offen offset:2048 sc1
    s_waitcnt vmcnt(11)
    v_max3_u32 v63, v195, v199, v203
    v_max_u32 v63, v63, v207
    v_mfma_f32_32x32x16_bf16 v[112:127], v[184:187], a[132:135], 0
    v_cmp_eq_u32 s[40:41], -1, v63
    v_mfma_f32_32x32x16_bf16 v[96:111], v[188:191], a[136:139], v[96:111]
    buffer_load_dwordx4 v[164:167], v8, s[28:31], s77 offen offset:3072 sc1
    s_cmp_lg_u64 s[40:41], 0
    s_cbranch_scc1 RT214
CD215:
    ds_write_b128 v10, v[80:83] offset:0
    v_mfma_f32_32x32x16_bf16 v[112:127], v[188:191], a[140:143], v[112:127]
    ds_write_b128 v10, v[84:87] offset:1024
    v_mfma_f32_32x32x16_bf16 v[96:111], v[192:195], a[144:147], v[96:111]
    s_add_u32 s77, s8, 118784
    buffer_load_dwordx4 v[168:171], v8, s[28:31], s77 offen offset:0 sc1
    ds_write_b128 v12, v[88:91] offset:0
    v_mfma_f32_32x32x16_bf16 v[112:127], v[192:195], a[148:151], v[112:127]
    ds_write_b128 v12, v[92:95] offset:1024
    v_mfma_f32_32x32x16_bf16 v[96:111], v[196:199], a[152:155], v[96:111]
    buffer_load_dwordx4 v[172:175], v8, s[28:31], s77 offen offset:1024 sc1
    ds_write_b128 v11, v[72:75] offset:0
    v_mfma_f32_32x32x16_bf16 v[112:127], v[196:199], a[156:159], v[112:127]
    ds_write_b128 v11, v[76:79] offset:1024
    v_mfma_f32_32x32x16_bf16 v[96:111], v[200:203], a[160:163], v[96:111]
    buffer_load_dwordx4 v[176:179], v8, s[28:31], s77 offen offset:2048 sc1
    s_waitcnt vmcnt(11)
    v_max3_u32 v63, v211, v215, v131
    v_max_u32 v63, v63, v135
    v_mfma_f32_32x32x16_bf16 v[112:127], v[200:203], a[164:167], v[112:127]
    v_cmp_eq_u32 s[40:41], -1, v63
    v_mfma_f32_32x32x16_bf16 v[96:111], v[204:207], a[168:171], v[96:111]
    buffer_load_dwordx4 v[180:183], v8, s[28:31], s77 offen offset:3072 sc1
    s_cmp_lg_u64 s[40:41], 0
    s_cbranch_scc1 RT216
CD217:
    v_mfma_f32_32x32x16_bf16 v[112:127], v[204:207], a[172:175], v[112:127]
    s_waitcnt lgkmcnt(0)
    s_barrier
    ds_read_b128 v[224:227], v13 offset:0
    ds_read_b128 v[228:231], v13 offset:1024
    ds_read_b128 v[232:235], v13 offset:2048
    ds_read_b128 v[236:239], v13 offset:3072
    v_mfma_f32_32x32x16_bf16 v[96:111], v[208:211], a[176:179], v[96:111]
    s_add_u32 s77, s8, 122880
    buffer_load_dwordx4 v[184:187], v8, s[28:31], s77 offen offset:0 sc1
    ds_read_b128 v[240:243], v13 offset:4096
    ds_read_b128 v[244:247], v13 offset:5120
    v_mfma_f32_32x32x16_bf16 v[112:127], v[208:211], a[180:183], v[112:127]
    v_mfma_f32_32x32x16_bf16 v[96:111], v[212:215], a[184:187], v[96:111]
    buffer_load_dwordx4 v[188:191], v8, s[28:31], s77 offen offset:1024 sc1
    v_mfma_f32_32x32x16_bf16 v[112:127], v[212:215], a[188:191], v[112:127]
    s_waitcnt lgkmcnt(0)
    v_add_f32 v224, v224, v232
    v_add_f32 v225, v225, v233
    v_add_f32 v226, v226, v234
    v_add_f32 v227, v227, v235
    v_add_f32 v228, v228, v236
    v_mfma_f32_32x32x16_bf16 v[96:111], v[128:131], a[192:195], v[96:111]
    buffer_load_dwordx4 v[192:195], v8, s[28:31], s77 offen offset:2048 sc1
    s_waitcnt vmcnt(11)
    v_max3_u32 v63, v139, v143, v147
    v_max_u32 v63, v63, v151
    v_mfma_f32_32x32x16_bf16 v[112:127], v[128:131], a[196:199], v[112:127]
    v_cmp_eq_u32 s[40:41], -1, v63
    v_add_f32 v229, v229, v237
    v_add_f32 v230, v230, v238
    v_add_f32 v231, v231, v239
    v_add_f32 v64, v64, v240
    v_mfma_f32_32x32x16_bf16 v[96:111], v[132:135], a[200:203], v[96:111]
    buffer_load_dwordx4 v[196:199], v8, s[28:31], s77 offen offset:3072 sc1
    s_cmp_lg_u64 s[40:41], 0
    s_cbranch_scc1 RT218
CD219:
    v_add_f32 v65, v65, v241
    v_add_f32 v66, v66, v242
    v_mfma_f32_32x32x16_bf16 v[112:127], v[132:135], a[204:207], v[112:127]
    v_add_f32 v67, v67, v243
    v_add_f32 v68, v68, v244
    v_add_f32 v69, v69, v245
    v_add_f32 v70, v70, v246
    v_add_f32 v71, v71, v247
    s_add_u32 s78, s10, 114688
    v_mfma_f32_32x32x16_bf16 v[96:111], v[136:139], a[208:211], v[96:111]
    s_add_u32 s77, s8, 126976
    buffer_load_dwordx4 v[200:203], v8, s[28:31], s77 offen offset:0 sc1
    v_add_f32 v64, v64, v224
    v_add_f32 v65, v65, v225
    v_add_f32 v66, v66, v226
    v_mfma_f32_32x32x16_bf16 v[112:127], v[136:139], a[212:215], v[112:127]
    v_add_f32 v67, v67, v227
    v_add_f32 v68, v68, v228
    v_add_f32 v69, v69, v229
    v_add_f32 v70, v70, v230
    v_add_f32 v71, v71, v231
    v_mfma_f32_32x32x16_bf16 v[96:111], v[140:143], a[216:219], v[96:111]
    buffer_load_dwordx4 v[204:207], v8, s[28:31], s77 offen offset:1024 sc1
    v_cvt_pk_bf16_f32 v64, v64, v65
    v_cvt_pk_bf16_f32 v65, v66, v67
    v_cvt_pk_bf16_f32 v66, v68, v69
    v_mfma_f32_32x32x16_bf16 v[112:127], v[140:143], a[220:223], v[112:127]
    v_cvt_pk_bf16_f32 v67, v70, v71
    s_add_u32 s81, s57, 12582912
    s_cmp_lg_u32 s79, 1
    s_cbranch_scc1 PL222
    buffer_store_dwordx4 v[64:67], v1, s[28:31], s81 offen
PE223:
    v_mfma_f32_32x32x16_bf16 v[96:111], v[144:147], a[224:227], v[96:111]
    s_add_u32 s77, s9, 114688
    buffer_load_dwordx4 v[208:211], v8, s[28:31], s77 offen offset:0 sc1
    s_waitcnt vmcnt(12)
    v_max3_u32 v63, v155, v159, v163
    v_max_u32 v63, v63, v167
    v_mfma_f32_32x32x16_bf16 v[112:127], v[144:147], a[228:231], v[112:127]
    v_cmp_eq_u32 s[40:41], -1, v63
    v_mfma_f32_32x32x16_bf16 v[96:111], v[148:151], a[232:235], v[96:111]
    buffer_load_dwordx4 v[212:215], v8, s[28:31], s77 offen offset:1024 sc1
    s_cmp_lg_u64 s[40:41], 0
    s_cbranch_scc1 RT220
CD221:
    v_mfma_f32_32x32x16_bf16 v[112:127], v[148:151], a[236:239], v[112:127]
    v_mfma_f32_32x32x16_bf16 v[64:79], v[152:155], a[128:131], 0
    buffer_load_dwordx4 v[128:131], v8, s[28:31], s77 offen offset:2048 sc1
    v_mfma_f32_32x32x16_bf16 v[80:95], v[152:155], a[132:135], 0
    v_mfma_f32_32x32x16_bf16 v[64:79], v[156:159], a[136:139], v[64:79]
    buffer_load_dwordx4 v[132:135], v8, s[28:31], s77 offen offset:3072 sc1
    ds_write_b128 v10, v[112:115] offset:6144
    v_mfma_f32_32x32x16_bf16 v[80:95], v[156:159], a[140:143], v[80:95]
    ds_write_b128 v10, v[116:119] offset:7168
    v_mfma_f32_32x32x16_bf16 v[64:79], v[160:163], a[144:147], v[64:79]
    s_add_u32 s77, s9, 118784
    buffer_load_dwordx4 v[136:139], v8, s[28:31], s77 offen offset:0 sc1
    s_waitcnt vmcnt(12)
    v_max3_u32 v63, v171, v175, v179
    v_max_u32 v63, v63, v183
    v_mfma_f32_32x32x16_bf16 v[80:95], v[160:163], a[148:151], v[80:95]
    v_cmp_eq_u32 s[40:41], -1, v63
    ds_write_b128 v12, v[120:123] offset:6144
    v_mfma_f32_32x32x16_bf16 v[64:79], v[164:167], a[152:155], v[64:79]
    buffer_load_dwordx4 v[140:143], v8, s[28:31], s77 offen offset:1024 sc1
    s_cmp_lg_u64 s[40:41], 0
    s_cbranch_scc1 RT224
CD225:
    ds_write_b128 v12, v[124:127] offset:7168
    v_mfma_f32_32x32x16_bf16 v[80:95], v[164:167], a[156:159], v[80:95]
    ds_write_b128 v11, v[104:107] offset:6144
    v_mfma_f32_32x32x16_bf16 v[64:79], v[168:171], a[160:163], v[64:79]
    buffer_load_dwordx4 v[144:147], v8, s[28:31], s77 offen offset:2048 sc1
    ds_write_b128 v11, v[108:111] offset:7168
    v_mfma_f32_32x32x16_bf16 v[80:95], v[168:171], a[164:167], v[80:95]
    v_add_f32 v96, v96, v32
    v_add_f32 v97, v97, v33
    v_add_f32 v98, v98, v34
    v_add_f32 v99, v99, v35
    v_add_f32 v100, v100, v36
    v_mfma_f32_32x32x16_bf16 v[64:79], v[172:175], a[168:171], v[64:79]
    buffer_load_dwordx4 v[148:151], v8, s[28:31], s77 offen offset:3072 sc1
    v_add_f32 v101, v101, v37
    v_add_f32 v102, v102, v38
    v_add_f32 v103, v103, v39
    v_mfma_f32_32x32x16_bf16 v[80:95], v[172:175], a[172:175], v[80:95]
    v_add_f32 v96, v7, v96
    v_add_f32 v97, v7, v97
    v_add_f32 v98, v7, v98
    v_add_f32 v99, v7, v99
    v_add_f32 v100, v7, v100
    v_mfma_f32_32x32x16_bf16 v[64:79], v[176:179], a[176:179], v[64:79]
    s_add_u32 s77, s9, 122880
    buffer_load_dwordx4 v[152:155], v8, s[28:31], s77 offen offset:0 sc1
    s_waitcnt vmcnt(12)
    v_max3_u32 v63, v187, v191, v195
    v_max_u32 v63, v63, v199
    v_mfma_f32_32x32x16_bf16 v[80:95], v[176:179], a[180:183], v[80:95]
    v_cmp_eq_u32 s[40:41], -1, v63
    v_add_f32 v101, v7, v101
    v_add_f32 v102, v7, v102
    v_add_f32 v103, v7, v103
    v_mfma_f32_32x32x16_bf16 v[64:79], v[180:183], a[184:187], v[64:79]
    buffer_load_dwordx4 v[156:159], v8, s[28:31], s77 offen offset:1024 sc1
    s_cmp_lg_u64 s[40:41], 0
    s_cbranch_scc1 RT226
CD227:
    v_mfma_f32_32x32x16_bf16 v[80:95], v[180:183], a[188:191], v[80:95]
    v_mfma_f32_32x32x16_bf16 v[64:79], v[184:187], a[192:195], v[64:79]
    buffer_load_dwordx4 v[160:163], v8, s[28:31], s77 offen offset:2048 sc1
    v_mfma_f32_32x32x16_bf16 v[80:95], v[184:187], a[196:199], v[80:95]
    s_waitcnt lgkmcnt(0)
    s_barrier
    ds_read_b128 v[224:227], v13 offset:6144
    ds_read_b128 v[228:231], v13 offset:7168
    ds_read_b128 v[232:235], v13 offset:8192
    ds_read_b128 v[236:239], v13 offset:9216
    v_mfma_f32_32x32x16_bf16 v[64:79], v[188:191], a[200:203], v[64:79]
    buffer_load_dwordx4 v[164:167], v8, s[28:31], s77 offen offset:3072 sc1
    ds_read_b128 v[240:243], v13 offset:10240
    ds_read_b128 v[244:247], v13 offset:11264
    v_mfma_f32_32x32x16_bf16 v[80:95], v[188:191], a[204:207], v[80:95]
    s_add_u32 s81, s83, 12582912
    buffer_load_dwordx4 v[216:219], v1, s[28:31], s81 offen sc1
    v_mfma_f32_32x32x16_bf16 v[64:79], v[192:195], a[208:211], v[64:79]
    s_add_u32 s77, s9, 126976
    buffer_load_dwordx4 v[168:171], v8, s[28:31], s77 offen offset:0 sc1
    s_waitcnt vmcnt(12)
    v_max3_u32 v63, v203, v207, v211
    v_max_u32 v63, v63, v215
    v_mfma_f32_32x32x16_bf16 v[80:95], v[192:195], a[212:215], v[80:95]
    v_cmp_eq_u32 s[40:41], -1, v63
    s_waitcnt lgkmcnt(0)
    v_add_f32 v224, v224, v232
    v_add_f32 v225, v225, v233
    v_add_f32 v226, v226, v234
    v_add_f32 v227, v227, v235
    v_mfma_f32_32x32x16_bf16 v[64:79], v[196:199], a[216:219], v[64:79]
    buffer_load_dwordx4 v[172:175], v8, s[28:31], s77 offen offset:1024 sc1
    s_cmp_lg_u64 s[40:41], 0
    s_cbranch_scc1 RT228
CD229:
    v_add_f32 v228, v228, v236
    v_add_f32 v229, v229, v237
    v_mfma_f32_32x32x16_bf16 v[80:95], v[196:199], a[220:223], v[80:95]
    v_add_f32 v230, v230, v238
    v_add_f32 v231, v231, v239
    v_add_f32 v96, v96, v240
    v_add_f32 v97, v97, v241
    v_add_f32 v98, v98, v242
    v_mfma_f32_32x32x16_bf16 v[64:79], v[200:203], a[224:227], v[64:79]
    v_add_f32 v99, v99, v243
    v_add_f32 v100, v100, v244
    v_add_f32 v101, v101, v245
    v_add_f32 v102, v102, v246
    v_add_f32 v103, v103, v247
    v_mfma_f32_32x32x16_bf16 v[80:95], v[200:203], a[228:231], v[80:95]
    v_add_f32 v32, v96, v224
    v_add_f32 v33, v97, v225
    v_add_f32 v34, v98, v226
    v_add_f32 v35, v99, v227
    v_add_f32 v36, v100, v228
    v_mfma_f32_32x32x16_bf16 v[64:79], v[204:207], a[232:235], v[64:79]
    v_add_f32 v37, v101, v229
    v_add_f32 v38, v102, v230
    v_add_f32 v39, v103, v231
    v_mfma_f32_32x32x16_bf16 v[80:95], v[204:207], a[236:239], v[80:95]
    v_mfma_f32_32x32x16_bf16 v[96:111], v[208:211], a[128:131], 0
    s_waitcnt vmcnt(9)
    v_max3_u32 v63, v131, v135, v139
    v_max_u32 v63, v63, v143
    v_cmp_eq_u32 s[40:41], -1, v63
    v_mfma_f32_32x32x16_bf16 v[112:127], v[208:211], a[132:135], 0
    s_cmp_lg_u64 s[40:41], 0
    s_cbranch_scc1 RT230
CD231:
    v_mfma_f32_32x32x16_bf16 v[96:111], v[212:215], a[136:139], v[96:111]
    ds_write_b128 v10, v[80:83] offset:0
    v_mfma_f32_32x32x16_bf16 v[112:127], v[212:215], a[140:143], v[112:127]
    ds_write_b128 v10, v[84:87] offset:1024
    v_mfma_f32_32x32x16_bf16 v[96:111], v[128:131], a[144:147], v[96:111]
    ds_write_b128 v12, v[88:91] offset:0
    v_mfma_f32_32x32x16_bf16 v[112:127], v[128:131], a[148:151], v[112:127]
    ds_write_b128 v12, v[92:95] offset:1024
    v_mfma_f32_32x32x16_bf16 v[96:111], v[132:135], a[152:155], v[96:111]
    ds_write_b128 v11, v[72:75] offset:0
    v_mfma_f32_32x32x16_bf16 v[112:127], v[132:135], a[156:159], v[112:127]
    ds_write_b128 v11, v[76:79] offset:1024
    v_mfma_f32_32x32x16_bf16 v[96:111], v[136:139], a[160:163], v[96:111]
    s_waitcnt vmcnt(5)
    v_max3_u32 v63, v147, v151, v155
    v_max_u32 v63, v63, v159
    v_cmp_eq_u32 s[40:41], -1, v63
    v_mfma_f32_32x32x16_bf16 v[112:127], v[136:139], a[164:167], v[112:127]
    s_cmp_lg_u64 s[40:41], 0
    s_cbranch_scc1 RT234
CD235:
    v_mfma_f32_32x32x16_bf16 v[96:111], v[140:143], a[168:171], v[96:111]
    v_mfma_f32_32x32x16_bf16 v[112:127], v[140:143], a[172:175], v[112:127]
    s_waitcnt lgkmcnt(0)
    s_barrier
    ds_read_b128 v[224:227], v13 offset:0
    ds_read_b128 v[228:231], v13 offset:1024
    ds_read_b128 v[232:235], v13 offset:2048
    ds_read_b128 v[236:239], v13 offset:3072
    v_mfma_f32_32x32x16_bf16 v[96:111], v[144:147], a[176:179], v[96:111]
    ds_read_b128 v[240:243], v13 offset:4096
    ds_read_b128 v[244:247], v13 offset:5120
    v_mfma_f32_32x32x16_bf16 v[112:127], v[144:147], a[180:183], v[112:127]
    v_mfma_f32_32x32x16_bf16 v[96:111], v[148:151], a[184:187], v[96:111]
    v_mfma_f32_32x32x16_bf16 v[112:127], v[148:151], a[188:191], v[112:127]
    s_waitcnt lgkmcnt(0)
    v_add_f32 v224, v224, v232
    v_add_f32 v225, v225, v233
    v_add_f32 v226, v226, v234
    v_add_f32 v227, v227, v235
    v_add_f32 v228, v228, v236
    v_mfma_f32_32x32x16_bf16 v[96:111], v[152:155], a[192:195], v[96:111]
    s_waitcnt vmcnt(0)
    v_max3_u32 v63, v163, v167, v171
    v_max_u32 v63, v63, v175
    v_cmp_eq_u32 s[40:41], -1, v63
    v_add_f32 v229, v229, v237
    v_add_f32 v230, v230, v238
    v_mfma_f32_32x32x16_bf16 v[112:127], v[152:155], a[196:199], v[112:127]
    s_cmp_lg_u64 s[40:41], 0
    s_cbranch_scc1 RT236
CD237:
    v_add_f32 v231, v231, v239
    v_add_f32 v64, v64, v240
    v_add_f32 v65, v65, v241
    v_add_f32 v66, v66, v242
    v_mfma_f32_32x32x16_bf16 v[96:111], v[156:159], a[200:203], v[96:111]
    v_add_f32 v67, v67, v243
    v_add_f32 v68, v68, v244
    v_add_f32 v69, v69, v245
    v_add_f32 v70, v70, v246
    v_add_f32 v71, v71, v247
    v_mfma_f32_32x32x16_bf16 v[112:127], v[156:159], a[204:207], v[112:127]
    v_add_f32 v64, v64, v224
    v_add_f32 v65, v65, v225
    v_add_f32 v66, v66, v226
    v_add_f32 v67, v67, v227
    v_add_f32 v68, v68, v228
    v_mfma_f32_32x32x16_bf16 v[96:111], v[160:163], a[208:211], v[96:111]
    v_add_f32 v69, v69, v229
    v_add_f32 v70, v70, v230
    v_add_f32 v71, v71, v231
    v_cvt_pk_bf16_f32 v64, v64, v65
    v_cvt_pk_bf16_f32 v65, v66, v67
    v_mfma_f32_32x32x16_bf16 v[112:127], v[160:163], a[212:215], v[112:127]
    v_cvt_pk_bf16_f32 v66, v68, v69
    v_cvt_pk_bf16_f32 v67, v70, v71
    s_add_u32 s81, s57, 12591104
    s_cmp_lg_u32 s79, 1
    s_cbranch_scc1 PL238
    buffer_store_dwordx4 v[64:67], v1, s[28:31], s81 offen
PE239:
    s_add_u32 s81, s83, 12591104
    buffer_load_dwordx4 v[220:223], v1, s[28:31], s81 offen sc1
    v_mfma_f32_32x32x16_bf16 v[96:111], v[164:167], a[216:219], v[96:111]
    v_max_u32 v61, v217, v219
    v_cmp_eq_u32 s[42:43], -1, v61
    v_mfma_f32_32x32x16_bf16 v[112:127], v[164:167], a[220:223], v[112:127]
    s_cmp_lg_u64 s[42:43], 0
    s_cbranch_scc1 RT232
CD233:
    v_lshlrev_b32 v248, 16, v216
    v_and_b32 v249, 0xffff0000, v216
    v_lshlrev_b32 v250, 16, v217
    v_and_b32 v251, 0xffff0000, v217
    v_mfma_f32_32x32x16_bf16 v[96:111], v[168:171], a[224:227], v[96:111]
    v_lshlrev_b32 v252, 16, v218
    v_and_b32 v253, 0xffff0000, v218
    v_lshlrev_b32 v254, 16, v219
    v_and_b32 v255, 0xffff0000, v219
    v_add_f32 v32, v32, v248
    v_mfma_f32_32x32x16_bf16 v[112:127], v[168:171], a[228:231], v[112:127]
    v_add_f32 v33, v33, v249
    v_add_f32 v34, v34, v250
    v_add_f32 v35, v35, v251
    v_add_f32 v36, v36, v252
    v_add_f32 v37, v37, v253
    v_mfma_f32_32x32x16_bf16 v[96:111], v[172:175], a[232:235], v[96:111]
    v_add_f32 v38, v38, v254
    v_add_f32 v39, v39, v255
    v_mfma_f32_32x32x16_bf16 v[112:127], v[172:175], a[236:239], v[112:127]
    s_nop 11
    ds_write_b128 v10, v[112:115] offset:6144
    ds_write_b128 v10, v[116:119] offset:7168
    ds_write_b128 v12, v[120:123] offset:6144
    ds_write_b128 v12, v[124:127] offset:7168
    ds_write_b128 v11, v[104:107] offset:6144
    ds_write_b128 v11, v[108:111] offset:7168
    v_pk_add_f32 v[96:97], v[96:97], v[40:41]
    v_pk_add_f32 v[98:99], v[98:99], v[42:43]
    v_pk_add_f32 v[100:101], v[100:101], v[44:45]
    v_pk_add_f32 v[102:103], v[102:103], v[46:47]
    v_add_f32 v96, v7, v96
    v_add_f32 v97, v7, v97
    v_add_f32 v98, v7, v98
    v_add_f32 v99, v7, v99
    v_add_f32 v100, v7, v100
    v_add_f32 v101, v7, v101
    v_add_f32 v102, v7, v102
    v_add_f32 v103, v7, v103
    s_waitcnt lgkmcnt(0)
    s_barrier
    ds_read_b128 v[224:227], v13 offset:6144
    ds_read_b128 v[228:231], v13 offset:7168
    ds_read_b128 v[232:235], v13 offset:8192
    ds_read_b128 v[236:239], v13 offset:9216
    ds_read_b128 v[240:243], v13 offset:10240
    ds_read_b128 v[244:247], v13 offset:11264
    s_waitcnt lgkmcnt(0)
    v_pk_add_f32 v[224:225], v[224:225], v[232:233]
    v_pk_add_f32 v[226:227], v[226:227], v[234:235]
    v_pk_add_f32 v[228:229], v[228:229], v[236:237]
    v_pk_add_f32 v[230:231], v[230:231], v[238:239]
    v_pk_add_f32 v[96:97], v[96:97], v[240:241]
    v_pk_add_f32 v[98:99], v[98:99], v[242:243]
    v_pk_add_f32 v[100:101], v[100:101], v[244:245]
    v_pk_add_f32 v[102:103], v[102:103], v[246:247]
    v_pk_add_f32 v[40:41], v[96:97], v[224:225]
    v_pk_add_f32 v[42:43], v[98:99], v[226:227]
    v_pk_add_f32 v[44:45], v[100:101], v[228:229]
    v_pk_add_f32 v[46:47], v[102:103], v[230:231]
    s_waitcnt vmcnt(0)
XR240:
    v_max_u32 v61, v221, v223
    v_cmp_eq_u32 vcc, -1, v61
    s_cbranch_vccz XK241
    s_add_u32 s81, s83, 12591104
    buffer_load_dwordx4 v[220:223], v1, s[28:31], s81 offen sc1
    s_add_u32 s56, s56, 1
    s_cmp_gt_u32 s56, 200000
    s_waitcnt vmcnt(0)
    s_cbranch_scc0 XR240
XK241:
    v_lshlrev_b32 v248, 16, v220
    v_and_b32 v249, 0xffff0000, v220
    v_lshlrev_b32 v250, 16, v221
    v_and_b32 v251, 0xffff0000, v221
    v_lshlrev_b32 v252, 16, v222
    v_and_b32 v253, 0xffff0000, v222
    v_lshlrev_b32 v254, 16, v223
    v_and_b32 v255, 0xffff0000, v223
    v_pk_add_f32 v[40:41], v[40:41], v[248:249]
    v_pk_add_f32 v[42:43], v[42:43], v[250:251]
    v_pk_add_f32 v[44:45], v[44:45], v[252:253]
    v_pk_add_f32 v[46:47], v[46:47], v[254:255]
    v_cvt_pk_bf16_f32 v228, v32, v33
    v_cvt_pk_bf16_f32 v229, v34, v35
    v_cvt_pk_bf16_f32 v230, v36, v37
    v_cvt_pk_bf16_f32 v231, v38, v39
    s_nop 0
    v_permlane32_swap_b32 v228, v230
    v_permlane32_swap_b32 v229, v231
    buffer_store_dwordx4 v[228:231], v9, s[32:35], s60 offen offset:0
    v_cvt_pk_bf16_f32 v232, v40, v41
    v_cvt_pk_bf16_f32 v233, v42, v43
    v_cvt_pk_bf16_f32 v234, v44, v45
    v_cvt_pk_bf16_f32 v235, v46, v47
    s_nop 0
    v_permlane32_swap_b32 v232, v234
    v_permlane32_swap_b32 v233, v235
    buffer_store_dwordx4 v[232:235], v9, s[32:35], s60 offen offset:64
L_end:
    s_endpgm
SR14:
    s_add_u32 s56, s56, 1
    s_cmp_gt_u32 s56, 200000
    s_cbranch_scc1 SR14x
    buffer_load_dword v63, v89, s[28:31], s80 offen sc1
    s_waitcnt vmcnt(0)
    v_cmp_eq_u32 vcc, -1, v63
    s_cbranch_vccnz SR14
    s_add_u32 s76, s80, 0
    buffer_load_dwordx2 v[128:129], v2, s[28:31], s76 offen offset:0 sc1
    buffer_load_dwordx2 v[130:131], v2, s[28:31], s76 offen offset:2048 sc1
    s_add_u32 s76, s80, 4096
    buffer_load_dwordx2 v[132:133], v2, s[28:31], s76 offen offset:0 sc1
    buffer_load_dwordx2 v[134:135], v2, s[28:31], s76 offen offset:2048 sc1
    s_add_u32 s76, s80, 8192
    buffer_load_dwordx2 v[136:137], v2, s[28:31], s76 offen offset:0 sc1
    buffer_load_dwordx2 v[138:139], v2, s[28:31], s76 offen offset:2048 sc1
    s_add_u32 s76, s80, 12288
    buffer_load_dwordx2 v[140:141], v2, s[28:31], s76 offen offset:0 sc1
    buffer_load_dwordx2 v[142:143], v2, s[28:31], s76 offen offset:2048 sc1
    s_add_u32 s76, s80, 16384
    buffer_load_dwordx2 v[144:145], v2, s[28:31], s76 offen offset:0 sc1
    buffer_load_dwordx2 v[146:147], v2, s[28:31], s76 offen offset:2048 sc1
    s_add_u32 s76, s80, 20480
    buffer_load_dwordx2 v[148:149], v2, s[28:31], s76 offen offset:0 sc1
    buffer_load_dwordx2 v[150:151], v2, s[28:31], s76 offen offset:2048 sc1
    s_add_u32 s76, s80, 24576
    buffer_load_dwordx2 v[152:153], v2, s[28:31], s76 offen offset:0 sc1
    buffer_load_dwordx2 v[154:155], v2, s[28:31], s76 offen offset:2048 sc1
    s_add_u32 s76, s80, 28672
    buffer_load_dwordx2 v[156:157], v2, s[28:31], s76 offen offset:0 sc1
    buffer_load_dwordx2 v[158:159], v2, s[28:31], s76 offen offset:2048 sc1
    s_waitcnt vmcnt(0)
    s_branch SU13
PL15:
    buffer_store_dwordx4 v[48:51], v1, s[28:31], s81 offen sc0 sc1
    buffer_store_dwordx4 v[52:55], v1, s[28:31], s81 offen offset:1024 sc0 sc1
    s_branch PE16
RT19:
    s_add_u32 s56, s56, 1
    s_cmp_gt_u32 s56, 200000
    s_cbranch_scc1 CD20
    buffer_load_dword v63, v14, s[28:31], s80 offen sc1
    s_waitcnt vmcnt(0)
    v_cmp_eq_u32 vcc, -1, v63
    s_cbranch_vccnz RT19
    s_add_u32 s76, s7, 0
    buffer_load_dwordx4 v[160:163], v1, s[28:31], s76 offen offset:0 sc1
    buffer_load_dwordx4 v[164:167], v1, s[28:31], s76 offen offset:1024 sc1
    buffer_load_dwordx4 v[168:171], v1, s[28:31], s76 offen offset:2048 sc1
    buffer_load_dwordx4 v[172:175], v1, s[28:31], s76 offen offset:3072 sc1
    s_add_u32 s76, s7, 4096
    buffer_load_dwordx4 v[176:179], v1, s[28:31], s76 offen offset:0 sc1
    buffer_load_dwordx4 v[180:183], v1, s[28:31], s76 offen offset:1024 sc1
    buffer_load_dwordx4 v[184:187], v1, s[28:31], s76 offen offset:2048 sc1
    buffer_load_dwordx4 v[188:191], v1, s[28:31], s76 offen offset:3072 sc1
    s_add_u32 s76, s6, 0
    buffer_load_dwordx4 v[128:131], v1, s[28:31], s76 offen offset:0 sc1
    buffer_load_dwordx4 v[132:135], v1, s[28:31], s76 offen offset:1024 sc1
    buffer_load_dwordx4 v[136:139], v1, s[28:31], s76 offen offset:2048 sc1
    buffer_load_dwordx4 v[140:143], v1, s[28:31], s76 offen offset:3072 sc1
    s_add_u32 s76, s6, 4096
    buffer_load_dwordx4 v[144:147], v1, s[28:31], s76 offen offset:0 sc1
    buffer_load_dwordx4 v[148:151], v1, s[28:31], s76 offen offset:1024 sc1
    buffer_load_dwordx4 v[152:155], v1, s[28:31], s76 offen offset:2048 sc1
    buffer_load_dwordx4 v[156:159], v1, s[28:31], s76 offen offset:3072 sc1
    s_waitcnt vmcnt(8)
    v_max3_u32 v63, v163, v167, v171
    v_max3_u32 v63, v63, v175, v179
    v_max3_u32 v63, v63, v183, v187
    v_max_u32 v63, v63, v191
    v_cmp_eq_u32 vcc, -1, v63
    s_cbranch_vccnz RT19
    s_branch CD20
RT21:
    s_add_u32 s56, s56, 1
    s_cmp_gt_u32 s56, 200000
    s_cbranch_scc1 CD22
    s_waitcnt vmcnt(0)
    s_add_u32 s76, s6, 0
    buffer_load_dwordx4 v[128:131], v1, s[28:31], s76 offen offset:0 sc1
    buffer_load_dwordx4 v[132:135], v1, s[28:31], s76 offen offset:1024 sc1
    buffer_load_dwordx4 v[136:139], v1, s[28:31], s76 offen offset:2048 sc1
    buffer_load_dwordx4 v[140:143], v1, s[28:31], s76 offen offset:3072 sc1
    s_add_u32 s76, s6, 4096
    buffer_load_dwordx4 v[144:147], v1, s[28:31], s76 offen offset:0 sc1
    buffer_load_dwordx4 v[148:151], v1, s[28:31], s76 offen offset:1024 sc1
    buffer_load_dwordx4 v[152:155], v1, s[28:31], s76 offen offset:2048 sc1
    buffer_load_dwordx4 v[156:159], v1, s[28:31], s76 offen offset:3072 sc1
    s_waitcnt vmcnt(0)
    v_max3_u32 v63, v131, v135, v139
    v_max3_u32 v63, v63, v143, v147
    v_max3_u32 v63, v63, v151, v155
    v_max_u32 v63, v63, v159
    v_cmp_eq_u32 vcc, -1, v63
    s_cbranch_vccnz RT21
    s_branch CD22
PL23:
    buffer_store_dword v128, v61, s[28:31], s81 offen sc0 sc1
    s_branch PE24
RT25:
    s_add_u32 s56, s56, 1
    s_cmp_gt_u32 s56, 200000
    s_cbranch_scc1 CD26
    s_waitcnt vmcnt(0)
    buffer_load_dwordx2 v[144:145], v62, s[28:31], s80 offen offset:0 sc1
    buffer_load_dwordx2 v[146:147], v62, s[28:31], s80 offen offset:512 sc1
    buffer_load_dwordx2 v[148:149], v62, s[28:31], s80 offen offset:1024 sc1
    buffer_load_dwordx2 v[150:151], v62, s[28:31], s80 offen offset:1536 sc1
    buffer_load_dwordx2 v[152:153], v62, s[28:31], s80 offen offset:2048 sc1
    buffer_load_dwordx2 v[154:155], v62, s[28:31], s80 offen offset:2560 sc1
    buffer_load_dwordx2 v[156:157], v62, s[28:31], s80 offen offset:3072 sc1
    s_waitcnt vmcnt(0)
    v_max3_u32 v63, v144, v145, v146
    v_max3_u32 v63, v63, v147, v148
    v_max3_u32 v63, v63, v149, v150
    v_max3_u32 v63, v63, v151, v152
    v_max3_u32 v63, v63, v153, v154
    v_max3_u32 v63, v63, v155, v156
    v_max_u32 v63, v63, v157
    v_cmp_eq_u32 vcc, -1, v63
    s_cbranch_vccnz RT25
    s_branch CD26
RT27:
    s_add_u32 s56, s56, 1
    s_cmp_gt_u32 s56, 200000
    s_cbranch_scc1 CD28
    buffer_load_dword v63, v14, s[28:31], s80 offen sc1
    s_waitcnt vmcnt(0)
    v_cmp_eq_u32 vcc, -1, v63
    s_cbranch_vccnz RT27
    v_mov_b32 v62, 0
    s_add_u32 s76, s6, 0
    buffer_load_dwordx4 v[128:131], v1, s[28:31], s76 offen offset:0 sc1
    s_add_u32 s76, s6, 0
    buffer_load_dwordx4 v[132:135], v1, s[28:31], s76 offen offset:1024 sc1
    s_add_u32 s76, s6, 0
    buffer_load_dwordx4 v[136:139], v1, s[28:31], s76 offen offset:2048 sc1
    s_add_u32 s76, s6, 0
    buffer_load_dwordx4 v[140:143], v1, s[28:31], s76 offen offset:3072 sc1
    s_add_u32 s76, s6, 4096
    buffer_load_dwordx4 v[144:147], v1, s[28:31], s76 offen offset:0 sc1
    s_add_u32 s76, s6, 4096
    buffer_load_dwordx4 v[148:151], v1, s[28:31], s76 offen offset:1024 sc1
    s_add_u32 s76, s6, 4096
    buffer_load_dwordx4 v[152:155], v1, s[28:31], s76 offen offset:2048 sc1
    s_add_u32 s76, s6, 4096
    buffer_load_dwordx4 v[156:159], v1, s[28:31], s76 offen offset:3072 sc1
    s_add_u32 s76, s6, 8192
    buffer_load_dwordx4 v[160:163], v1, s[28:31], s76 offen offset:0 sc1
    s_add_u32 s76, s6, 8192
    buffer_load_dwordx4 v[164:167], v1, s[28:31], s76 offen offset:1024 sc1
    s_add_u32 s76, s6, 8192
    buffer_load_dwordx4 v[168:171], v1, s[28:31], s76 offen offset:2048 sc1
    s_add_u32 s76, s6, 8192
    buffer_load_dwordx4 v[172:175], v1, s[28:31], s76 offen offset:3072 sc1
    s_add_u32 s76, s6, 12288
    buffer_load_dwordx4 v[176:179], v1, s[28:31], s76 offen offset:0 sc1
    s_add_u32 s76, s6, 12288
    buffer_load_dwordx4 v[180:183], v1, s[28:31], s76 offen offset:1024 sc1
    s_add_u32 s76, s6, 12288
    buffer_load_dwordx4 v[184:187], v1, s[28:31], s76 offen offset:2048 sc1
    s_add_u32 s76, s6, 12288
    buffer_load_dwordx4 v[188:191], v1, s[28:31], s76 offen offset:3072 sc1
    s_waitcnt vmcnt(12)
    v_max3_u32 v63, v131, v135, v139
    v_max3_u32 v63, v63, v143, v62
    v_cmp_eq_u32 vcc, -1, v63
    s_cbranch_vccnz RT27
    s_branch CD28
RT29:
    s_add_u32 s56, s56, 1
    s_cmp_gt_u32 s56, 200000
    s_cbranch_scc1 CD30
    s_waitcnt vmcnt(0)
    s_add_u32 s76, s6, 4096
    buffer_load_dwordx4 v[144:147], v1, s[28:31], s76 offen offset:0 sc1
    s_add_u32 s76, s6, 4096
    buffer_load_dwordx4 v[148:151], v1, s[28:31], s76 offen offset:1024 sc1
    s_add_u32 s76, s6, 4096
    buffer_load_dwordx4 v[152:155], v1, s[28:31], s76 offen offset:2048 sc1
    s_add_u32 s76, s6, 4096
    buffer_load_dwordx4 v[156:159], v1, s[28:31], s76 offen offset:3072 sc1
    s_waitcnt vmcnt(0)
    v_max3_u32 v63, v147, v151, v155
    v_max_u32 v63, v63, v159
    v_cmp_eq_u32 vcc, -1, v63
    s_cbranch_vccnz RT29
    s_branch CD30
RT31:
    s_add_u32 s56, s56, 1
    s_cmp_gt_u32 s56, 200000
    s_cbranch_scc1 CD32
    s_waitcnt vmcnt(0)
    s_add_u32 s76, s6, 8192
    buffer_load_dwordx4 v[160:163], v1, s[28:31], s76 offen offset:0 sc1
    s_add_u32 s76, s6, 8192
    buffer_load_dwordx4 v[164:167], v1, s[28:31], s76 offen offset:1024 sc1
    s_add_u32 s76, s6, 8192
    buffer_load_dwordx4 v[168:171], v1, s[28:31], s76 offen offset:2048 sc1
    s_add_u32 s76, s6, 8192
    buffer_load_dwordx4 v[172:175], v1, s[28:31], s76 offen offset:3072 sc1
    s_waitcnt vmcnt(0)
    v_max3_u32 v63, v163, v167, v171
    v_max_u32 v63, v63, v175
    v_cmp_eq_u32 vcc, -1, v63
    s_cbranch_vccnz RT31
    s_branch CD32
RT33:
    s_add_u32 s56, s56, 1
    s_cmp_gt_u32 s56, 200000
    s_cbranch_scc1 CD34
    s_waitcnt vmcnt(0)
    s_add_u32 s76, s6, 12288
    buffer_load_dwordx4 v[176:179], v1, s[28:31], s76 offen offset:0 sc1
    s_add_u32 s76, s6, 12288
    buffer_load_dwordx4 v[180:183], v1, s[28:31], s76 offen offset:1024 sc1
    s_add_u32 s76, s6, 12288
    buffer_load_dwordx4 v[184:187], v1, s[28:31], s76 offen offset:2048 sc1
    s_add_u32 s76, s6, 12288
    buffer_load_dwordx4 v[188:191], v1, s[28:31], s76 offen offset:3072 sc1
    s_waitcnt vmcnt(0)
    v_max3_u32 v63, v179, v183, v187
    v_max_u32 v63, v63, v191
    v_cmp_eq_u32 vcc, -1, v63
    s_cbranch_vccnz RT33
    s_branch CD34
RT35:
    s_add_u32 s56, s56, 1
    s_cmp_gt_u32 s56, 200000
    s_cbranch_scc1 CD36
    s_waitcnt vmcnt(0)
    s_add_u32 s76, s7, 0
    buffer_load_dwordx4 v[192:195], v1, s[28:31], s76 offen offset:0 sc1
    s_add_u32 s76, s7, 0
    buffer_load_dwordx4 v[196:199], v1, s[28:31], s76 offen offset:1024 sc1
    s_add_u32 s76, s7, 0
    buffer_load_dwordx4 v[200:203], v1, s[28:31], s76 offen offset:2048 sc1
    s_add_u32 s76, s7, 0
    buffer_load_dwordx4 v[204:207], v1, s[28:31], s76 offen offset:3072 sc1
    s_waitcnt vmcnt(0)
    v_max3_u32 v63, v195, v199, v203
    v_max_u32 v63, v63, v207
    v_cmp_eq_u32 vcc, -1, v63
    s_cbranch_vccnz RT35
    s_branch CD36
RT37:
    s_add_u32 s56, s56, 1
    s_cmp_gt_u32 s56, 200000
    s_cbranch_scc1 CD38
    s_waitcnt vmcnt(0)
    s_add_u32 s76, s7, 4096
    buffer_load_dwordx4 v[208:211], v1, s[28:31], s76 offen offset:0 sc1
    s_add_u32 s76, s7, 4096
    buffer_load_dwordx4 v[212:215], v1, s[28:31], s76 offen offset:1024 sc1
    s_add_u32 s76, s7, 4096
    buffer_load_dwordx4 v[128:131], v1, s[28:31], s76 offen offset:2048 sc1
    s_add_u32 s76, s7, 4096
    buffer_load_dwordx4 v[132:135], v1, s[28:31], s76 offen offset:3072 sc1
    s_waitcnt vmcnt(0)
    v_max3_u32 v63, v211, v215, v131
    v_max_u32 v63, v63, v135
    v_cmp_eq_u32 vcc, -1, v63
    s_cbranch_vccnz RT37
    s_branch CD38
RT39:
    s_add_u32 s56, s56, 1
    s_cmp_gt_u32 s56, 200000
    s_cbranch_scc1 CD40
    s_waitcnt vmcnt(0)
    s_add_u32 s76, s7, 8192
    buffer_load_dwordx4 v[136:139], v1, s[28:31], s76 offen offset:0 sc1
    s_add_u32 s76, s7, 8192
    buffer_load_dwordx4 v[140:143], v1, s[28:31], s76 offen offset:1024 sc1
    s_add_u32 s76, s7, 8192
    buffer_load_dwordx4 v[144:147], v1, s[28:31], s76 offen offset:2048 sc1
    s_add_u32 s76, s7, 8192
    buffer_load_dwordx4 v[148:151], v1, s[28:31], s76 offen offset:3072 sc1
    s_waitcnt vmcnt(0)
    v_max3_u32 v63, v139, v143, v147
    v_max_u32 v63, v63, v151
    v_cmp_eq_u32 vcc, -1, v63
    s_cbranch_vccnz RT39
    s_branch CD40
RT41:
    s_add_u32 s56, s56, 1
    s_cmp_gt_u32 s56, 200000
    s_cbranch_scc1 CD42
    s_waitcnt vmcnt(0)
    s_add_u32 s76, s7, 12288
    buffer_load_dwordx4 v[152:155], v1, s[28:31], s76 offen offset:0 sc1
    s_add_u32 s76, s7, 12288
    buffer_load_dwordx4 v[156:159], v1, s[28:31], s76 offen offset:1024 sc1
    s_add_u32 s76, s7, 12288
    buffer_load_dwordx4 v[160:163], v1, s[28:31], s76 offen offset:2048 sc1
    s_add_u32 s76, s7, 12288
    buffer_load_dwordx4 v[164:167], v1, s[28:31], s76 offen offset:3072 sc1
    s_waitcnt vmcnt(0)
    v_max3_u32 v63, v155, v159, v163
    v_max_u32 v63, v63, v167
    v_cmp_eq_u32 vcc, -1, v63
    s_cbranch_vccnz RT41
    s_branch CD42
RT43:
    s_add_u32 s56, s56, 1
    s_cmp_gt_u32 s56, 200000
    s_cbranch_scc1 CD44
    s_waitcnt vmcnt(0)
    s_add_u32 s76, s6, 131072
    buffer_load_dwordx4 v[168:171], v1, s[28:31], s76 offen offset:0 sc1
    s_add_u32 s76, s6, 131072
    buffer_load_dwordx4 v[172:175], v1, s[28:31], s76 offen offset:1024 sc1
    s_add_u32 s76, s6, 131072
    buffer_load_dwordx4 v[176:179], v1, s[28:31], s76 offen offset:2048 sc1
    s_add_u32 s76, s6, 131072
    buffer_load_dwordx4 v[180:183], v1, s[28:31], s76 offen offset:3072 sc1
    s_waitcnt vmcnt(0)
    v_max3_u32 v63, v171, v175, v179
    v_max_u32 v63, v63, v183
    v_cmp_eq_u32 vcc, -1, v63
    s_cbranch_vccnz RT43
    s_branch CD44
PL45:
    buffer_store_dwordx4 v[64:67], v1, s[28:31], s81 offen sc0 sc1
    s_branch PE46
RT47:
    s_add_u32 s56, s56, 1
    s_cmp_gt_u32 s56, 200000
    s_cbranch_scc1 CD48
    s_waitcnt vmcnt(0)
    s_add_u32 s76, s6, 135168
    buffer_load_dwordx4 v[184:187], v1, s[28:31], s76 offen offset:0 sc1
    s_add_u32 s76, s6, 135168
    buffer_load_dwordx4 v[188:191], v1, s[28:31], s76 offen offset:1024 sc1
    s_add_u32 s76, s6, 135168
    buffer_load_dwordx4 v[192:195], v1, s[28:31], s76 offen offset:2048 sc1
    s_add_u32 s76, s6, 135168
    buffer_load_dwordx4 v[196:199], v1, s[28:31], s76 offen offset:3072 sc1
    s_waitcnt vmcnt(0)
    v_max3_u32 v63, v187, v191, v195
    v_max_u32 v63, v63, v199
    v_cmp_eq_u32 vcc, -1, v63
    s_cbranch_vccnz RT47
    s_branch CD48
RT51:
    s_add_u32 s56, s56, 1
    s_cmp_gt_u32 s56, 200000
    s_cbranch_scc1 CD52
    s_waitcnt vmcnt(0)
    s_add_u32 s76, s6, 139264
    buffer_load_dwordx4 v[200:203], v1, s[28:31], s76 offen offset:0 sc1
    s_add_u32 s76, s6, 139264
    buffer_load_dwordx4 v[204:207], v1, s[28:31], s76 offen offset:1024 sc1
    s_add_u32 s76, s6, 139264
    buffer_load_dwordx4 v[208:211], v1, s[28:31], s76 offen offset:2048 sc1
    s_add_u32 s76, s6, 139264
    buffer_load_dwordx4 v[212:215], v1, s[28:31], s76 offen offset:3072 sc1
    s_waitcnt vmcnt(0)
    v_max3_u32 v63, v203, v207, v211
    v_max_u32 v63, v63, v215
    v_cmp_eq_u32 vcc, -1, v63
    s_cbranch_vccnz RT51
    s_branch CD52
RT53:
    s_add_u32 s56, s56, 1
    s_cmp_gt_u32 s56, 200000
    s_cbranch_scc1 CD54
    s_waitcnt vmcnt(0)
    s_add_u32 s76, s6, 143360
    buffer_load_dwordx4 v[128:131], v1, s[28:31], s76 offen offset:0 sc1
    s_add_u32 s76, s6, 143360
    buffer_load_dwordx4 v[132:135], v1, s[28:31], s76 offen offset:1024 sc1
    s_add_u32 s76, s6, 143360
    buffer_load_dwordx4 v[136:139], v1, s[28:31], s76 offen offset:2048 sc1
    s_add_u32 s76, s6, 143360
    buffer_load_dwordx4 v[140:143], v1, s[28:31], s76 offen offset:3072 sc1
    s_waitcnt vmcnt(0)
    v_max3_u32 v63, v131, v135, v139
    v_max_u32 v63, v63, v143
    v_cmp_eq_u32 vcc, -1, v63
    s_cbranch_vccnz RT53
    s_branch CD54
RT55:
    s_add_u32 s56, s56, 1
    s_cmp_gt_u32 s56, 200000
    s_cbranch_scc1 CD56
    s_waitcnt vmcnt(0)
    s_add_u32 s76, s7, 131072
    buffer_load_dwordx4 v[144:147], v1, s[28:31], s76 offen offset:0 sc1
    s_add_u32 s76, s7, 131072
    buffer_load_dwordx4 v[148:151], v1, s[28:31], s76 offen offset:1024 sc1
    s_add_u32 s76, s7, 131072
    buffer_load_dwordx4 v[152:155], v1, s[28:31], s76 offen offset:2048 sc1
    s_add_u32 s76, s7, 131072
    buffer_load_dwordx4 v[156:159], v1, s[28:31], s76 offen offset:3072 sc1
    s_waitcnt vmcnt(0)
    v_max3_u32 v63, v147, v151, v155
    v_max_u32 v63, v63, v159
    v_cmp_eq_u32 vcc, -1, v63
    s_cbranch_vccnz RT55
    s_branch CD56
RT49:
    s_add_u32 s56, s56, 1
    s_cmp_gt_u32 s56, 200000
    s_cbranch_scc1 CD50
    s_waitcnt vmcnt(0)
    s_add_u32 s81, s82, 0
    buffer_load_dwordx4 v[216:219], v1, s[28:31], s81 offen sc1
    s_waitcnt vmcnt(0)
    v_max_u32 v61, v217, v219
    v_cmp_eq_u32 vcc, -1, v61
    s_cbranch_vccnz RT49
    s_branch CD50
RT57:
    s_add_u32 s56, s56, 1
    s_cmp_gt_u32 s56, 200000
    s_cbranch_scc1 CD58
    s_waitcnt vmcnt(0)
    s_add_u32 s76, s7, 135168
    buffer_load_dwordx4 v[160:163], v1, s[28:31], s76 offen offset:0 sc1
    s_add_u32 s76, s7, 135168
    buffer_load_dwordx4 v[164:167], v1, s[28:31], s76 offen offset:1024 sc1
    s_add_u32 s76, s7, 135168
    buffer_load_dwordx4 v[168:171], v1, s[28:31], s76 offen offset:2048 sc1
    s_add_u32 s76, s7, 135168
    buffer_load_dwordx4 v[172:175], v1, s[28:31], s76 offen offset:3072 sc1
    s_waitcnt vmcnt(0)
    v_max3_u32 v63, v163, v167, v171
    v_max_u32 v63, v63, v175
    v_cmp_eq_u32 vcc, -1, v63
    s_cbranch_vccnz RT57
    s_branch CD58
RT59:
    s_add_u32 s56, s56, 1
    s_cmp_gt_u32 s56, 200000
    s_cbranch_scc1 CD60
    s_waitcnt vmcnt(0)
    s_add_u32 s76, s7, 139264
    buffer_load_dwordx4 v[176:179], v1, s[28:31], s76 offen offset:0 sc1
    s_add_u32 s76, s7, 139264
    buffer_load_dwordx4 v[180:183], v1, s[28:31], s76 offen offset:1024 sc1
    s_add_u32 s76, s7, 139264
    buffer_load_dwordx4 v[184:187], v1, s[28:31], s76 offen offset:2048 sc1
    s_add_u32 s76, s7, 139264
    buffer_load_dwordx4 v[188:191], v1, s[28:31], s76 offen offset:3072 sc1
    s_waitcnt vmcnt(0)
    v_max3_u32 v63, v179, v183, v187
    v_max_u32 v63, v63, v191
    v_cmp_eq_u32 vcc, -1, v63
    s_cbranch_vccnz RT59
    s_branch CD60
RT61:
    s_add_u32 s56, s56, 1
    s_cmp_gt_u32 s56, 200000
    s_cbranch_scc1 CD62
    s_waitcnt vmcnt(0)
    s_add_u32 s76, s7, 143360
    buffer_load_dwordx4 v[192:195], v1, s[28:31], s76 offen offset:0 sc1
    s_add_u32 s76, s7, 143360
    buffer_load_dwordx4 v[196:199], v1, s[28:31], s76 offen offset:1024 sc1
    s_add_u32 s76, s7, 143360
    buffer_load_dwordx4 v[200:203], v1, s[28:31], s76 offen offset:2048 sc1
    s_add_u32 s76, s7, 143360
    buffer_load_dwordx4 v[204:207], v1, s[28:31], s76 offen offset:3072 sc1
    s_waitcnt vmcnt(0)
    v_max3_u32 v63, v195, v199, v203
    v_max_u32 v63, v63, v207
    v_cmp_eq_u32 vcc, -1, v63
    s_cbranch_vccnz RT61
    s_branch CD62
PL63:
    buffer_store_dwordx4 v[64:67], v1, s[28:31], s81 offen sc0 sc1
    s_branch PE64
L_side0:
    s_waitcnt vmcnt(0)
    s_barrier
    s_lshr_b32 s77, s2, 3
    s_sub_u32 s77, s77, 28
    s_lshl_b32 s77, s77, 2
    s_add_u32 s77, s77, s48
    s_mul_i32 s77, s77, 65536
    s_and_b32 s3, s2, 7
    s_lshl_b32 s3, s3, 9
    s_add_u32 s77, s77, s3
    v_and_b32 v60, 3, v0
    v_lshlrev_b32 v60, 7, v60
    v_lshrrev_b32 v61, 2, v0
    v_lshl_add_u32 v60, v61, 12, v60
    s_add_u32 s4, s77, 0
    buffer_load_dword v62, v60, s[24:27], s4 offen
    s_add_u32 s4, s77, 1048576
    buffer_load_dword v62, v60, s[24:27], s4 offen
    s_add_u32 s4, s77, 2097152
    buffer_load_dword v62, v60, s[24:27], s4 offen
    s_add_u32 s4, s77, 3145728
    buffer_load_dword v62, v60, s[24:27], s4 offen
    s_add_u32 s4, s77, 4194304
    buffer_load_dword v62, v60, s[24:27], s4 offen
    s_add_u32 s4, s77, 5242880
    buffer_load_dword v62, v60, s[24:27], s4 offen
    s_add_u32 s4, s77, 6291456
    buffer_load_dword v62, v60, s[24:27], s4 offen
    s_add_u32 m0, s58, 0
    s_add_u32 s4, s63, 0
    buffer_load_dwordx4 v59, s[24:27], s4 offen lds
    s_add_u32 m0, s58, 1024
    s_add_u32 s4, s63, 32768
    buffer_load_dwordx4 v59, s[24:27], s4 offen lds
    s_add_u32 m0, s58, 2048
    s_add_u32 s4, s63, 65536
    buffer_load_dwordx4 v59, s[24:27], s4 offen lds
    s_add_u32 m0, s58, 3072
    s_add_u32 s4, s63, 98304
    buffer_load_dwordx4 v59, s[24:27], s4 offen lds
    s_add_u32 m0, s58, 4096
    s_add_u32 s4, s63, 131072
    buffer_load_dwordx4 v59, s[24:27], s4 offen lds
    s_add_u32 m0, s58, 5120
    s_add_u32 s4, s63, 163840
    buffer_load_dwordx4 v59, s[24:27], s4 offen lds
    s_add_u32 m0, s58, 6144
    s_add_u32 s4, s63, 196608
    buffer_load_dwordx4 v59, s[24:27], s4 offen lds
    s_add_u32 m0, s58, 7168
    s_add_u32 s4, s63, 229376
    buffer_load_dwordx4 v59, s[24:27], s4 offen lds
    s_add_u32 m0, s58, 8192
    s_add_u32 s4, s63, 262144
    buffer_load_dwordx4 v59, s[24:27], s4 offen lds
    s_add_u32 m0, s58, 9216
    s_add_u32 s4, s63, 294912
    buffer_load_dwordx4 v59, s[24:27], s4 offen lds
    s_add_u32 m0, s58, 10240
    s_add_u32 s4, s63, 327680
    buffer_load_dwordx4 v59, s[24:27], s4 offen lds
    s_add_u32 m0, s58, 11264
    s_add_u32 s4, s63, 360448
    buffer_load_dwordx4 v59, s[24:27], s4 offen lds
    s_add_u32 m0, s58, 12288
    s_add_u32 s4, s63, 393216
    buffer_load_dwordx4 v59, s[24:27], s4 offen lds
    s_add_u32 m0, s58, 13312
    s_add_u32 s4, s63, 425984
    buffer_load_dwordx4 v59, s[24:27], s4 offen lds
    s_add_u32 m0, s58, 14336
    s_add_u32 s4, s63, 458752
    buffer_load_dwordx4 v59, s[24:27], s4 offen lds
    s_add_u32 m0, s58, 15360
    s_add_u32 s4, s63, 491520
    buffer_load_dwordx4 v59, s[24:27], s4 offen lds
    s_waitcnt vmcnt(0)
    ds_read_b64_tr_b16 a[128:129], v3 offset:0
    ds_read_b64_tr_b16 a[130:131], v3 offset:1024
    ds_read_b64_tr_b16 a[132:133], v3 offset:512
    ds_read_b64_tr_b16 a[134:135], v3 offset:1536
    ds_read_b64_tr_b16 a[136:137], v3 offset:2048
    ds_read_b64_tr_b16 a[138:139], v3 offset:3072
    ds_read_b64_tr_b16 a[140:141], v3 offset:2560
    ds_read_b64_tr_b16 a[142:143], v3 offset:3584
    ds_read_b64_tr_b16 a[144:145], v3 offset:4096
    ds_read_b64_tr_b16 a[146:147], v3 offset:5120
    ds_read_b64_tr_b16 a[148:149], v3 offset:4608
    ds_read_b64_tr_b16 a[150:151], v3 offset:5632
    ds_read_b64_tr_b16 a[152:153], v3 offset:6144
    ds_read_b64_tr_b16 a[154:155], v3 offset:7168
    ds_read_b64_tr_b16 a[156:157], v3 offset:6656
    ds_read_b64_tr_b16 a[158:159], v3 offset:7680
    ds_read_b64_tr_b16 a[160:161], v3 offset:8192
    ds_read_b64_tr_b16 a[162:163], v3 offset:9216
    ds_read_b64_tr_b16 a[164:165], v3 offset:8704
    ds_read_b64_tr_b16 a[166:167], v3 offset:9728
    ds_read_b64_tr_b16 a[168:169], v3 offset:10240
    ds_read_b64_tr_b16 a[170:171], v3 offset:11264
    ds_read_b64_tr_b16 a[172:173], v3 offset:10752
    ds_read_b64_tr_b16 a[174:175], v3 offset:11776
    ds_read_b64_tr_b16 a[176:177], v3 offset:12288
    ds_read_b64_tr_b16 a[178:179], v3 offset:13312
    ds_read_b64_tr_b16 a[180:181], v3 offset:12800
    ds_read_b64_tr_b16 a[182:183], v3 offset:13824
    ds_read_b64_tr_b16 a[184:185], v3 offset:14336
    ds_read_b64_tr_b16 a[186:187], v3 offset:15360
    ds_read_b64_tr_b16 a[188:189], v3 offset:14848
    ds_read_b64_tr_b16 a[190:191], v3 offset:15872
    s_waitcnt lgkmcnt(0)
    s_add_u32 m0, s58, 0
    s_add_u32 s4, s63, 524288
    buffer_load_dwordx4 v59, s[24:27], s4 offen lds
    s_add_u32 m0, s58, 1024
    s_add_u32 s4, s63, 557056
    buffer_load_dwordx4 v59, s[24:27], s4 offen lds
    s_add_u32 m0, s58, 2048
    s_add_u32 s4, s63, 589824
    buffer_load_dwordx4 v59, s[24:27], s4 offen lds
    s_add_u32 m0, s58, 3072
    s_add_u32 s4, s63, 622592
    buffer_load_dwordx4 v59, s[24:27], s4 offen lds
    s_add_u32 m0, s58, 4096
    s_add_u32 s4, s63, 655360
    buffer_load_dwordx4 v59, s[24:27], s4 offen lds
    s_add_u32 m0, s58, 5120
    s_add_u32 s4, s63, 688128
    buffer_load_dwordx4 v59, s[24:27], s4 offen lds
    s_add_u32 m0, s58, 6144
    s_add_u32 s4, s63, 720896
    buffer_load_dwordx4 v59, s[24:27], s4 offen lds
    s_add_u32 m0, s58, 7168
    s_add_u32 s4, s63, 753664
    buffer_load_dwordx4 v59, s[24:27], s4 offen lds
    s_add_u32 m0, s58, 8192
    s_add_u32 s4, s63, 786432
    buffer_load_dwordx4 v59, s[24:27], s4 offen lds
    s_add_u32 m0, s58, 9216
    s_add_u32 s4, s63, 819200
    buffer_load_dwordx4 v59, s[24:27], s4 offen lds
    s_add_u32 m0, s58, 10240
    s_add_u32 s4, s63, 851968
    buffer_load_dwordx4 v59, s[24:27], s4 offen lds
    s_add_u32 m0, s58, 11264
    s_add_u32 s4, s63, 884736
    buffer_load_dwordx4 v59, s[24:27], s4 offen lds
    s_waitcnt vmcnt(0)
    ds_read_b64_tr_b16 a[192:193], v3 offset:0
    ds_read_b64_tr_b16 a[194:195], v3 offset:1024
    ds_read_b64_tr_b16 a[196:197], v3 offset:512
    ds_read_b64_tr_b16 a[198:199], v3 offset:1536
    ds_read_b64_tr_b16 a[200:201], v3 offset:2048
    ds_read_b64_tr_b16 a[202:203], v3 offset:3072
    ds_read_b64_tr_b16 a[204:205], v3 offset:2560
    ds_read_b64_tr_b16 a[206:207], v3 offset:3584
    ds_read_b64_tr_b16 a[208:209], v3 offset:4096
    ds_read_b64_tr_b16 a[210:211], v3 offset:5120
    ds_read_b64_tr_b16 a[212:213], v3 offset:4608
    ds_read_b64_tr_b16 a[214:215], v3 offset:5632
    ds_read_b64_tr_b16 a[216:217], v3 offset:6144
    ds_read_b64_tr_b16 a[218:219], v3 offset:7168
    ds_read_b64_tr_b16 a[220:221], v3 offset:6656
    ds_read_b64_tr_b16 a[222:223], v3 offset:7680
    ds_read_b64_tr_b16 a[224:225], v3 offset:8192
    ds_read_b64_tr_b16 a[226:227], v3 offset:9216
    ds_read_b64_tr_b16 a[228:229], v3 offset:8704
    ds_read_b64_tr_b16 a[230:231], v3 offset:9728
    ds_read_b64_tr_b16 a[232:233], v3 offset:10240
    ds_read_b64_tr_b16 a[234:235], v3 offset:11264
    ds_read_b64_tr_b16 a[236:237], v3 offset:10752
    ds_read_b64_tr_b16 a[238:239], v3 offset:11776
    s_waitcnt lgkmcnt(0)
    s_barrier
    v_and_b32 v60, 15, v0
    v_lshlrev_b32 v60, 11, v60
    s_lshl_b32 s3, s5, 15
    s_add_u32 s76, s3, 1048576
    buffer_load_dword v61, v60, s[28:31], s76 offen sc1
    s_waitcnt vmcnt(0)
PS67:
    v_cmp_eq_u32 vcc, -1, v61
    s_cbranch_vccz PK68
    s_sleep 8
    buffer_load_dword v61, v60, s[28:31], s76 offen sc1
    s_add_u32 s56, s56, 1
    s_cmp_gt_u32 s56, 200000
    s_waitcnt vmcnt(0)
    s_cbranch_scc0 PS67
PK68:
    v_lshlrev_b32 v60, 11, v0
    s_mov_b32 s76, 6291456
    buffer_load_dword v61, v60, s[28:31], s76 offen sc1
    s_waitcnt vmcnt(0)
PS69:
    v_cmp_eq_u32 vcc, -1, v61
    s_cbranch_vccz PK70
    s_sleep 8
    buffer_load_dword v61, v60, s[28:31], s76 offen sc1
    s_add_u32 s56, s56, 1
    s_cmp_gt_u32 s56, 200000
    s_waitcnt vmcnt(0)
    s_cbranch_scc0 PS69
PK70:
    s_and_b32 s3, s52, 1
    s_lshl_b32 s3, s3, 2
    s_add_u32 s3, s3, s48
    s_mul_i32 s4, s3, 14336
    s_add_u32 s4, s4, 9961472
    s_and_b32 s3, s52, 6
    s_mul_i32 s10, s3, 229376
    s_add_u32 s10, s10, s4
    s_cmp_eq_u32 s3, 6
    s_cselect_b32 s3, 1073741824, 0
    s_cselect_b32 s4, 0, 229376
    s_add_u32 s3, s3, s4
    s_add_u32 s4, s10, s3
    s_bitcmp1_b32 s52, 0
    s_cselect_b32 s8, s10, s4
    s_cselect_b32 s9, s4, s10
    v_and_b32 v15, 15, v0
    v_min_u32 v15, 13, v15
    v_lshlrev_b32 v15, 10, v15
    v_bfe_u32 v60, v0, 4, 1
    v_mul_lo_u32 v60, v60, s3
    v_add3_u32 v15, v15, v60, 4
    v_and_b32 v61, 31, v0
    v_lshrrev_b32 v60, 5, v0
    v_mul_u32_u24 v9, 896, v61
    v_lshl_add_u32 v9, v60, 4, v9
    buffer_load_dword v62, v15, s[28:31], s10 offen sc1
    s_waitcnt vmcnt(0)
PS71:
    v_cmp_eq_u32 vcc, -1, v62
    s_cbranch_vccz PK72
    s_sleep 4
    buffer_load_dword v62, v15, s[28:31], s10 offen sc1
    s_add_u32 s56, s56, 1
    s_cmp_gt_u32 s56, 200000
    s_waitcnt vmcnt(0)
    s_cbranch_scc0 PS71
PK72:
    s_add_u32 s77, s8, 0
    buffer_load_dwordx4 v[128:131], v8, s[28:31], s77 offen offset:0 sc1
    buffer_load_dwordx4 v[132:135], v8, s[28:31], s77 offen offset:1024 sc1
    buffer_load_dwordx4 v[136:139], v8, s[28:31], s77 offen offset:2048 sc1
    buffer_load_dwordx4 v[140:143], v8, s[28:31], s77 offen offset:3072 sc1
    s_add_u32 s77, s8, 4096
    buffer_load_dwordx4 v[144:147], v8, s[28:31], s77 offen offset:0 sc1
    buffer_load_dwordx4 v[148:151], v8, s[28:31], s77 offen offset:1024 sc1
    buffer_load_dwordx4 v[152:155], v8, s[28:31], s77 offen offset:2048 sc1
    buffer_load_dwordx4 v[156:159], v8, s[28:31], s77 offen offset:3072 sc1
    s_add_u32 s77, s8, 8192
    buffer_load_dwordx4 v[160:163], v8, s[28:31], s77 offen offset:0 sc1
    buffer_load_dwordx4 v[164:167], v8, s[28:31], s77 offen offset:1024 sc1
    buffer_load_dwordx4 v[168:171], v8, s[28:31], s77 offen offset:2048 sc1
    buffer_load_dwordx4 v[172:175], v8, s[28:31], s77 offen offset:3072 sc1
    s_add_u32 s77, s8, 12288
    buffer_load_dwordx4 v[176:179], v8, s[28:31], s77 offen offset:0 sc1
    buffer_load_dwordx4 v[180:183], v8, s[28:31], s77 offen offset:1024 sc1
    s_add_u32 s77, s9, 0
    buffer_load_dwordx4 v[184:187], v8, s[28:31], s77 offen offset:0 sc1
    buffer_load_dwordx4 v[188:191], v8, s[28:31], s77 offen offset:1024 sc1
    s_waitcnt vmcnt(0)
    s_branch L_p4_0
RT73:
    s_add_u32 s56, s56, 1
    s_cmp_gt_u32 s56, 200000
    s_cbranch_scc1 CD74
    buffer_load_dword v63, v15, s[28:31], s10 offen sc1
    s_waitcnt vmcnt(0)
    v_cmp_eq_u32 vcc, -1, v63
    s_cbranch_vccnz RT73
    v_mov_b32 v62, 0
    s_add_u32 s76, s8, 0
    buffer_load_dwordx4 v[128:131], v8, s[28:31], s76 offen offset:0 sc1
    s_add_u32 s76, s8, 0
    buffer_load_dwordx4 v[132:135], v8, s[28:31], s76 offen offset:1024 sc1
    s_add_u32 s76, s8, 0
    buffer_load_dwordx4 v[136:139], v8, s[28:31], s76 offen offset:2048 sc1
    s_add_u32 s76, s8, 0
    buffer_load_dwordx4 v[140:143], v8, s[28:31], s76 offen offset:3072 sc1
    s_add_u32 s76, s8, 4096
    buffer_load_dwordx4 v[144:147], v8, s[28:31], s76 offen offset:0 sc1
    s_add_u32 s76, s8, 4096
    buffer_load_dwordx4 v[148:151], v8, s[28:31], s76 offen offset:1024 sc1
    s_add_u32 s76, s8, 4096
    buffer_load_dwordx4 v[152:155], v8, s[28:31], s76 offen offset:2048 sc1
    s_add_u32 s76, s8, 4096
    buffer_load_dwordx4 v[156:159], v8, s[28:31], s76 offen offset:3072 sc1
    s_add_u32 s76, s8, 8192
    buffer_load_dwordx4 v[160:163], v8, s[28:31], s76 offen offset:0 sc1
    s_add_u32 s76, s8, 8192
    buffer_load_dwordx4 v[164:167], v8, s[28:31], s76 offen offset:1024 sc1
    s_add_u32 s76, s8, 8192
    buffer_load_dwordx4 v[168:171], v8, s[28:31], s76 offen offset:2048 sc1
    s_add_u32 s76, s8, 8192
    buffer_load_dwordx4 v[172:175], v8, s[28:31], s76 offen offset:3072 sc1
    s_add_u32 s76, s8, 12288
    buffer_load_dwordx4 v[176:179], v8, s[28:31], s76 offen offset:0 sc1
    s_add_u32 s76, s8, 12288
    buffer_load_dwordx4 v[180:183], v8, s[28:31], s76 offen offset:1024 sc1
    s_add_u32 s76, s9, 0
    buffer_load_dwordx4 v[184:187], v8, s[28:31], s76 offen offset:0 sc1
    s_add_u32 s76, s9, 0
    buffer_load_dwordx4 v[188:191], v8, s[28:31], s76 offen offset:1024 sc1
    s_waitcnt vmcnt(12)
    v_max3_u32 v63, v131, v135, v139
    v_max3_u32 v63, v63, v143, v62
    v_cmp_eq_u32 vcc, -1, v63
    s_cbranch_vccnz RT73
    s_branch CD74
RT75:
    s_add_u32 s56, s56, 1
    s_cmp_gt_u32 s56, 200000
    s_cbranch_scc1 CD76
    s_waitcnt vmcnt(0)
    s_add_u32 s76, s8, 4096
    buffer_load_dwordx4 v[144:147], v8, s[28:31], s76 offen offset:0 sc1
    s_add_u32 s76, s8, 4096
    buffer_load_dwordx4 v[148:151], v8, s[28:31], s76 offen offset:1024 sc1
    s_add_u32 s76, s8, 4096
    buffer_load_dwordx4 v[152:155], v8, s[28:31], s76 offen offset:2048 sc1
    s_add_u32 s76, s8, 4096
    buffer_load_dwordx4 v[156:159], v8, s[28:31], s76 offen offset:3072 sc1
    s_waitcnt vmcnt(0)
    v_max3_u32 v63, v147, v151, v155
    v_max_u32 v63, v63, v159
    v_cmp_eq_u32 vcc, -1, v63
    s_cbranch_vccnz RT75
    s_branch CD76
RT77:
    s_add_u32 s56, s56, 1
    s_cmp_gt_u32 s56, 200000
    s_cbranch_scc1 CD78
    s_waitcnt vmcnt(0)
    s_add_u32 s76, s8, 8192
    buffer_load_dwordx4 v[160:163], v8, s[28:31], s76 offen offset:0 sc1
    s_add_u32 s76, s8, 8192
    buffer_load_dwordx4 v[164:167], v8, s[28:31], s76 offen offset:1024 sc1
    s_add_u32 s76, s8, 8192
    buffer_load_dwordx4 v[168:171], v8, s[28:31], s76 offen offset:2048 sc1
    s_add_u32 s76, s8, 8192
    buffer_load_dwordx4 v[172:175], v8, s[28:31], s76 offen offset:3072 sc1
    s_waitcnt vmcnt(0)
    v_max3_u32 v63, v163, v167, v171
    v_max_u32 v63, v63, v175
    v_cmp_eq_u32 vcc, -1, v63
    s_cbranch_vccnz RT77
    s_branch CD78
RT79:
    s_add_u32 s56, s56, 1
    s_cmp_gt_u32 s56, 200000
    s_cbranch_scc1 CD80
    s_waitcnt vmcnt(0)
    s_add_u32 s76, s8, 12288
    buffer_load_dwordx4 v[176:179], v8, s[28:31], s76 offen offset:0 sc1
    s_add_u32 s76, s8, 12288
    buffer_load_dwordx4 v[180:183], v8, s[28:31], s76 offen offset:1024 sc1
    s_add_u32 s76, s9, 0
    buffer_load_dwordx4 v[184:187], v8, s[28:31], s76 offen offset:0 sc1
    s_add_u32 s76, s9, 0
    buffer_load_dwordx4 v[188:191], v8, s[28:31], s76 offen offset:1024 sc1
    s_waitcnt vmcnt(0)
    v_max3_u32 v63, v179, v183, v187
    v_max_u32 v63, v63, v191
    v_cmp_eq_u32 vcc, -1, v63
    s_cbranch_vccnz RT79
    s_branch CD80
RT81:
    s_add_u32 s56, s56, 1
    s_cmp_gt_u32 s56, 200000
    s_cbranch_scc1 CD82
    s_waitcnt vmcnt(0)
    s_add_u32 s76, s9, 0
    buffer_load_dwordx4 v[192:195], v8, s[28:31], s76 offen offset:2048 sc1
    s_add_u32 s76, s9, 0
    buffer_load_dwordx4 v[196:199], v8, s[28:31], s76 offen offset:3072 sc1
    s_add_u32 s76, s9, 4096
    buffer_load_dwordx4 v[200:203], v8, s[28:31], s76 offen offset:0 sc1
    s_add_u32 s76, s9, 4096
    buffer_load_dwordx4 v[204:207], v8, s[28:31], s76 offen offset:1024 sc1
    s_waitcnt vmcnt(0)
    v_max3_u32 v63, v195, v199, v203
    v_max_u32 v63, v63, v207
    v_cmp_eq_u32 vcc, -1, v63
    s_cbranch_vccnz RT81
    s_branch CD82
RT83:
    s_add_u32 s56, s56, 1
    s_cmp_gt_u32 s56, 200000
    s_cbranch_scc1 CD84
    s_waitcnt vmcnt(0)
    s_add_u32 s76, s9, 4096
    buffer_load_dwordx4 v[208:211], v8, s[28:31], s76 offen offset:2048 sc1
    s_add_u32 s76, s9, 4096
    buffer_load_dwordx4 v[212:215], v8, s[28:31], s76 offen offset:3072 sc1
    s_add_u32 s76, s9, 8192
    buffer_load_dwordx4 v[128:131], v8, s[28:31], s76 offen offset:0 sc1
    s_add_u32 s76, s9, 8192
    buffer_load_dwordx4 v[132:135], v8, s[28:31], s76 offen offset:1024 sc1
    s_waitcnt vmcnt(0)
    v_max3_u32 v63, v211, v215, v131
    v_max_u32 v63, v63, v135
    v_cmp_eq_u32 vcc, -1, v63
    s_cbranch_vccnz RT83
    s_branch CD84
RT85:
    s_add_u32 s56, s56, 1
    s_cmp_gt_u32 s56, 200000
    s_cbranch_scc1 CD86
    s_waitcnt vmcnt(0)
    s_add_u32 s76, s9, 8192
    buffer_load_dwordx4 v[136:139], v8, s[28:31], s76 offen offset:2048 sc1
    s_add_u32 s76, s9, 8192
    buffer_load_dwordx4 v[140:143], v8, s[28:31], s76 offen offset:3072 sc1
    s_add_u32 s76, s9, 12288
    buffer_load_dwordx4 v[144:147], v8, s[28:31], s76 offen offset:0 sc1
    s_add_u32 s76, s9, 12288
    buffer_load_dwordx4 v[148:151], v8, s[28:31], s76 offen offset:1024 sc1
    s_waitcnt vmcnt(0)
    v_max3_u32 v63, v139, v143, v147
    v_max_u32 v63, v63, v151
    v_cmp_eq_u32 vcc, -1, v63
    s_cbranch_vccnz RT85
    s_branch CD86
PL89:
    buffer_store_dwordx4 v[64:67], v1, s[28:31], s81 offen sc0 sc1
    s_branch PE90
RT87:
    s_add_u32 s56, s56, 1
    s_cmp_gt_u32 s56, 200000
    s_cbranch_scc1 CD88
    buffer_load_dword v63, v15, s[28:31], s78 offen sc1
    s_waitcnt vmcnt(0)
    v_cmp_eq_u32 vcc, -1, v63
    s_cbranch_vccnz RT87
    s_add_u32 s76, s8, 114688
    buffer_load_dwordx4 v[152:155], v8, s[28:31], s76 offen offset:0 sc1
    s_add_u32 s76, s8, 114688
    buffer_load_dwordx4 v[156:159], v8, s[28:31], s76 offen offset:1024 sc1
    s_add_u32 s76, s8, 114688
    buffer_load_dwordx4 v[160:163], v8, s[28:31], s76 offen offset:2048 sc1
    s_add_u32 s76, s8, 114688
    buffer_load_dwordx4 v[164:167], v8, s[28:31], s76 offen offset:3072 sc1
    s_add_u32 s76, s8, 118784
    buffer_load_dwordx4 v[168:171], v8, s[28:31], s76 offen offset:0 sc1
    s_add_u32 s76, s8, 118784
    buffer_load_dwordx4 v[172:175], v8, s[28:31], s76 offen offset:1024 sc1
    s_add_u32 s76, s8, 118784
    buffer_load_dwordx4 v[176:179], v8, s[28:31], s76 offen offset:2048 sc1
    s_add_u32 s76, s8, 118784
    buffer_load_dwordx4 v[180:183], v8, s[28:31], s76 offen offset:3072 sc1
    s_add_u32 s76, s8, 122880
    buffer_load_dwordx4 v[184:187], v8, s[28:31], s76 offen offset:0 sc1
    s_add_u32 s76, s8, 122880
    buffer_load_dwordx4 v[188:191], v8, s[28:31], s76 offen offset:1024 sc1
    s_add_u32 s76, s8, 122880
    buffer_load_dwordx4 v[192:195], v8, s[28:31], s76 offen offset:2048 sc1
    s_add_u32 s76, s8, 122880
    buffer_load_dwordx4 v[196:199], v8, s[28:31], s76 offen offset:3072 sc1
    s_add_u32 s76, s8, 126976
    buffer_load_dwordx4 v[200:203], v8, s[28:31], s76 offen offset:0 sc1
    s_add_u32 s76, s8, 126976
    buffer_load_dwordx4 v[204:207], v8, s[28:31], s76 offen offset:1024 sc1
    s_add_u32 s76, s9, 114688
    buffer_load_dwordx4 v[208:211], v8, s[28:31], s76 offen offset:0 sc1
    s_add_u32 s76, s9, 114688
    buffer_load_dwordx4 v[212:215], v8, s[28:31], s76 offen offset:1024 sc1
    s_waitcnt vmcnt(12)
    v_max3_u32 v63, v155, v159, v163
    v_max_u32 v63, v63, v167
    v_cmp_eq_u32 vcc, -1, v63
    s_cbranch_vccnz RT87
    s_branch CD88
RT91:
    s_add_u32 s56, s56, 1
    s_cmp_gt_u32 s56, 200000
    s_cbranch_scc1 CD92
    s_waitcnt vmcnt(0)
    s_add_u32 s76, s8, 118784
    buffer_load_dwordx4 v[168:171], v8, s[28:31], s76 offen offset:0 sc1
    s_add_u32 s76, s8, 118784
    buffer_load_dwordx4 v[172:175], v8, s[28:31], s76 offen offset:1024 sc1
    s_add_u32 s76, s8, 118784
    buffer_load_dwordx4 v[176:179], v8, s[28:31], s76 offen offset:2048 sc1
    s_add_u32 s76, s8, 118784
    buffer_load_dwordx4 v[180:183], v8, s[28:31], s76 offen offset:3072 sc1
    s_waitcnt vmcnt(0)
    v_max3_u32 v63, v171, v175, v179
    v_max_u32 v63, v63, v183
    v_cmp_eq_u32 vcc, -1, v63
    s_cbranch_vccnz RT91
    s_branch CD92
RT93:
    s_add_u32 s56, s56, 1
    s_cmp_gt_u32 s56, 200000
    s_cbranch_scc1 CD94
    s_waitcnt vmcnt(0)
    s_add_u32 s76, s8, 122880
    buffer_load_dwordx4 v[184:187], v8, s[28:31], s76 offen offset:0 sc1
    s_add_u32 s76, s8, 122880
    buffer_load_dwordx4 v[188:191], v8, s[28:31], s76 offen offset:1024 sc1
    s_add_u32 s76, s8, 122880
    buffer_load_dwordx4 v[192:195], v8, s[28:31], s76 offen offset:2048 sc1
    s_add_u32 s76, s8, 122880
    buffer_load_dwordx4 v[196:199], v8, s[28:31], s76 offen offset:3072 sc1
    s_waitcnt vmcnt(0)
    v_max3_u32 v63, v187, v191, v195
    v_max_u32 v63, v63, v199
    v_cmp_eq_u32 vcc, -1, v63
    s_cbranch_vccnz RT93
    s_branch CD94
RT95:
    s_add_u32 s56, s56, 1
    s_cmp_gt_u32 s56, 200000
    s_cbranch_scc1 CD96
    s_waitcnt vmcnt(0)
    s_add_u32 s76, s8, 126976
    buffer_load_dwordx4 v[200:203], v8, s[28:31], s76 offen offset:0 sc1
    s_add_u32 s76, s8, 126976
    buffer_load_dwordx4 v[204:207], v8, s[28:31], s76 offen offset:1024 sc1
    s_add_u32 s76, s9, 114688
    buffer_load_dwordx4 v[208:211], v8, s[28:31], s76 offen offset:0 sc1
    s_add_u32 s76, s9, 114688
    buffer_load_dwordx4 v[212:215], v8, s[28:31], s76 offen offset:1024 sc1
    s_waitcnt vmcnt(0)
    v_max3_u32 v63, v203, v207, v211
    v_max_u32 v63, v63, v215
    v_cmp_eq_u32 vcc, -1, v63
    s_cbranch_vccnz RT95
    s_branch CD96
PL99:
    buffer_store_dword v48, v52, s[28:31], s4 offen offset:0 sc0 sc1
    s_branch PE100
RT97:
    s_add_u32 s56, s56, 1
    s_cmp_gt_u32 s56, 200000
    s_cbranch_scc1 CD98
    s_waitcnt vmcnt(0)
    s_add_u32 s76, s9, 114688
    buffer_load_dwordx4 v[128:131], v8, s[28:31], s76 offen offset:2048 sc1
    s_add_u32 s76, s9, 114688
    buffer_load_dwordx4 v[132:135], v8, s[28:31], s76 offen offset:3072 sc1
    s_add_u32 s76, s9, 118784
    buffer_load_dwordx4 v[136:139], v8, s[28:31], s76 offen offset:0 sc1
    s_add_u32 s76, s9, 118784
    buffer_load_dwordx4 v[140:143], v8, s[28:31], s76 offen offset:1024 sc1
    s_waitcnt vmcnt(0)
    v_max3_u32 v63, v131, v135, v139
    v_max_u32 v63, v63, v143
    v_cmp_eq_u32 vcc, -1, v63
    s_cbranch_vccnz RT97
    s_branch CD98
PL105:
    buffer_store_dwordx4 v[48:51], v1, s[28:31], s4 offen offset:0 sc0 sc1
    s_branch PE106
PL107:
    buffer_store_dwordx4 v[48:51], v1, s[28:31], s4 offen offset:0 sc0 sc1
    s_branch PE108
PL109:
    buffer_store_dwordx4 v[48:51], v1, s[28:31], s4 offen offset:0 sc0 sc1
    s_branch PE110
RT103:
    s_add_u32 s56, s56, 1
    s_cmp_gt_u32 s56, 200000
    s_cbranch_scc1 CD104
    s_waitcnt vmcnt(0)
    s_add_u32 s76, s9, 118784
    buffer_load_dwordx4 v[144:147], v8, s[28:31], s76 offen offset:2048 sc1
    s_add_u32 s76, s9, 118784
    buffer_load_dwordx4 v[148:151], v8, s[28:31], s76 offen offset:3072 sc1
    s_add_u32 s76, s9, 122880
    buffer_load_dwordx4 v[152:155], v8, s[28:31], s76 offen offset:0 sc1
    s_add_u32 s76, s9, 122880
    buffer_load_dwordx4 v[156:159], v8, s[28:31], s76 offen offset:1024 sc1
    s_waitcnt vmcnt(0)
    v_max3_u32 v63, v147, v151, v155
    v_max_u32 v63, v63, v159
    v_cmp_eq_u32 vcc, -1, v63
    s_cbranch_vccnz RT103
    s_branch CD104
PL113:
    buffer_store_dwordx4 v[48:51], v1, s[28:31], s4 offen offset:0 sc0 sc1
    s_branch PE114
RT111:
    s_add_u32 s56, s56, 1
    s_cmp_gt_u32 s56, 200000
    s_cbranch_scc1 CD112
    s_waitcnt vmcnt(0)
    s_add_u32 s76, s9, 122880
    buffer_load_dwordx4 v[160:163], v8, s[28:31], s76 offen offset:2048 sc1
    s_add_u32 s76, s9, 122880
    buffer_load_dwordx4 v[164:167], v8, s[28:31], s76 offen offset:3072 sc1
    s_add_u32 s76, s9, 126976
    buffer_load_dwordx4 v[168:171], v8, s[28:31], s76 offen offset:0 sc1
    s_add_u32 s76, s9, 126976
    buffer_load_dwordx4 v[172:175], v8, s[28:31], s76 offen offset:1024 sc1
    s_waitcnt vmcnt(0)
    v_max3_u32 v63, v163, v167, v171
    v_max_u32 v63, v63, v175
    v_cmp_eq_u32 vcc, -1, v63
    s_cbranch_vccnz RT111
    s_branch CD112
PL115:
    buffer_store_dwordx4 v[64:67], v1, s[28:31], s81 offen sc0 sc1
    s_branch PE116
RT101:
    s_add_u32 s56, s56, 1
    s_cmp_gt_u32 s56, 200000
    s_cbranch_scc1 CD102
    s_waitcnt vmcnt(0)
    s_add_u32 s81, s83, 4194304
    buffer_load_dwordx4 v[216:219], v1, s[28:31], s81 offen sc1
    s_waitcnt vmcnt(0)
    v_max_u32 v61, v217, v219
    v_cmp_eq_u32 vcc, -1, v61
    s_cbranch_vccnz RT101
    s_branch CD102
PL117:
    buffer_store_dwordx4 v[228:231], v1, s[28:31], s0 offen offset:0 sc0 sc1
    s_branch PE118
PL121:
    buffer_store_dwordx4 v[232:235], v1, s[28:31], s0 offen offset:2048 sc0 sc1
    s_branch PE122
PL123:
    buffer_store_dword v192, v61, s[28:31], s81 offen sc0 sc1
    s_branch PE124
RT125:
    s_add_u32 s56, s56, 1
    s_cmp_gt_u32 s56, 200000
    s_cbranch_scc1 CD126
    buffer_load_dword v63, v8, s[28:31], s80 offen sc1
    s_waitcnt vmcnt(0)
    v_cmp_eq_u32 vcc, -1, v63
    s_cbranch_vccnz RT125
    s_add_u32 s76, s80, 0
    buffer_load_dwordx4 v[128:131], v1, s[28:31], s76 offen offset:0 sc1
    s_add_u32 s76, s80, 0
    buffer_load_dwordx4 v[132:135], v1, s[28:31], s76 offen offset:1024 sc1
    s_add_u32 s76, s80, 4096
    buffer_load_dwordx4 v[136:139], v1, s[28:31], s76 offen offset:0 sc1
    s_add_u32 s76, s80, 4096
    buffer_load_dwordx4 v[140:143], v1, s[28:31], s76 offen offset:1024 sc1
    s_add_u32 s76, s80, 8192
    buffer_load_dwordx4 v[144:147], v1, s[28:31], s76 offen offset:0 sc1
    s_add_u32 s76, s80, 8192
    buffer_load_dwordx4 v[148:151], v1, s[28:31], s76 offen offset:1024 sc1
    s_add_u32 s76, s80, 12288
    buffer_load_dwordx4 v[152:155], v1, s[28:31], s76 offen offset:0 sc1
    s_add_u32 s76, s80, 12288
    buffer_load_dwordx4 v[156:159], v1, s[28:31], s76 offen offset:1024 sc1
    s_add_u32 s76, s80, 16384
    buffer_load_dwordx4 v[160:163], v1, s[28:31], s76 offen offset:0 sc1
    s_add_u32 s76, s80, 16384
    buffer_load_dwordx4 v[164:167], v1, s[28:31], s76 offen offset:1024 sc1
    s_add_u32 s76, s80, 20480
    buffer_load_dwordx4 v[168:171], v1, s[28:31], s76 offen offset:0 sc1
    s_add_u32 s76, s80, 20480
    buffer_load_dwordx4 v[172:175], v1, s[28:31], s76 offen offset:1024 sc1
    s_add_u32 s76, s80, 24576
    buffer_load_dwordx4 v[176:179], v1, s[28:31], s76 offen offset:0 sc1
    s_add_u32 s76, s80, 24576
    buffer_load_dwordx4 v[180:183], v1, s[28:31], s76 offen offset:1024 sc1
    s_waitcnt vmcnt(10)
    v_max3_u32 v63, v131, v135, v139
    v_max_u32 v63, v63, v143
    v_cmp_eq_u32 vcc, -1, v63
    s_cbranch_vccnz RT125
    s_branch CD126
RT127:
    s_add_u32 s56, s56, 1
    s_cmp_gt_u32 s56, 200000
    s_cbranch_scc1 CD128
    buffer_load_dword v63, v8, s[28:31], s80 offen sc1
    s_waitcnt vmcnt(0)
    v_cmp_eq_u32 vcc, -1, v63
    s_cbranch_vccnz RT127
    s_add_u32 s76, s80, 8192
    buffer_load_dwordx4 v[144:147], v1, s[28:31], s76 offen offset:0 sc1
    s_add_u32 s76, s80, 8192
    buffer_load_dwordx4 v[148:151], v1, s[28:31], s76 offen offset:1024 sc1
    s_add_u32 s76, s80, 12288
    buffer_load_dwordx4 v[152:155], v1, s[28:31], s76 offen offset:0 sc1
    s_add_u32 s76, s80, 12288
    buffer_load_dwordx4 v[156:159], v1, s[28:31], s76 offen offset:1024 sc1
    s_add_u32 s76, s80, 16384
    buffer_load_dwordx4 v[160:163], v1, s[28:31], s76 offen offset:0 sc1
    s_add_u32 s76, s80, 16384
    buffer_load_dwordx4 v[164:167], v1, s[28:31], s76 offen offset:1024 sc1
    s_add_u32 s76, s80, 20480
    buffer_load_dwordx4 v[168:171], v1, s[28:31], s76 offen offset:0 sc1
    s_add_u32 s76, s80, 20480
    buffer_load_dwordx4 v[172:175], v1, s[28:31], s76 offen offset:1024 sc1
    s_add_u32 s76, s80, 24576
    buffer_load_dwordx4 v[176:179], v1, s[28:31], s76 offen offset:0 sc1
    s_add_u32 s76, s80, 24576
    buffer_load_dwordx4 v[180:183], v1, s[28:31], s76 offen offset:1024 sc1
    s_waitcnt vmcnt(6)
    v_max3_u32 v63, v147, v151, v155
    v_max_u32 v63, v63, v159
    v_cmp_eq_u32 vcc, -1, v63
    s_cbranch_vccnz RT127
    s_branch CD128
RT129:
    s_add_u32 s56, s56, 1
    s_cmp_gt_u32 s56, 200000
    s_cbranch_scc1 CD130
    buffer_load_dword v63, v8, s[28:31], s80 offen sc1
    s_waitcnt vmcnt(0)
    v_cmp_eq_u32 vcc, -1, v63
    s_cbranch_vccnz RT129
    s_add_u32 s76, s80, 16384
    buffer_load_dwordx4 v[160:163], v1, s[28:31], s76 offen offset:0 sc1
    s_add_u32 s76, s80, 16384
    buffer_load_dwordx4 v[164:167], v1, s[28:31], s76 offen offset:1024 sc1
    s_add_u32 s76, s80, 20480
    buffer_load_dwordx4 v[168:171], v1, s[28:31], s76 offen offset:0 sc1
    s_add_u32 s76, s80, 20480
    buffer_load_dwordx4 v[172:175], v1, s[28:31], s76 offen offset:1024 sc1
    s_add_u32 s76, s80, 24576
    buffer_load_dwordx4 v[176:179], v1, s[28:31], s76 offen offset:0 sc1
    s_add_u32 s76, s80, 24576
    buffer_load_dwordx4 v[180:183], v1, s[28:31], s76 offen offset:1024 sc1
    s_waitcnt vmcnt(2)
    v_max3_u32 v63, v163, v167, v171
    v_max_u32 v63, v63, v175
    v_cmp_eq_u32 vcc, -1, v63
    s_cbranch_vccnz RT129
    s_branch CD130
RT131:
    s_add_u32 s56, s56, 1
    s_cmp_gt_u32 s56, 200000
    s_cbranch_scc1 CD132
    buffer_load_dword v63, v8, s[28:31], s80 offen sc1
    s_waitcnt vmcnt(0)
    v_cmp_eq_u32 vcc, -1, v63
    s_cbranch_vccnz RT131
    s_add_u32 s76, s80, 24576
    buffer_load_dwordx4 v[176:179], v1, s[28:31], s76 offen offset:0 sc1
    s_add_u32 s76, s80, 24576
    buffer_load_dwordx4 v[180:183], v1, s[28:31], s76 offen offset:1024 sc1
    s_waitcnt vmcnt(0)
    v_max_u32 v63, v179, v183
    v_cmp_eq_u32 vcc, -1, v63
    s_cbranch_vccnz RT131
    s_branch CD132
RT133:
    s_add_u32 s56, s56, 1
    s_cmp_gt_u32 s56, 200000
    s_cbranch_scc1 CD134
    buffer_load_dword v63, v8, s[28:31], s80 offen sc1
    s_waitcnt vmcnt(0)
    v_cmp_eq_u32 vcc, -1, v63
    s_cbranch_vccnz RT133
    s_add_u32 s76, s80, 0
    buffer_load_dwordx4 v[184:187], v1, s[28:31], s76 offen offset:2048 sc1
    s_add_u32 s76, s80, 0
    buffer_load_dwordx4 v[188:191], v1, s[28:31], s76 offen offset:3072 sc1
    s_add_u32 s76, s80, 4096
    buffer_load_dwordx4 v[192:195], v1, s[28:31], s76 offen offset:2048 sc1
    s_add_u32 s76, s80, 4096
    buffer_load_dwordx4 v[196:199], v1, s[28:31], s76 offen offset:3072 sc1
    s_add_u32 s76, s80, 8192
    buffer_load_dwordx4 v[200:203], v1, s[28:31], s76 offen offset:2048 sc1
    s_add_u32 s76, s80, 8192
    buffer_load_dwordx4 v[204:207], v1, s[28:31], s76 offen offset:3072 sc1
    s_add_u32 s76, s80, 12288
    buffer_load_dwordx4 v[208:211], v1, s[28:31], s76 offen offset:2048 sc1
    s_add_u32 s76, s80, 12288
    buffer_load_dwordx4 v[212:215], v1, s[28:31], s76 offen offset:3072 sc1
    s_add_u32 s76, s80, 16384
    buffer_load_dwordx4 v[216:219], v1, s[28:31], s76 offen offset:2048 sc1
    s_add_u32 s76, s80, 16384
    buffer_load_dwordx4 v[220:223], v1, s[28:31], s76 offen offset:3072 sc1
    s_add_u32 s76, s80, 20480
    buffer_load_dwordx4 v[224:227], v1, s[28:31], s76 offen offset:2048 sc1
    s_add_u32 s76, s80, 20480
    buffer_load_dwordx4 v[228:231], v1, s[28:31], s76 offen offset:3072 sc1
    s_add_u32 s76, s80, 24576
    buffer_load_dwordx4 v[232:235], v1, s[28:31], s76 offen offset:2048 sc1
    s_add_u32 s76, s80, 24576
    buffer_load_dwordx4 v[236:239], v1, s[28:31], s76 offen offset:3072 sc1
    s_waitcnt vmcnt(10)
    v_max3_u32 v63, v187, v191, v195
    v_max_u32 v63, v63, v199
    v_cmp_eq_u32 vcc, -1, v63
    s_cbranch_vccnz RT133
    s_branch CD134
RT135:
    s_add_u32 s56, s56, 1
    s_cmp_gt_u32 s56, 200000
    s_cbranch_scc1 CD136
    buffer_load_dword v63, v8, s[28:31], s80 offen sc1
    s_waitcnt vmcnt(0)
    v_cmp_eq_u32 vcc, -1, v63
    s_cbranch_vccnz RT135
    s_add_u32 s76, s80, 8192
    buffer_load_dwordx4 v[200:203], v1, s[28:31], s76 offen offset:2048 sc1
    s_add_u32 s76, s80, 8192
    buffer_load_dwordx4 v[204:207], v1, s[28:31], s76 offen offset:3072 sc1
    s_add_u32 s76, s80, 12288
    buffer_load_dwordx4 v[208:211], v1, s[28:31], s76 offen offset:2048 sc1
    s_add_u32 s76, s80, 12288
    buffer_load_dwordx4 v[212:215], v1, s[28:31], s76 offen offset:3072 sc1
    s_add_u32 s76, s80, 16384
    buffer_load_dwordx4 v[216:219], v1, s[28:31], s76 offen offset:2048 sc1
    s_add_u32 s76, s80, 16384
    buffer_load_dwordx4 v[220:223], v1, s[28:31], s76 offen offset:3072 sc1
    s_add_u32 s76, s80, 20480
    buffer_load_dwordx4 v[224:227], v1, s[28:31], s76 offen offset:2048 sc1
    s_add_u32 s76, s80, 20480
    buffer_load_dwordx4 v[228:231], v1, s[28:31], s76 offen offset:3072 sc1
    s_add_u32 s76, s80, 24576
    buffer_load_dwordx4 v[232:235], v1, s[28:31], s76 offen offset:2048 sc1
    s_add_u32 s76, s80, 24576
    buffer_load_dwordx4 v[236:239], v1, s[28:31], s76 offen offset:3072 sc1
    s_waitcnt vmcnt(6)
    v_max3_u32 v63, v203, v207, v211
    v_max_u32 v63, v63, v215
    v_cmp_eq_u32 vcc, -1, v63
    s_cbranch_vccnz RT135
    s_branch CD136
RT137:
    s_add_u32 s56, s56, 1
    s_cmp_gt_u32 s56, 200000
    s_cbranch_scc1 CD138
    s_waitcnt vmcnt(0)
    buffer_load_dwordx2 v[240:241], v2, s[28:31], s81 offen offset:0 sc1
    buffer_load_dwordx2 v[242:243], v2, s[28:31], s81 offen offset:512 sc1
    buffer_load_dwordx2 v[244:245], v2, s[28:31], s81 offen offset:1024 sc1
    buffer_load_dwordx2 v[246:247], v2, s[28:31], s81 offen offset:1536 sc1
    buffer_load_dwordx2 v[248:249], v2, s[28:31], s81 offen offset:2048 sc1
    buffer_load_dwordx2 v[250:251], v2, s[28:31], s81 offen offset:2560 sc1
    buffer_load_dwordx2 v[252:253], v2, s[28:31], s81 offen offset:3072 sc1
    s_waitcnt vmcnt(0)
    v_max3_u32 v62, v240, v241, v242
    v_max3_u32 v62, v62, v243, v244
    v_max3_u32 v62, v62, v245, v246
    v_max3_u32 v62, v62, v247, v248
    v_max3_u32 v62, v62, v249, v250
    v_max3_u32 v62, v62, v251, v252
    v_max_u32 v62, v62, v253
    v_cmp_eq_u32 vcc, -1, v62
    s_cbranch_vccnz RT137
    s_branch CD138
RT139:
    s_add_u32 s56, s56, 1
    s_cmp_gt_u32 s56, 200000
    s_cbranch_scc1 CD140
    buffer_load_dword v63, v8, s[28:31], s80 offen sc1
    s_waitcnt vmcnt(0)
    v_cmp_eq_u32 vcc, -1, v63
    s_cbranch_vccnz RT139
    s_add_u32 s76, s80, 16384
    buffer_load_dwordx4 v[216:219], v1, s[28:31], s76 offen offset:2048 sc1
    s_add_u32 s76, s80, 16384
    buffer_load_dwordx4 v[220:223], v1, s[28:31], s76 offen offset:3072 sc1
    s_add_u32 s76, s80, 20480
    buffer_load_dwordx4 v[224:227], v1, s[28:31], s76 offen offset:2048 sc1
    s_add_u32 s76, s80, 20480
    buffer_load_dwordx4 v[228:231], v1, s[28:31], s76 offen offset:3072 sc1
    s_add_u32 s76, s80, 24576
    buffer_load_dwordx4 v[232:235], v1, s[28:31], s76 offen offset:2048 sc1
    s_add_u32 s76, s80, 24576
    buffer_load_dwordx4 v[236:239], v1, s[28:31], s76 offen offset:3072 sc1
    s_waitcnt vmcnt(2)
    v_max3_u32 v63, v219, v223, v227
    v_max_u32 v63, v63, v231
    v_cmp_eq_u32 vcc, -1, v63
    s_cbranch_vccnz RT139
    s_branch CD140
RT141:
    s_add_u32 s56, s56, 1
    s_cmp_gt_u32 s56, 200000
    s_cbranch_scc1 CD142
    buffer_load_dword v63, v8, s[28:31], s80 offen sc1
    s_waitcnt vmcnt(0)
    v_cmp_eq_u32 vcc, -1, v63
    s_cbranch_vccnz RT141
    s_add_u32 s76, s80, 24576
    buffer_load_dwordx4 v[232:235], v1, s[28:31], s76 offen offset:2048 sc1
    s_add_u32 s76, s80, 24576
    buffer_load_dwordx4 v[236:239], v1, s[28:31], s76 offen offset:3072 sc1
    s_waitcnt vmcnt(0)
    v_max_u32 v63, v235, v239
    v_cmp_eq_u32 vcc, -1, v63
    s_cbranch_vccnz RT141
    s_branch CD142
SR149:
    s_add_u32 s56, s56, 1
    s_cmp_gt_u32 s56, 200000
    s_cbranch_scc1 SR149x
    buffer_load_dword v63, v89, s[28:31], s80 offen sc1
    s_waitcnt vmcnt(0)
    v_cmp_eq_u32 vcc, -1, v63
    s_cbranch_vccnz SR149
    s_add_u32 s76, s80, 0
    buffer_load_dwordx2 v[128:129], v2, s[28:31], s76 offen offset:0 sc1
    buffer_load_dwordx2 v[130:131], v2, s[28:31], s76 offen offset:2048 sc1
    s_add_u32 s76, s80, 4096
    buffer_load_dwordx2 v[132:133], v2, s[28:31], s76 offen offset:0 sc1
    buffer_load_dwordx2 v[134:135], v2, s[28:31], s76 offen offset:2048 sc1
    s_add_u32 s76, s80, 8192
    buffer_load_dwordx2 v[136:137], v2, s[28:31], s76 offen offset:0 sc1
    buffer_load_dwordx2 v[138:139], v2, s[28:31], s76 offen offset:2048 sc1
    s_add_u32 s76, s80, 12288
    buffer_load_dwordx2 v[140:141], v2, s[28:31], s76 offen offset:0 sc1
    buffer_load_dwordx2 v[142:143], v2, s[28:31], s76 offen offset:2048 sc1
    s_add_u32 s76, s80, 16384
    buffer_load_dwordx2 v[144:145], v2, s[28:31], s76 offen offset:0 sc1
    buffer_load_dwordx2 v[146:147], v2, s[28:31], s76 offen offset:2048 sc1
    s_add_u32 s76, s80, 20480
    buffer_load_dwordx2 v[148:149], v2, s[28:31], s76 offen offset:0 sc1
    buffer_load_dwordx2 v[150:151], v2, s[28:31], s76 offen offset:2048 sc1
    s_add_u32 s76, s80, 24576
    buffer_load_dwordx2 v[152:153], v2, s[28:31], s76 offen offset:0 sc1
    buffer_load_dwordx2 v[154:155], v2, s[28:31], s76 offen offset:2048 sc1
    s_add_u32 s76, s80, 28672
    buffer_load_dwordx2 v[156:157], v2, s[28:31], s76 offen offset:0 sc1
    buffer_load_dwordx2 v[158:159], v2, s[28:31], s76 offen offset:2048 sc1
    s_waitcnt vmcnt(0)
    s_branch SU148
PL150:
    buffer_store_dwordx4 v[48:51], v1, s[28:31], s81 offen sc0 sc1
    buffer_store_dwordx4 v[52:55], v1, s[28:31], s81 offen offset:1024 sc0 sc1
    s_branch PE151
RT152:
    s_add_u32 s56, s56, 1
    s_cmp_gt_u32 s56, 200000
    s_cbranch_scc1 CD153
    buffer_load_dword v63, v14, s[28:31], s80 offen sc1
    s_waitcnt vmcnt(0)
    v_cmp_eq_u32 vcc, -1, v63
    s_cbranch_vccnz RT152
    s_add_u32 s76, s7, 0
    buffer_load_dwordx4 v[160:163], v1, s[28:31], s76 offen offset:0 sc1
    buffer_load_dwordx4 v[164:167], v1, s[28:31], s76 offen offset:1024 sc1
    buffer_load_dwordx4 v[168:171], v1, s[28:31], s76 offen offset:2048 sc1
    buffer_load_dwordx4 v[172:175], v1, s[28:31], s76 offen offset:3072 sc1
    s_add_u32 s76, s7, 4096
    buffer_load_dwordx4 v[176:179], v1, s[28:31], s76 offen offset:0 sc1
    buffer_load_dwordx4 v[180:183], v1, s[28:31], s76 offen offset:1024 sc1
    buffer_load_dwordx4 v[184:187], v1, s[28:31], s76 offen offset:2048 sc1
    buffer_load_dwordx4 v[188:191], v1, s[28:31], s76 offen offset:3072 sc1
    s_add_u32 s76, s6, 0
    buffer_load_dwordx4 v[128:131], v1, s[28:31], s76 offen offset:0 sc1
    buffer_load_dwordx4 v[132:135], v1, s[28:31], s76 offen offset:1024 sc1
    buffer_load_dwordx4 v[136:139], v1, s[28:31], s76 offen offset:2048 sc1
    buffer_load_dwordx4 v[140:143], v1, s[28:31], s76 offen offset:3072 sc1
    s_add_u32 s76, s6, 4096
    buffer_load_dwordx4 v[144:147], v1, s[28:31], s76 offen offset:0 sc1
    buffer_load_dwordx4 v[148:151], v1, s[28:31], s76 offen offset:1024 sc1
    buffer_load_dwordx4 v[152:155], v1, s[28:31], s76 offen offset:2048 sc1
    buffer_load_dwordx4 v[156:159], v1, s[28:31], s76 offen offset:3072 sc1
    s_waitcnt vmcnt(8)
    v_max3_u32 v63, v163, v167, v171
    v_max3_u32 v63, v63, v175, v179
    v_max3_u32 v63, v63, v183, v187
    v_max_u32 v63, v63, v191
    v_cmp_eq_u32 vcc, -1, v63
    s_cbranch_vccnz RT152
    s_branch CD153
RT154:
    s_add_u32 s56, s56, 1
    s_cmp_gt_u32 s56, 200000
    s_cbranch_scc1 CD155
    s_waitcnt vmcnt(0)
    s_add_u32 s76, s6, 0
    buffer_load_dwordx4 v[128:131], v1, s[28:31], s76 offen offset:0 sc1
    buffer_load_dwordx4 v[132:135], v1, s[28:31], s76 offen offset:1024 sc1
    buffer_load_dwordx4 v[136:139], v1, s[28:31], s76 offen offset:2048 sc1
    buffer_load_dwordx4 v[140:143], v1, s[28:31], s76 offen offset:3072 sc1
    s_add_u32 s76, s6, 4096
    buffer_load_dwordx4 v[144:147], v1, s[28:31], s76 offen offset:0 sc1
    buffer_load_dwordx4 v[148:151], v1, s[28:31], s76 offen offset:1024 sc1
    buffer_load_dwordx4 v[152:155], v1, s[28:31], s76 offen offset:2048 sc1
    buffer_load_dwordx4 v[156:159], v1, s[28:31], s76 offen offset:3072 sc1
    s_waitcnt vmcnt(0)
    v_max3_u32 v63, v131, v135, v139
    v_max3_u32 v63, v63, v143, v147
    v_max3_u32 v63, v63, v151, v155
    v_max_u32 v63, v63, v159
    v_cmp_eq_u32 vcc, -1, v63
    s_cbranch_vccnz RT154
    s_branch CD155
PL156:
    buffer_store_dword v128, v61, s[28:31], s81 offen sc0 sc1
    s_branch PE157
RT158:
    s_add_u32 s56, s56, 1
    s_cmp_gt_u32 s56, 200000
    s_cbranch_scc1 CD159
    s_waitcnt vmcnt(0)
    buffer_load_dwordx2 v[144:145], v62, s[28:31], s80 offen offset:0 sc1
    buffer_load_dwordx2 v[146:147], v62, s[28:31], s80 offen offset:512 sc1
    buffer_load_dwordx2 v[148:149], v62, s[28:31], s80 offen offset:1024 sc1
    buffer_load_dwordx2 v[150:151], v62, s[28:31], s80 offen offset:1536 sc1
    buffer_load_dwordx2 v[152:153], v62, s[28:31], s80 offen offset:2048 sc1
    buffer_load_dwordx2 v[154:155], v62, s[28:31], s80 offen offset:2560 sc1
    buffer_load_dwordx2 v[156:157], v62, s[28:31], s80 offen offset:3072 sc1
    s_waitcnt vmcnt(0)
    v_max3_u32 v63, v144, v145, v146
    v_max3_u32 v63, v63, v147, v148
    v_max3_u32 v63, v63, v149, v150
    v_max3_u32 v63, v63, v151, v152
    v_max3_u32 v63, v63, v153, v154
    v_max3_u32 v63, v63, v155, v156
    v_max_u32 v63, v63, v157
    v_cmp_eq_u32 vcc, -1, v63
    s_cbranch_vccnz RT158
    s_branch CD159
RT160:
    s_add_u32 s56, s56, 1
    s_cmp_gt_u32 s56, 200000
    s_cbranch_scc1 CD161
    buffer_load_dword v63, v14, s[28:31], s80 offen sc1
    s_waitcnt vmcnt(0)
    v_cmp_eq_u32 vcc, -1, v63
    s_cbranch_vccnz RT160
    v_mov_b32 v62, 0
    s_add_u32 s76, s6, 0
    buffer_load_dwordx4 v[128:131], v1, s[28:31], s76 offen offset:0 sc1
    s_add_u32 s76, s6, 0
    buffer_load_dwordx4 v[132:135], v1, s[28:31], s76 offen offset:1024 sc1
    s_add_u32 s76, s6, 0
    buffer_load_dwordx4 v[136:139], v1, s[28:31], s76 offen offset:2048 sc1
    s_add_u32 s76, s6, 0
    buffer_load_dwordx4 v[140:143], v1, s[28:31], s76 offen offset:3072 sc1
    s_add_u32 s76, s6, 4096
    buffer_load_dwordx4 v[144:147], v1, s[28:31], s76 offen offset:0 sc1
    s_add_u32 s76, s6, 4096
    buffer_load_dwordx4 v[148:151], v1, s[28:31], s76 offen offset:1024 sc1
    s_add_u32 s76, s6, 4096
    buffer_load_dwordx4 v[152:155], v1, s[28:31], s76 offen offset:2048 sc1
    s_add_u32 s76, s6, 4096
    buffer_load_dwordx4 v[156:159], v1, s[28:31], s76 offen offset:3072 sc1
    s_add_u32 s76, s6, 8192
    buffer_load_dwordx4 v[160:163], v1, s[28:31], s76 offen offset:0 sc1
    s_add_u32 s76, s6, 8192
    buffer_load_dwordx4 v[164:167], v1, s[28:31], s76 offen offset:1024 sc1
    s_add_u32 s76, s6, 8192
    buffer_load_dwordx4 v[168:171], v1, s[28:31], s76 offen offset:2048 sc1
    s_add_u32 s76, s6, 8192
    buffer_load_dwordx4 v[172:175], v1, s[28:31], s76 offen offset:3072 sc1
    s_add_u32 s76, s6, 12288
    buffer_load_dwordx4 v[176:179], v1, s[28:31], s76 offen offset:0 sc1
    s_add_u32 s76, s6, 12288
    buffer_load_dwordx4 v[180:183], v1, s[28:31], s76 offen offset:1024 sc1
    s_add_u32 s76, s6, 12288
    buffer_load_dwordx4 v[184:187], v1, s[28:31], s76 offen offset:2048 sc1
    s_add_u32 s76, s6, 12288
    buffer_load_dwordx4 v[188:191], v1, s[28:31], s76 offen offset:3072 sc1
    s_waitcnt vmcnt(12)
    v_max3_u32 v63, v131, v135, v139
    v_max3_u32 v63, v63, v143, v62
    v_cmp_eq_u32 vcc, -1, v63
    s_cbranch_vccnz RT160
    s_branch CD161
RT162:
    s_add_u32 s56, s56, 1
    s_cmp_gt_u32 s56, 200000
    s_cbranch_scc1 CD163
    s_waitcnt vmcnt(0)
    s_add_u32 s76, s6, 4096
    buffer_load_dwordx4 v[144:147], v1, s[28:31], s76 offen offset:0 sc1
    s_add_u32 s76, s6, 4096
    buffer_load_dwordx4 v[148:151], v1, s[28:31], s76 offen offset:1024 sc1
    s_add_u32 s76, s6, 4096
    buffer_load_dwordx4 v[152:155], v1, s[28:31], s76 offen offset:2048 sc1
    s_add_u32 s76, s6, 4096
    buffer_load_dwordx4 v[156:159], v1, s[28:31], s76 offen offset:3072 sc1
    s_waitcnt vmcnt(0)
    v_max3_u32 v63, v147, v151, v155
    v_max_u32 v63, v63, v159
    v_cmp_eq_u32 vcc, -1, v63
    s_cbranch_vccnz RT162
    s_branch CD163
RT164:
    s_add_u32 s56, s56, 1
    s_cmp_gt_u32 s56, 200000
    s_cbranch_scc1 CD165
    s_waitcnt vmcnt(0)
    s_add_u32 s76, s6, 8192
    buffer_load_dwordx4 v[160:163], v1, s[28:31], s76 offen offset:0 sc1
    s_add_u32 s76, s6, 8192
    buffer_load_dwordx4 v[164:167], v1, s[28:31], s76 offen offset:1024 sc1
    s_add_u32 s76, s6, 8192
    buffer_load_dwordx4 v[168:171], v1, s[28:31], s76 offen offset:2048 sc1
    s_add_u32 s76, s6, 8192
    buffer_load_dwordx4 v[172:175], v1, s[28:31], s76 offen offset:3072 sc1
    s_waitcnt vmcnt(0)
    v_max3_u32 v63, v163, v167, v171
    v_max_u32 v63, v63, v175
    v_cmp_eq_u32 vcc, -1, v63
    s_cbranch_vccnz RT164
    s_branch CD165
RT166:
    s_add_u32 s56, s56, 1
    s_cmp_gt_u32 s56, 200000
    s_cbranch_scc1 CD167
    s_waitcnt vmcnt(0)
    s_add_u32 s76, s6, 12288
    buffer_load_dwordx4 v[176:179], v1, s[28:31], s76 offen offset:0 sc1
    s_add_u32 s76, s6, 12288
    buffer_load_dwordx4 v[180:183], v1, s[28:31], s76 offen offset:1024 sc1
    s_add_u32 s76, s6, 12288
    buffer_load_dwordx4 v[184:187], v1, s[28:31], s76 offen offset:2048 sc1
    s_add_u32 s76, s6, 12288
    buffer_load_dwordx4 v[188:191], v1, s[28:31], s76 offen offset:3072 sc1
    s_waitcnt vmcnt(0)
    v_max3_u32 v63, v179, v183, v187
    v_max_u32 v63, v63, v191
    v_cmp_eq_u32 vcc, -1, v63
    s_cbranch_vccnz RT166
    s_branch CD167
RT168:
    s_add_u32 s56, s56, 1
    s_cmp_gt_u32 s56, 200000
    s_cbranch_scc1 CD169
    s_waitcnt vmcnt(0)
    s_add_u32 s76, s7, 0
    buffer_load_dwordx4 v[192:195], v1, s[28:31], s76 offen offset:0 sc1
    s_add_u32 s76, s7, 0
    buffer_load_dwordx4 v[196:199], v1, s[28:31], s76 offen offset:1024 sc1
    s_add_u32 s76, s7, 0
    buffer_load_dwordx4 v[200:203], v1, s[28:31], s76 offen offset:2048 sc1
    s_add_u32 s76, s7, 0
    buffer_load_dwordx4 v[204:207], v1, s[28:31], s76 offen offset:3072 sc1
    s_waitcnt vmcnt(0)
    v_max3_u32 v63, v195, v199, v203
    v_max_u32 v63, v63, v207
    v_cmp_eq_u32 vcc, -1, v63
    s_cbranch_vccnz RT168
    s_branch CD169
RT170:
    s_add_u32 s56, s56, 1
    s_cmp_gt_u32 s56, 200000
    s_cbranch_scc1 CD171
    s_waitcnt vmcnt(0)
    s_add_u32 s76, s7, 4096
    buffer_load_dwordx4 v[208:211], v1, s[28:31], s76 offen offset:0 sc1
    s_add_u32 s76, s7, 4096
    buffer_load_dwordx4 v[212:215], v1, s[28:31], s76 offen offset:1024 sc1
    s_add_u32 s76, s7, 4096
    buffer_load_dwordx4 v[128:131], v1, s[28:31], s76 offen offset:2048 sc1
    s_add_u32 s76, s7, 4096
    buffer_load_dwordx4 v[132:135], v1, s[28:31], s76 offen offset:3072 sc1
    s_waitcnt vmcnt(0)
    v_max3_u32 v63, v211, v215, v131
    v_max_u32 v63, v63, v135
    v_cmp_eq_u32 vcc, -1, v63
    s_cbranch_vccnz RT170
    s_branch CD171
RT172:
    s_add_u32 s56, s56, 1
    s_cmp_gt_u32 s56, 200000
    s_cbranch_scc1 CD173
    s_waitcnt vmcnt(0)
    s_add_u32 s76, s7, 8192
    buffer_load_dwordx4 v[136:139], v1, s[28:31], s76 offen offset:0 sc1
    s_add_u32 s76, s7, 8192
    buffer_load_dwordx4 v[140:143], v1, s[28:31], s76 offen offset:1024 sc1
    s_add_u32 s76, s7, 8192
    buffer_load_dwordx4 v[144:147], v1, s[28:31], s76 offen offset:2048 sc1
    s_add_u32 s76, s7, 8192
    buffer_load_dwordx4 v[148:151], v1, s[28:31], s76 offen offset:3072 sc1
    s_waitcnt vmcnt(0)
    v_max3_u32 v63, v139, v143, v147
    v_max_u32 v63, v63, v151
    v_cmp_eq_u32 vcc, -1, v63
    s_cbranch_vccnz RT172
    s_branch CD173
RT174:
    s_add_u32 s56, s56, 1
    s_cmp_gt_u32 s56, 200000
    s_cbranch_scc1 CD175
    s_waitcnt vmcnt(0)
    s_add_u32 s76, s7, 12288
    buffer_load_dwordx4 v[152:155], v1, s[28:31], s76 offen offset:0 sc1
    s_add_u32 s76, s7, 12288
    buffer_load_dwordx4 v[156:159], v1, s[28:31], s76 offen offset:1024 sc1
    s_add_u32 s76, s7, 12288
    buffer_load_dwordx4 v[160:163], v1, s[28:31], s76 offen offset:2048 sc1
    s_add_u32 s76, s7, 12288
    buffer_load_dwordx4 v[164:167], v1, s[28:31], s76 offen offset:3072 sc1
    s_waitcnt vmcnt(0)
    v_max3_u32 v63, v155, v159, v163
    v_max_u32 v63, v63, v167
    v_cmp_eq_u32 vcc, -1, v63
    s_cbranch_vccnz RT174
    s_branch CD175
PL178:
    buffer_store_dwordx4 v[64:67], v1, s[28:31], s81 offen sc0 sc1
    s_branch PE179
RT176:
    s_add_u32 s56, s56, 1
    s_cmp_gt_u32 s56, 200000
    s_cbranch_scc1 CD177
    s_waitcnt vmcnt(0)
    s_add_u32 s76, s6, 131072
    buffer_load_dwordx4 v[168:171], v1, s[28:31], s76 offen offset:0 sc1
    s_add_u32 s76, s6, 131072
    buffer_load_dwordx4 v[172:175], v1, s[28:31], s76 offen offset:1024 sc1
    s_add_u32 s76, s6, 131072
    buffer_load_dwordx4 v[176:179], v1, s[28:31], s76 offen offset:2048 sc1
    s_add_u32 s76, s6, 131072
    buffer_load_dwordx4 v[180:183], v1, s[28:31], s76 offen offset:3072 sc1
    s_waitcnt vmcnt(0)
    v_max3_u32 v63, v171, v175, v179
    v_max_u32 v63, v63, v183
    v_cmp_eq_u32 vcc, -1, v63
    s_cbranch_vccnz RT176
    s_branch CD177
RT180:
    s_add_u32 s56, s56, 1
    s_cmp_gt_u32 s56, 200000
    s_cbranch_scc1 CD181
    s_waitcnt vmcnt(0)
    s_add_u32 s76, s6, 135168
    buffer_load_dwordx4 v[184:187], v1, s[28:31], s76 offen offset:0 sc1
    s_add_u32 s76, s6, 135168
    buffer_load_dwordx4 v[188:191], v1, s[28:31], s76 offen offset:1024 sc1
    s_add_u32 s76, s6, 135168
    buffer_load_dwordx4 v[192:195], v1, s[28:31], s76 offen offset:2048 sc1
    s_add_u32 s76, s6, 135168
    buffer_load_dwordx4 v[196:199], v1, s[28:31], s76 offen offset:3072 sc1
    s_waitcnt vmcnt(0)
    v_max3_u32 v63, v187, v191, v195
    v_max_u32 v63, v63, v199
    v_cmp_eq_u32 vcc, -1, v63
    s_cbranch_vccnz RT180
    s_branch CD181
RT184:
    s_add_u32 s56, s56, 1
    s_cmp_gt_u32 s56, 200000
    s_cbranch_scc1 CD185
    s_waitcnt vmcnt(0)
    s_add_u32 s76, s6, 139264
    buffer_load_dwordx4 v[200:203], v1, s[28:31], s76 offen offset:0 sc1
    s_add_u32 s76, s6, 139264
    buffer_load_dwordx4 v[204:207], v1, s[28:31], s76 offen offset:1024 sc1
    s_add_u32 s76, s6, 139264
    buffer_load_dwordx4 v[208:211], v1, s[28:31], s76 offen offset:2048 sc1
    s_add_u32 s76, s6, 139264
    buffer_load_dwordx4 v[212:215], v1, s[28:31], s76 offen offset:3072 sc1
    s_waitcnt vmcnt(0)
    v_max3_u32 v63, v203, v207, v211
    v_max_u32 v63, v63, v215
    v_cmp_eq_u32 vcc, -1, v63
    s_cbranch_vccnz RT184
    s_branch CD185
RT186:
    s_add_u32 s56, s56, 1
    s_cmp_gt_u32 s56, 200000
    s_cbranch_scc1 CD187
    s_waitcnt vmcnt(0)
    s_add_u32 s76, s6, 143360
    buffer_load_dwordx4 v[128:131], v1, s[28:31], s76 offen offset:0 sc1
    s_add_u32 s76, s6, 143360
    buffer_load_dwordx4 v[132:135], v1, s[28:31], s76 offen offset:1024 sc1
    s_add_u32 s76, s6, 143360
    buffer_load_dwordx4 v[136:139], v1, s[28:31], s76 offen offset:2048 sc1
    s_add_u32 s76, s6, 143360
    buffer_load_dwordx4 v[140:143], v1, s[28:31], s76 offen offset:3072 sc1
    s_waitcnt vmcnt(0)
    v_max3_u32 v63, v131, v135, v139
    v_max_u32 v63, v63, v143
    v_cmp_eq_u32 vcc, -1, v63
    s_cbranch_vccnz RT186
    s_branch CD187
RT182:
    s_add_u32 s56, s56, 1
    s_cmp_gt_u32 s56, 200000
    s_cbranch_scc1 CD183
    s_waitcnt vmcnt(0)
    s_add_u32 s81, s82, 8388608
    buffer_load_dwordx4 v[216:219], v1, s[28:31], s81 offen sc1
    s_waitcnt vmcnt(0)
    v_max_u32 v61, v217, v219
    v_cmp_eq_u32 vcc, -1, v61
    s_cbranch_vccnz RT182
    s_branch CD183
RT188:
    s_add_u32 s56, s56, 1
    s_cmp_gt_u32 s56, 200000
    s_cbranch_scc1 CD189
    s_waitcnt vmcnt(0)
    s_add_u32 s76, s7, 131072
    buffer_load_dwordx4 v[144:147], v1, s[28:31], s76 offen offset:0 sc1
    s_add_u32 s76, s7, 131072
    buffer_load_dwordx4 v[148:151], v1, s[28:31], s76 offen offset:1024 sc1
    s_add_u32 s76, s7, 131072
    buffer_load_dwordx4 v[152:155], v1, s[28:31], s76 offen offset:2048 sc1
    s_add_u32 s76, s7, 131072
    buffer_load_dwordx4 v[156:159], v1, s[28:31], s76 offen offset:3072 sc1
    s_waitcnt vmcnt(0)
    v_max3_u32 v63, v147, v151, v155
    v_max_u32 v63, v63, v159
    v_cmp_eq_u32 vcc, -1, v63
    s_cbranch_vccnz RT188
    s_branch CD189
RT190:
    s_add_u32 s56, s56, 1
    s_cmp_gt_u32 s56, 200000
    s_cbranch_scc1 CD191
    s_waitcnt vmcnt(0)
    s_add_u32 s76, s7, 135168
    buffer_load_dwordx4 v[160:163], v1, s[28:31], s76 offen offset:0 sc1
    s_add_u32 s76, s7, 135168
    buffer_load_dwordx4 v[164:167], v1, s[28:31], s76 offen offset:1024 sc1
    s_add_u32 s76, s7, 135168
    buffer_load_dwordx4 v[168:171], v1, s[28:31], s76 offen offset:2048 sc1
    s_add_u32 s76, s7, 135168
    buffer_load_dwordx4 v[172:175], v1, s[28:31], s76 offen offset:3072 sc1
    s_waitcnt vmcnt(0)
    v_max3_u32 v63, v163, v167, v171
    v_max_u32 v63, v63, v175
    v_cmp_eq_u32 vcc, -1, v63
    s_cbranch_vccnz RT190
    s_branch CD191
RT192:
    s_add_u32 s56, s56, 1
    s_cmp_gt_u32 s56, 200000
    s_cbranch_scc1 CD193
    s_waitcnt vmcnt(0)
    s_add_u32 s76, s7, 139264
    buffer_load_dwordx4 v[176:179], v1, s[28:31], s76 offen offset:0 sc1
    s_add_u32 s76, s7, 139264
    buffer_load_dwordx4 v[180:183], v1, s[28:31], s76 offen offset:1024 sc1
    s_add_u32 s76, s7, 139264
    buffer_load_dwordx4 v[184:187], v1, s[28:31], s76 offen offset:2048 sc1
    s_add_u32 s76, s7, 139264
    buffer_load_dwordx4 v[188:191], v1, s[28:31], s76 offen offset:3072 sc1
    s_waitcnt vmcnt(0)
    v_max3_u32 v63, v179, v183, v187
    v_max_u32 v63, v63, v191
    v_cmp_eq_u32 vcc, -1, v63
    s_cbranch_vccnz RT192
    s_branch CD193
RT194:
    s_add_u32 s56, s56, 1
    s_cmp_gt_u32 s56, 200000
    s_cbranch_scc1 CD195
    s_waitcnt vmcnt(0)
    s_add_u32 s76, s7, 143360
    buffer_load_dwordx4 v[192:195], v1, s[28:31], s76 offen offset:0 sc1
    s_add_u32 s76, s7, 143360
    buffer_load_dwordx4 v[196:199], v1, s[28:31], s76 offen offset:1024 sc1
    s_add_u32 s76, s7, 143360
    buffer_load_dwordx4 v[200:203], v1, s[28:31], s76 offen offset:2048 sc1
    s_add_u32 s76, s7, 143360
    buffer_load_dwordx4 v[204:207], v1, s[28:31], s76 offen offset:3072 sc1
    s_waitcnt vmcnt(0)
    v_max3_u32 v63, v195, v199, v203
    v_max_u32 v63, v63, v207
    v_cmp_eq_u32 vcc, -1, v63
    s_cbranch_vccnz RT194
    s_branch CD195
PL196:
    buffer_store_dwordx4 v[64:67], v1, s[28:31], s81 offen sc0 sc1
    s_branch PE197
L_side1:
    s_waitcnt vmcnt(0)
    s_barrier
    v_and_b32 v60, 15, v0
    v_lshlrev_b32 v60, 11, v60
    s_lshl_b32 s3, s5, 15
    s_add_u32 s76, s3, 4194304
    buffer_load_dword v61, v60, s[28:31], s76 offen sc1
    s_waitcnt vmcnt(0)
PS200:
    v_cmp_eq_u32 vcc, -1, v61
    s_cbranch_vccz PK201
    s_sleep 8
    buffer_load_dword v61, v60, s[28:31], s76 offen sc1
    s_add_u32 s56, s56, 1
    s_cmp_gt_u32 s56, 200000
    s_waitcnt vmcnt(0)
    s_cbranch_scc0 PS200
PK201:
    v_lshlrev_b32 v60, 11, v0
    s_mov_b32 s76, 8126464
    buffer_load_dword v61, v60, s[28:31], s76 offen sc1
    s_waitcnt vmcnt(0)
PS202:
    v_cmp_eq_u32 vcc, -1, v61
    s_cbranch_vccz PK203
    s_sleep 8
    buffer_load_dword v61, v60, s[28:31], s76 offen sc1
    s_add_u32 s56, s56, 1
    s_cmp_gt_u32 s56, 200000
    s_waitcnt vmcnt(0)
    s_cbranch_scc0 PS202
PK203:
    s_and_b32 s3, s52, 1
    s_lshl_b32 s3, s3, 2
    s_add_u32 s3, s3, s48
    s_mul_i32 s4, s3, 14336
    s_add_u32 s4, s4, 11567104
    s_and_b32 s3, s52, 6
    s_mul_i32 s10, s3, 229376
    s_add_u32 s10, s10, s4
    s_cmp_eq_u32 s3, 6
    s_cselect_b32 s3, 1073741824, 0
    s_cselect_b32 s4, 0, 229376
    s_add_u32 s3, s3, s4
    s_add_u32 s4, s10, s3
    s_bitcmp1_b32 s52, 0
    s_cselect_b32 s8, s10, s4
    s_cselect_b32 s9, s4, s10
    v_and_b32 v15, 15, v0
    v_min_u32 v15, 13, v15
    v_lshlrev_b32 v15, 10, v15
    v_bfe_u32 v60, v0, 4, 1
    v_mul_lo_u32 v60, v60, s3
    v_add3_u32 v15, v15, v60, 4
    v_and_b32 v61, 31, v0
    v_lshrrev_b32 v60, 5, v0
    v_mul_u32_u24 v9, 896, v61
    v_lshl_add_u32 v9, v60, 4, v9
    buffer_load_dword v62, v15, s[28:31], s10 offen sc1
    s_waitcnt vmcnt(0)
PS204:
    v_cmp_eq_u32 vcc, -1, v62
    s_cbranch_vccz PK205
    s_sleep 4
    buffer_load_dword v62, v15, s[28:31], s10 offen sc1
    s_add_u32 s56, s56, 1
    s_cmp_gt_u32 s56, 200000
    s_waitcnt vmcnt(0)
    s_cbranch_scc0 PS204
PK205:
    s_add_u32 s77, s8, 0
    buffer_load_dwordx4 v[128:131], v8, s[28:31], s77 offen offset:0 sc1
    buffer_load_dwordx4 v[132:135], v8, s[28:31], s77 offen offset:1024 sc1
    buffer_load_dwordx4 v[136:139], v8, s[28:31], s77 offen offset:2048 sc1
    buffer_load_dwordx4 v[140:143], v8, s[28:31], s77 offen offset:3072 sc1
    s_add_u32 s77, s8, 4096
    buffer_load_dwordx4 v[144:147], v8, s[28:31], s77 offen offset:0 sc1
    buffer_load_dwordx4 v[148:151], v8, s[28:31], s77 offen offset:1024 sc1
    buffer_load_dwordx4 v[152:155], v8, s[28:31], s77 offen offset:2048 sc1
    buffer_load_dwordx4 v[156:159], v8, s[28:31], s77 offen offset:3072 sc1
    s_add_u32 s77, s8, 8192
    buffer_load_dwordx4 v[160:163], v8, s[28:31], s77 offen offset:0 sc1
    buffer_load_dwordx4 v[164:167], v8, s[28:31], s77 offen offset:1024 sc1
    buffer_load_dwordx4 v[168:171], v8, s[28:31], s77 offen offset:2048 sc1
    buffer_load_dwordx4 v[172:175], v8, s[28:31], s77 offen offset:3072 sc1
    s_add_u32 s77, s8, 12288
    buffer_load_dwordx4 v[176:179], v8, s[28:31], s77 offen offset:0 sc1
    buffer_load_dwordx4 v[180:183], v8, s[28:31], s77 offen offset:1024 sc1
    s_add_u32 s77, s9, 0
    buffer_load_dwordx4 v[184:187], v8, s[28:31], s77 offen offset:0 sc1
    buffer_load_dwordx4 v[188:191], v8, s[28:31], s77 offen offset:1024 sc1
    s_waitcnt vmcnt(0)
    s_branch L_p4_1
RT206:
    s_add_u32 s56, s56, 1
    s_cmp_gt_u32 s56, 200000
    s_cbranch_scc1 CD207
    buffer_load_dword v63, v15, s[28:31], s10 offen sc1
    s_waitcnt vmcnt(0)
    v_cmp_eq_u32 vcc, -1, v63
    s_cbranch_vccnz RT206
    v_mov_b32 v62, 0
    s_add_u32 s76, s8, 0
    buffer_load_dwordx4 v[128:131], v8, s[28:31], s76 offen offset:0 sc1
    s_add_u32 s76, s8, 0
    buffer_load_dwordx4 v[132:135], v8, s[28:31], s76 offen offset:1024 sc1
    s_add_u32 s76, s8, 0
    buffer_load_dwordx4 v[136:139], v8, s[28:31], s76 offen offset:2048 sc1
    s_add_u32 s76, s8, 0
    buffer_load_dwordx4 v[140:143], v8, s[28:31], s76 offen offset:3072 sc1
    s_add_u32 s76, s8, 4096
    buffer_load_dwordx4 v[144:147], v8, s[28:31], s76 offen offset:0 sc1
    s_add_u32 s76, s8, 4096
    buffer_load_dwordx4 v[148:151], v8, s[28:31], s76 offen offset:1024 sc1
    s_add_u32 s76, s8, 4096
    buffer_load_dwordx4 v[152:155], v8, s[28:31], s76 offen offset:2048 sc1
    s_add_u32 s76, s8, 4096
    buffer_load_dwordx4 v[156:159], v8, s[28:31], s76 offen offset:3072 sc1
    s_add_u32 s76, s8, 8192
    buffer_load_dwordx4 v[160:163], v8, s[28:31], s76 offen offset:0 sc1
    s_add_u32 s76, s8, 8192
    buffer_load_dwordx4 v[164:167], v8, s[28:31], s76 offen offset:1024 sc1
    s_add_u32 s76, s8, 8192
    buffer_load_dwordx4 v[168:171], v8, s[28:31], s76 offen offset:2048 sc1
    s_add_u32 s76, s8, 8192
    buffer_load_dwordx4 v[172:175], v8, s[28:31], s76 offen offset:3072 sc1
    s_add_u32 s76, s8, 12288
    buffer_load_dwordx4 v[176:179], v8, s[28:31], s76 offen offset:0 sc1
    s_add_u32 s76, s8, 12288
    buffer_load_dwordx4 v[180:183], v8, s[28:31], s76 offen offset:1024 sc1
    s_add_u32 s76, s9, 0
    buffer_load_dwordx4 v[184:187], v8, s[28:31], s76 offen offset:0 sc1
    s_add_u32 s76, s9, 0
    buffer_load_dwordx4 v[188:191], v8, s[28:31], s76 offen offset:1024 sc1
    s_waitcnt vmcnt(12)
    v_max3_u32 v63, v131, v135, v139
    v_max3_u32 v63, v63, v143, v62
    v_cmp_eq_u32 vcc, -1, v63
    s_cbranch_vccnz RT206
    s_branch CD207
RT208:
    s_add_u32 s56, s56, 1
    s_cmp_gt_u32 s56, 200000
    s_cbranch_scc1 CD209
    s_waitcnt vmcnt(0)
    s_add_u32 s76, s8, 4096
    buffer_load_dwordx4 v[144:147], v8, s[28:31], s76 offen offset:0 sc1
    s_add_u32 s76, s8, 4096
    buffer_load_dwordx4 v[148:151], v8, s[28:31], s76 offen offset:1024 sc1
    s_add_u32 s76, s8, 4096
    buffer_load_dwordx4 v[152:155], v8, s[28:31], s76 offen offset:2048 sc1
    s_add_u32 s76, s8, 4096
    buffer_load_dwordx4 v[156:159], v8, s[28:31], s76 offen offset:3072 sc1
    s_waitcnt vmcnt(0)
    v_max3_u32 v63, v147, v151, v155
    v_max_u32 v63, v63, v159
    v_cmp_eq_u32 vcc, -1, v63
    s_cbranch_vccnz RT208
    s_branch CD209
RT210:
    s_add_u32 s56, s56, 1
    s_cmp_gt_u32 s56, 200000
    s_cbranch_scc1 CD211
    s_waitcnt vmcnt(0)
    s_add_u32 s76, s8, 8192
    buffer_load_dwordx4 v[160:163], v8, s[28:31], s76 offen offset:0 sc1
    s_add_u32 s76, s8, 8192
    buffer_load_dwordx4 v[164:167], v8, s[28:31], s76 offen offset:1024 sc1
    s_add_u32 s76, s8, 8192
    buffer_load_dwordx4 v[168:171], v8, s[28:31], s76 offen offset:2048 sc1
    s_add_u32 s76, s8, 8192
    buffer_load_dwordx4 v[172:175], v8, s[28:31], s76 offen offset:3072 sc1
    s_waitcnt vmcnt(0)
    v_max3_u32 v63, v163, v167, v171
    v_max_u32 v63, v63, v175
    v_cmp_eq_u32 vcc, -1, v63
    s_cbranch_vccnz RT210
    s_branch CD211
RT212:
    s_add_u32 s56, s56, 1
    s_cmp_gt_u32 s56, 200000
    s_cbranch_scc1 CD213
    s_waitcnt vmcnt(0)
    s_add_u32 s76, s8, 12288
    buffer_load_dwordx4 v[176:179], v8, s[28:31], s76 offen offset:0 sc1
    s_add_u32 s76, s8, 12288
    buffer_load_dwordx4 v[180:183], v8, s[28:31], s76 offen offset:1024 sc1
    s_add_u32 s76, s9, 0
    buffer_load_dwordx4 v[184:187], v8, s[28:31], s76 offen offset:0 sc1
    s_add_u32 s76, s9, 0
    buffer_load_dwordx4 v[188:191], v8, s[28:31], s76 offen offset:1024 sc1
    s_waitcnt vmcnt(0)
    v_max3_u32 v63, v179, v183, v187
    v_max_u32 v63, v63, v191
    v_cmp_eq_u32 vcc, -1, v63
    s_cbranch_vccnz RT212
    s_branch CD213
RT214:
    s_add_u32 s56, s56, 1
    s_cmp_gt_u32 s56, 200000
    s_cbranch_scc1 CD215
    s_waitcnt vmcnt(0)
    s_add_u32 s76, s9, 0
    buffer_load_dwordx4 v[192:195], v8, s[28:31], s76 offen offset:2048 sc1
    s_add_u32 s76, s9, 0
    buffer_load_dwordx4 v[196:199], v8, s[28:31], s76 offen offset:3072 sc1
    s_add_u32 s76, s9, 4096
    buffer_load_dwordx4 v[200:203], v8, s[28:31], s76 offen offset:0 sc1
    s_add_u32 s76, s9, 4096
    buffer_load_dwordx4 v[204:207], v8, s[28:31], s76 offen offset:1024 sc1
    s_waitcnt vmcnt(0)
    v_max3_u32 v63, v195, v199, v203
    v_max_u32 v63, v63, v207
    v_cmp_eq_u32 vcc, -1, v63
    s_cbranch_vccnz RT214
    s_branch CD215
RT216:
    s_add_u32 s56, s56, 1
    s_cmp_gt_u32 s56, 200000
    s_cbranch_scc1 CD217
    s_waitcnt vmcnt(0)
    s_add_u32 s76, s9, 4096
    buffer_load_dwordx4 v[208:211], v8, s[28:31], s76 offen offset:2048 sc1
    s_add_u32 s76, s9, 4096
    buffer_load_dwordx4 v[212:215], v8, s[28:31], s76 offen offset:3072 sc1
    s_add_u32 s76, s9, 8192
    buffer_load_dwordx4 v[128:131], v8, s[28:31], s76 offen offset:0 sc1
    s_add_u32 s76, s9, 8192
    buffer_load_dwordx4 v[132:135], v8, s[28:31], s76 offen offset:1024 sc1
    s_waitcnt vmcnt(0)
    v_max3_u32 v63, v211, v215, v131
    v_max_u32 v63, v63, v135
    v_cmp_eq_u32 vcc, -1, v63
    s_cbranch_vccnz RT216
    s_branch CD217
RT218:
    s_add_u32 s56, s56, 1
    s_cmp_gt_u32 s56, 200000
    s_cbranch_scc1 CD219
    s_waitcnt vmcnt(0)
    s_add_u32 s76, s9, 8192
    buffer_load_dwordx4 v[136:139], v8, s[28:31], s76 offen offset:2048 sc1
    s_add_u32 s76, s9, 8192
    buffer_load_dwordx4 v[140:143], v8, s[28:31], s76 offen offset:3072 sc1
    s_add_u32 s76, s9, 12288
    buffer_load_dwordx4 v[144:147], v8, s[28:31], s76 offen offset:0 sc1
    s_add_u32 s76, s9, 12288
    buffer_load_dwordx4 v[148:151], v8, s[28:31], s76 offen offset:1024 sc1
    s_waitcnt vmcnt(0)
    v_max3_u32 v63, v139, v143, v147
    v_max_u32 v63, v63, v151
    v_cmp_eq_u32 vcc, -1, v63
    s_cbranch_vccnz RT218
    s_branch CD219
PL222:
    buffer_store_dwordx4 v[64:67], v1, s[28:31], s81 offen sc0 sc1
    s_branch PE223
RT220:
    s_add_u32 s56, s56, 1
    s_cmp_gt_u32 s56, 200000
    s_cbranch_scc1 CD221
    buffer_load_dword v63, v15, s[28:31], s78 offen sc1
    s_waitcnt vmcnt(0)
    v_cmp_eq_u32 vcc, -1, v63
    s_cbranch_vccnz RT220
    s_add_u32 s76, s8, 114688
    buffer_load_dwordx4 v[152:155], v8, s[28:31], s76 offen offset:0 sc1
    s_add_u32 s76, s8, 114688
    buffer_load_dwordx4 v[156:159], v8, s[28:31], s76 offen offset:1024 sc1
    s_add_u32 s76, s8, 114688
    buffer_load_dwordx4 v[160:163], v8, s[28:31], s76 offen offset:2048 sc1
    s_add_u32 s76, s8, 114688
    buffer_load_dwordx4 v[164:167], v8, s[28:31], s76 offen offset:3072 sc1
    s_add_u32 s76, s8, 118784
    buffer_load_dwordx4 v[168:171], v8, s[28:31], s76 offen offset:0 sc1
    s_add_u32 s76, s8, 118784
    buffer_load_dwordx4 v[172:175], v8, s[28:31], s76 offen offset:1024 sc1
    s_add_u32 s76, s8, 118784
    buffer_load_dwordx4 v[176:179], v8, s[28:31], s76 offen offset:2048 sc1
    s_add_u32 s76, s8, 118784
    buffer_load_dwordx4 v[180:183], v8, s[28:31], s76 offen offset:3072 sc1
    s_add_u32 s76, s8, 122880
    buffer_load_dwordx4 v[184:187], v8, s[28:31], s76 offen offset:0 sc1
    s_add_u32 s76, s8, 122880
    buffer_load_dwordx4 v[188:191], v8, s[28:31], s76 offen offset:1024 sc1
    s_add_u32 s76, s8, 122880
    buffer_load_dwordx4 v[192:195], v8, s[28:31], s76 offen offset:2048 sc1
    s_add_u32 s76, s8, 122880
    buffer_load_dwordx4 v[196:199], v8, s[28:31], s76 offen offset:3072 sc1
    s_add_u32 s76, s8, 126976
    buffer_load_dwordx4 v[200:203], v8, s[28:31], s76 offen offset:0 sc1
    s_add_u32 s76, s8, 126976
    buffer_load_dwordx4 v[204:207], v8, s[28:31], s76 offen offset:1024 sc1
    s_add_u32 s76, s9, 114688
    buffer_load_dwordx4 v[208:211], v8, s[28:31], s76 offen offset:0 sc1
    s_add_u32 s76, s9, 114688
    buffer_load_dwordx4 v[212:215], v8, s[28:31], s76 offen offset:1024 sc1
    s_waitcnt vmcnt(12)
    v_max3_u32 v63, v155, v159, v163
    v_max_u32 v63, v63, v167
    v_cmp_eq_u32 vcc, -1, v63
    s_cbranch_vccnz RT220
    s_branch CD221
RT224:
    s_add_u32 s56, s56, 1
    s_cmp_gt_u32 s56, 200000
    s_cbranch_scc1 CD225
    s_waitcnt vmcnt(0)
    s_add_u32 s76, s8, 118784
    buffer_load_dwordx4 v[168:171], v8, s[28:31], s76 offen offset:0 sc1
    s_add_u32 s76, s8, 118784
    buffer_load_dwordx4 v[172:175], v8, s[28:31], s76 offen offset:1024 sc1
    s_add_u32 s76, s8, 118784
    buffer_load_dwordx4 v[176:179], v8, s[28:31], s76 offen offset:2048 sc1
    s_add_u32 s76, s8, 118784
    buffer_load_dwordx4 v[180:183], v8, s[28:31], s76 offen offset:3072 sc1
    s_waitcnt vmcnt(0)
    v_max3_u32 v63, v171, v175, v179
    v_max_u32 v63, v63, v183
    v_cmp_eq_u32 vcc, -1, v63
    s_cbranch_vccnz RT224
    s_branch CD225
RT226:
    s_add_u32 s56, s56, 1
    s_cmp_gt_u32 s56, 200000
    s_cbranch_scc1 CD227
    s_waitcnt vmcnt(0)
    s_add_u32 s76, s8, 122880
    buffer_load_dwordx4 v[184:187], v8, s[28:31], s76 offen offset:0 sc1
    s_add_u32 s76, s8, 122880
    buffer_load_dwordx4 v[188:191], v8, s[28:31], s76 offen offset:1024 sc1
    s_add_u32 s76, s8, 122880
    buffer_load_dwordx4 v[192:195], v8, s[28:31], s76 offen offset:2048 sc1
    s_add_u32 s76, s8, 122880
    buffer_load_dwordx4 v[196:199], v8, s[28:31], s76 offen offset:3072 sc1
    s_waitcnt vmcnt(0)
    v_max3_u32 v63, v187, v191, v195
    v_max_u32 v63, v63, v199
    v_cmp_eq_u32 vcc, -1, v63
    s_cbranch_vccnz RT226
    s_branch CD227
RT228:
    s_add_u32 s56, s56, 1
    s_cmp_gt_u32 s56, 200000
    s_cbranch_scc1 CD229
    s_waitcnt vmcnt(0)
    s_add_u32 s76, s8, 126976
    buffer_load_dwordx4 v[200:203], v8, s[28:31], s76 offen offset:0 sc1
    s_add_u32 s76, s8, 126976
    buffer_load_dwordx4 v[204:207], v8, s[28:31], s76 offen offset:1024 sc1
    s_add_u32 s76, s9, 114688
    buffer_load_dwordx4 v[208:211], v8, s[28:31], s76 offen offset:0 sc1
    s_add_u32 s76, s9, 114688
    buffer_load_dwordx4 v[212:215], v8, s[28:31], s76 offen offset:1024 sc1
    s_waitcnt vmcnt(0)
    v_max3_u32 v63, v203, v207, v211
    v_max_u32 v63, v63, v215
    v_cmp_eq_u32 vcc, -1, v63
    s_cbranch_vccnz RT228
    s_branch CD229
RT230:
    s_add_u32 s56, s56, 1
    s_cmp_gt_u32 s56, 200000
    s_cbranch_scc1 CD231
    s_waitcnt vmcnt(0)
    s_add_u32 s76, s9, 114688
    buffer_load_dwordx4 v[128:131], v8, s[28:31], s76 offen offset:2048 sc1
    s_add_u32 s76, s9, 114688
    buffer_load_dwordx4 v[132:135], v8, s[28:31], s76 offen offset:3072 sc1
    s_add_u32 s76, s9, 118784
    buffer_load_dwordx4 v[136:139], v8, s[28:31], s76 offen offset:0 sc1
    s_add_u32 s76, s9, 118784
    buffer_load_dwordx4 v[140:143], v8, s[28:31], s76 offen offset:1024 sc1
    s_waitcnt vmcnt(0)
    v_max3_u32 v63, v131, v135, v139
    v_max_u32 v63, v63, v143
    v_cmp_eq_u32 vcc, -1, v63
    s_cbranch_vccnz RT230
    s_branch CD231
RT234:
    s_add_u32 s56, s56, 1
    s_cmp_gt_u32 s56, 200000
    s_cbranch_scc1 CD235
    s_waitcnt vmcnt(0)
    s_add_u32 s76, s9, 118784
    buffer_load_dwordx4 v[144:147], v8, s[28:31], s76 offen offset:2048 sc1
    s_add_u32 s76, s9, 118784
    buffer_load_dwordx4 v[148:151], v8, s[28:31], s76 offen offset:3072 sc1
    s_add_u32 s76, s9, 122880
    buffer_load_dwordx4 v[152:155], v8, s[28:31], s76 offen offset:0 sc1
    s_add_u32 s76, s9, 122880
    buffer_load_dwordx4 v[156:159], v8, s[28:31], s76 offen offset:1024 sc1
    s_waitcnt vmcnt(0)
    v_max3_u32 v63, v147, v151, v155
    v_max_u32 v63, v63, v159
    v_cmp_eq_u32 vcc, -1, v63
    s_cbranch_vccnz RT234
    s_branch CD235
RT236:
    s_add_u32 s56, s56, 1
    s_cmp_gt_u32 s56, 200000
    s_cbranch_scc1 CD237
    s_waitcnt vmcnt(0)
    s_add_u32 s76, s9, 122880
    buffer_load_dwordx4 v[160:163], v8, s[28:31], s76 offen offset:2048 sc1
    s_add_u32 s76, s9, 122880
    buffer_load_dwordx4 v[164:167], v8, s[28:31], s76 offen offset:3072 sc1
    s_add_u32 s76, s9, 126976
    buffer_load_dwordx4 v[168:171], v8, s[28:31], s76 offen offset:0 sc1
    s_add_u32 s76, s9, 126976
    buffer_load_dwordx4 v[172:175], v8, s[28:31], s76 offen offset:1024 sc1
    s_waitcnt vmcnt(0)
    v_max3_u32 v63, v163, v167, v171
    v_max_u32 v63, v63, v175
    v_cmp_eq_u32 vcc, -1, v63
    s_cbranch_vccnz RT236
    s_branch CD237
PL238:
    buffer_store_dwordx4 v[64:67], v1, s[28:31], s81 offen sc0 sc1
    s_branch PE239
RT232:
    s_add_u32 s56, s56, 1
    s_cmp_gt_u32 s56, 200000
    s_cbranch_scc1 CD233
    s_waitcnt vmcnt(0)
    s_add_u32 s81, s83, 12582912
    buffer_load_dwordx4 v[216:219], v1, s[28:31], s81 offen sc1
    s_waitcnt vmcnt(0)
    v_max_u32 v61, v217, v219
    v_cmp_eq_u32 vcc, -1, v61
    s_cbranch_vccnz RT232
    s_branch CD233
.section .rodata,"a"
.p2align 6
.amdhsa_kernel interleave_layers__linear_attn_block__mixer_token_mlp__prompt_kernel
  .amdhsa_next_free_vgpr 512
  .amdhsa_next_free_sgpr 102
  .amdhsa_accum_offset 256
  .amdhsa_group_segment_fixed_size 0
  .amdhsa_kernarg_size 88
  .amdhsa_user_sgpr_count 2
  .amdhsa_user_sgpr_kernarg_segment_ptr 1
  .amdhsa_system_sgpr_workgroup_id_x 1
.end_amdhsa_kernel
```
